```python
import torch

def _softmax(x, axis=-1):
    return torch.softmax(x, dim=axis)
def _gelu(x):
    return torch.nn.functional.gelu(x, approximate="tanh")
def _silu(x):
    return torch.nn.functional.silu(x)
def _sigmoid(x):
    return torch.sigmoid(x)
def _layernorm(x, axis=-1, eps=1e-5):
    m = x.mean(dim=axis, keepdim=True)
    v = x.var(dim=axis, keepdim=True, unbiased=False)
    return (x - m) / torch.sqrt(v + eps)
def _scatter_add(tgt, idx, src, axis=0):
    return tgt.clone().index_add_(axis, idx, src)
def _segment_sum(src, seg, n):
    out = torch.zeros((n,) + src.shape[1:], dtype=src.dtype)
    return out.index_add_(0, seg, src)
def _pad(x, pw):
    flat = tuple(v for pair in reversed(pw) for v in pair)
    return torch.nn.functional.pad(x, flat)

kernel_name = 'gated_mix__ssm_conv_s4d__ssm_conv_s5__prompt'

def setup_inputs():

    _w = (lambda a: (lambda t: t.to(torch.bfloat16) if t.is_floating_point() else t)(torch.as_tensor(a)))
    def _A_setup():
        Bsz, L, D, N = 1, 2048, 576, 128
        return {
            "u": _w((lambda *s: torch.randn(*s, dtype=torch.bfloat16) * 0.05)(Bsz, L, D)),
            "log_A_real": _w((lambda *s: torch.randn(*s, dtype=torch.bfloat16) * 3.2)(D, N) * 0.5),
            "A_imag": _w((lambda *s: torch.randn(*s, dtype=torch.bfloat16) * 0.05)(D, N) * 3.14),
            "C_real": _w((lambda *s: torch.randn(*s, dtype=torch.bfloat16) * 0.1)(D, N) / N ** 0.5),
            "C_imag": _w((lambda *s: torch.randn(*s, dtype=torch.bfloat16) * 0.1)(D, N) / N ** 0.5),
            "log_dt": _w((lambda *s: torch.randn(*s, dtype=torch.bfloat16) * 0.05)(D) * 0.5 - 4.0),
            "D_skip": _w((lambda *s: torch.randn(*s, dtype=torch.bfloat16) * 0.05)(D)),
        }
    _A_in = _A_setup()

    def _B_setup():
        B, S, D = 1, 2048, 576
        P = D
        Lambda_re = -0.5 * (lambda _x: torch.exp(torch.as_tensor(_x)))((lambda *s: torch.randn(*s, dtype=torch.bfloat16) * 0.2)(P))
        Lambda_im = (lambda *s: torch.randn(*s, dtype=torch.bfloat16) * 0.4)(P) * 1.0
        B_re = (lambda *s: torch.randn(*s, dtype=torch.bfloat16) * 0.2)(P, D) * (D ** -0.5)
        B_im = (lambda *s: torch.randn(*s, dtype=torch.bfloat16) * 0.2)(P, D) * (D ** -0.5)
        C_re = (lambda *s: torch.randn(*s, dtype=torch.bfloat16) * 0.2)(D, P) * (P ** -0.5)
        C_im = (lambda *s: torch.randn(*s, dtype=torch.bfloat16) * 0.2)(D, P) * (P ** -0.5)
        log_dt = (lambda *s: torch.randn(*s, dtype=torch.bfloat16) * 0.2)(P) * 0.3 - 2.0
        Dskip = (lambda *s: torch.randn(*s, dtype=torch.bfloat16) * 0.05)(D)
        return {
            "x": _w((lambda *s: torch.randn(*s, dtype=torch.bfloat16) * 0.05)(B, S, D)),
            "Lambda_re": _w(Lambda_re),
            "Lambda_im": _w(Lambda_im),
            "B_re": _w(B_re),
            "B_im": _w(B_im),
            "C_re": _w(C_re),
            "C_im": _w(C_im),
            "log_dt": _w(log_dt),
            "Dskip": _w(Dskip),
        }
    _B_in = _B_setup()

    return {
        "A_u": _A_in["u"],
        "A_log_A_real": _A_in["log_A_real"],
        "A_A_imag": _A_in["A_imag"],
        "A_C_real": _A_in["C_real"],
        "A_C_imag": _A_in["C_imag"],
        "A_log_dt": _A_in["log_dt"],
        "A_D_skip": _A_in["D_skip"],
        "B_x": _B_in["x"],
        "B_Lambda_re": _B_in["Lambda_re"],
        "B_Lambda_im": _B_in["Lambda_im"],
        "B_B_re": _B_in["B_re"],
        "B_B_im": _B_in["B_im"],
        "B_C_re": _B_in["C_re"],
        "B_C_im": _B_in["C_im"],
        "B_log_dt": _B_in["log_dt"],
        "B_Dskip": _B_in["Dskip"],
        "gate_w": _w((lambda *s: torch.randn(*s, dtype=torch.bfloat16) * 0.05)(576) * 16.0),
    }

def reference(A_u, A_log_A_real, A_A_imag, A_C_real, A_C_imag, A_log_dt, A_D_skip, B_x, B_Lambda_re, B_Lambda_im, B_B_re, B_B_im, B_C_re, B_C_im, B_log_dt, B_Dskip, gate_w):
    def _A_ref(u, log_A_real, A_imag, C_real, C_imag, log_dt, D_skip):
        L = u.shape[1]
        dt = torch.exp(log_dt)
        A = -torch.exp(log_A_real) + 1j * A_imag
        C = (C_real + 1j * C_imag) * dt[:, None]
        pos = (lambda x, dt: x.to(dt))(torch.arange(L), log_dt.dtype)
        P = torch.exp((A * dt[:, None])[:, :, None] * pos[None, None, :])
        K = 2.0 * torch.einsum("dn,dnl->dl", C, P).real
        L2 = 2 * L
        u_t = (lambda x, *d: x.permute(*d))(u, 0, 2, 1)
        Kf = (lambda x, *a, **k: torch.fft.rfft(x.float(), *a, **k))(K, L2)
        Uf = (lambda x, *a, **k: torch.fft.rfft(x.float(), *a, **k))(u_t, L2)
        y = (lambda x, *a, **k: torch.fft.irfft(x, *a, **k).to(torch.bfloat16))(Uf * Kf[None, :, :], L2)[:, :, :L]
        y = (lambda x, *d: x.permute(*d))(y, 0, 2, 1)
        return y + u * D_skip[None, None, :]

    def _B_ref(x, Lambda_re, Lambda_im, B_re, B_im, C_re, C_im, log_dt, Dskip):
        Bsz, L, H = x.shape
        Lam = Lambda_re + 1j * Lambda_im
        Bmat = B_re + 1j * B_im
        Cmat = C_re + 1j * C_im
        dt = torch.exp(log_dt)
        Lam_bar = torch.exp(dt * Lam)
        B_bar = ((Lam_bar - 1.0) / Lam)[:, None] * Bmat
        Bu = torch.einsum("bld,pd->blp", x + 0j, B_bar)
        h = torch.zeros_like(Bu[:, 0, :])
        hs = []
        for t in range(L):
            h = Lam_bar[None, :] * h + Bu[:, t, :]
            hs.append(h)
        hseq = torch.stack(hs, 1)
        y = 2.0 * torch.einsum("blp,dp->bld", hseq, Cmat).real + x * Dskip[None, None, :]
        return y

    x = A_u
    g = _sigmoid((x * gate_w).sum(-1, keepdims=True))
    a = _A_ref(x, A_log_A_real, A_A_imag, A_C_real, A_C_imag, A_log_dt, A_D_skip)
    b = _B_ref(x, B_Lambda_re, B_Lambda_im, B_B_re, B_B_im, B_C_re, B_C_im, B_log_dt, B_Dskip)
    return g * a + (1 - g) * b
```

```asm
; @launch grid=(256,1,1) block=(512,1,1) lds=163840
.amdgcn_target "amdgcn-amd-amdhsa--gfx950"
.text
.globl gated_mix__ssm_conv_s4d__ssm_conv_s5__prompt_kernel
.p2align 8
.type gated_mix__ssm_conv_s4d__ssm_conv_s5__prompt_kernel,@function
gated_mix__ssm_conv_s4d__ssm_conv_s5__prompt_kernel:
    s_load_dwordx16 s[8:23], s[0:1], 0
    s_load_dwordx16 s[24:39], s[0:1], 64
    s_load_dwordx8 s[40:47], s[0:1], 128
    s_cmp_ge_u32 s2, 256
    s_cbranch_scc1 L_end
    v_lshrrev_b32 v4, 6, v0
    s_lshr_b32 s6, s2, 3
    v_readfirstlane_b32 s48, v4
    s_add_u32 s49, s6, 18
    s_and_b32 s49, s49, 31
    s_and_b32 s50, s2, 7
    v_and_b32 v1, 63, v0
    v_and_b32_e64 v2, 15, v0
    v_bfe_u32 v3, v0, 4, 2
    s_cmp_lt_u32 s48, 4
    s_cbranch_scc0 L_hi
    s_getpc_b64 s[4:5]
    s_lshl_b32 s6, s6, 4
    v_lshrrev_b32 v252, 4, v0
    v_add_u32 v252, s6, v252
    v_min_u32 v252, (L_end - gated_mix__ssm_conv_s4d__ssm_conv_s5__prompt_kernel)/128, v252
    v_lshlrev_b32 v252, 7, v252
    v_mov_b32_e64 v253, s5
    v_add_co_u32 v252, vcc, s4, v252
    s_nop 1
    v_addc_co_u32 v253, vcc, 0, v253, vcc
    global_load_dword v7, v[252:253], off
    s_cmp_ge_u32 s49, 18
    s_cbranch_scc1 L_A
    s_branch L_LO
L_hi:
    s_cmp_ge_u32 s49, 18
    s_cbranch_scc1 L_R2G
    s_cmp_ge_u32 s49, 9
    s_cselect_b32 s5, 1, 0
    s_cselect_b32 s54, 9, 0
    s_lshl_b32 s53, s50, 1
    s_sub_u32 s54, s49, s54
    s_add_u32 s53, s53, s5
    s_add_u32 s59, s54, s50
    s_sub_u32 s4, s59, 9
    s_min_u32 s59, s59, s4
    s_lshl_b32 s59, s59, 7
    s_movk_i32 s3, 1152
    s_sub_u32 s62, s48, 4
    v_lshrrev_b32 v4, 3, v1
    v_and_b32 v5, 7, v1
    s_lshl_b32 s4, s54, 1
    v_xor_b32 v5, v5, v3
    s_and_b32 s5, s62, 1
    v_lshlrev_b32 v5, 4, v5
    s_add_u32 s4, s4, s5
    v_mad_u32_u24 v6, v4, s3, v5
    s_mul_i32 s4, s4, 36864
    s_mov_b32 s70, 663552
    s_mov_b32 s71, 0x20000
    v_add_u32 v12, s4, v6
    s_lshl_b32 s6, s62, 12
    v_xor_b32_e64 v13, 64, v12
    v_add_u32 v14, 16384, v12
    v_add_u32 v15, 24576, v13
    v_add_u32 v13, 8192, v13
    v_and_b32 v8, 4, v4
    v_lshlrev_b32 v8, 3, v8
    v_and_b32_e64 v9, 1, v4
    v_lshl_add_u32 v8, v9, 4, v8
    v_bfe_u32 v9, v4, 1, 1
    s_lshl_b32 s4, s53, 7
    s_lshl_b32 s5, s62, 2
    s_add_u32 s4, s4, s5
    v_add3_u32 v8, v8, v9, s4
    v_mad_u32_u24 v8, v8, s3, v5
    s_mov_b32 s66, 2359296
    s_mov_b32 s67, 0x20000
    v_xor_b32 v9, 64, v8
    v_add_u32 v10, 256, v8
    v_add_u32 v11, 72960, v9
    v_add_u32 v9, 72704, v9
    s_cmp_lt_u32 s62, 2
    s_waitcnt lgkmcnt(0)
    s_mov_b64 s[64:65], s[8:9]
    s_cselect_b64 s[68:69], s[28:29], s[30:31]
    s_mov_b32 s10, s59
    s_add_u32 m0, s6, 49152
    s_nop 0
    buffer_load_dwordx4 v12, s[68:71], s10 offen offset:0 lds
    buffer_load_dwordx4 v13, s[68:71], s10 offen offset:1024 lds
    buffer_load_dwordx4 v14, s[68:71], s10 offen offset:2048 lds
    buffer_load_dwordx4 v15, s[68:71], s10 offen offset:3072 lds
    s_add_u32 m0, s6, 0
    s_nop 0
    buffer_load_dwordx4 v8, s[64:67], s10 offen offset:0 lds
    buffer_load_dwordx4 v9, s[64:67], s10 offen offset:1024 lds
    buffer_load_dwordx4 v10, s[64:67], s10 offen offset:2048 lds
    buffer_load_dwordx4 v11, s[64:67], s10 offen offset:3072 lds
    s_add_u32 s11, s10, 128
    s_cmp_eq_u32 s11, 1152
    s_cselect_b32 s11, 0, s11
    s_add_u32 s12, s11, 128
    s_cmp_eq_u32 s12, 1152
    s_cselect_b32 s12, 0, s12
    s_add_u32 s13, s12, 128
    s_cmp_eq_u32 s13, 1152
    s_cselect_b32 s13, 0, s13
    s_add_u32 s14, s13, 128
    s_cmp_eq_u32 s14, 1152
    s_cselect_b32 s14, 0, s14
    s_add_u32 s15, s14, 128
    s_cmp_eq_u32 s15, 1152
    s_cselect_b32 s15, 0, s15
    s_add_u32 s16, s15, 128
    s_cmp_eq_u32 s16, 1152
    s_cselect_b32 s16, 0, s16
    s_add_u32 s17, s16, 128
    s_cmp_eq_u32 s17, 1152
    s_cselect_b32 s17, 0, s17
    s_add_u32 s18, s17, 128
    s_cmp_eq_u32 s18, 1152
    s_cselect_b32 s18, 0, s18
    s_cmp_ge_u32 s49, 12
    s_mov_b32 s4, 3393292320
    s_mov_b32 s5, 155585890
    s_cmov_b32 s4, 899438227
    s_cmov_b32 s5, 250833482
    s_cselect_b32 s52, 12, 0
    s_sub_u32 s52, s49, s52
    s_mul_i32 s52, s52, 5
    s_lshr_b64 s[4:5], s[4:5], s52
    s_and_b32 s52, s4, 7
    s_bfe_u32 s4, s4, 0x20003
    s_and_b32 s51, s4, 1
    s_lshl_b32 s56, s50, 2
    s_add_u32 s56, s56, s4
    s_mul_i32 s57, s52, 3
    s_lshr_b32 s57, s57, 1
    s_mul_i32 s4, s4, 0
    s_add_u32 s57, s57, s4
    s_mul_i32 s4, s50, 3
    s_add_u32 s57, s57, s4
    s_mul_hi_u32 s4, s57, 0x1C71C71D
    s_mul_i32 s4, s4, 9
    s_sub_u32 s57, s57, s4
    s_lshl_b32 s57, s57, 7
    s_mov_b32 s74, 663552
    s_mov_b32 s75, 0x20000
    s_mul_i32 s61, s62, 12288
    s_add_u32 s61, s61, 100352
    s_cmp_lt_u32 s62, 2
    s_cselect_b32 s72, s32, s34
    s_cselect_b32 s73, s33, s35
    s_mov_b32 s33, s57
    s_mul_i32 s4, s52, 96
    s_and_b32 s5, s62, 1
    s_mul_i32 s5, s5, 48
    s_add_u32 s4, s4, s5
    s_mul_i32 s4, s4, 1152
    v_add_u32 v6, s4, v6
    v_xor_b32_e64 v7, 64, v6
    v_add_u32 v7, 8192, v7
    v_lshrrev_b32 v4, 1, v2
    v_xor_b32 v4, v4, v3
    v_lshlrev_b32_e64 v4, 4, v4
    v_lshl_add_u32 v4, v2, 7, v4
    v_add_u32 v4, s61, v4
    v_xor_b32 v5, 64, v4
    s_add_u32 s34, s33, 128
    s_cmp_eq_u32 s34, 1152
    s_cselect_b32 s34, 0, s34
    s_add_u32 s35, s34, 128
    s_cmp_eq_u32 s35, 1152
    s_cselect_b32 s35, 0, s35
    s_add_u32 s36, s35, 128
    s_cmp_eq_u32 s36, 1152
    s_cselect_b32 s36, 0, s36
    s_add_u32 s37, s36, 128
    s_cmp_eq_u32 s37, 1152
    s_cselect_b32 s37, 0, s37
    s_add_u32 s40, s37, 128
    s_cmp_eq_u32 s40, 1152
    s_cselect_b32 s40, 0, s40
    s_add_u32 s41, s40, 128
    s_cmp_eq_u32 s41, 1152
    s_cselect_b32 s41, 0, s41
    s_add_u32 s44, s41, 128
    s_cmp_eq_u32 s44, 1152
    s_cselect_b32 s44, 0, s44
    s_add_u32 s45, s44, 128
    s_cmp_eq_u32 s45, 1152
    s_cselect_b32 s45, 0, s45
    s_add_u32 m0, s6, 65536
    s_nop 0
    buffer_load_dwordx4 v12, s[68:71], s11 offen offset:0 lds
    buffer_load_dwordx4 v13, s[68:71], s11 offen offset:1024 lds
    buffer_load_dwordx4 v14, s[68:71], s11 offen offset:2048 lds
    buffer_load_dwordx4 v15, s[68:71], s11 offen offset:3072 lds
    s_add_u32 m0, s6, 16384
    s_nop 0
    buffer_load_dwordx4 v8, s[64:67], s11 offen offset:0 lds
    buffer_load_dwordx4 v9, s[64:67], s11 offen offset:1024 lds
    buffer_load_dwordx4 v10, s[64:67], s11 offen offset:2048 lds
    buffer_load_dwordx4 v11, s[64:67], s11 offen offset:3072 lds
    s_waitcnt vmcnt(8)
    s_barrier
    s_add_u32 m0, s6, 81920
    s_nop 0
    buffer_load_dwordx4 v12, s[68:71], s12 offen offset:0 lds
    buffer_load_dwordx4 v13, s[68:71], s12 offen offset:1024 lds
    buffer_load_dwordx4 v14, s[68:71], s12 offen offset:2048 lds
    buffer_load_dwordx4 v15, s[68:71], s12 offen offset:3072 lds
    s_add_u32 m0, s6, 32768
    s_nop 0
    buffer_load_dwordx4 v8, s[64:67], s12 offen offset:0 lds
    buffer_load_dwordx4 v9, s[64:67], s12 offen offset:1024 lds
    buffer_load_dwordx4 v10, s[64:67], s12 offen offset:2048 lds
    buffer_load_dwordx4 v11, s[64:67], s12 offen offset:3072 lds
    s_waitcnt vmcnt(8)
    s_barrier
    s_add_u32 m0, s6, 49152
    s_nop 0
    buffer_load_dwordx4 v12, s[68:71], s13 offen offset:0 lds
    buffer_load_dwordx4 v13, s[68:71], s13 offen offset:1024 lds
    buffer_load_dwordx4 v14, s[68:71], s13 offen offset:2048 lds
    buffer_load_dwordx4 v15, s[68:71], s13 offen offset:3072 lds
    s_add_u32 m0, s6, 0
    s_nop 0
    buffer_load_dwordx4 v8, s[64:67], s13 offen offset:0 lds
    buffer_load_dwordx4 v9, s[64:67], s13 offen offset:1024 lds
    buffer_load_dwordx4 v10, s[64:67], s13 offen offset:2048 lds
    buffer_load_dwordx4 v11, s[64:67], s13 offen offset:3072 lds
    s_waitcnt vmcnt(8)
    s_barrier
    s_add_u32 m0, s6, 65536
    s_nop 0
    buffer_load_dwordx4 v12, s[68:71], s14 offen offset:0 lds
    buffer_load_dwordx4 v13, s[68:71], s14 offen offset:1024 lds
    buffer_load_dwordx4 v14, s[68:71], s14 offen offset:2048 lds
    buffer_load_dwordx4 v15, s[68:71], s14 offen offset:3072 lds
    s_add_u32 m0, s6, 16384
    s_nop 0
    buffer_load_dwordx4 v8, s[64:67], s14 offen offset:0 lds
    buffer_load_dwordx4 v9, s[64:67], s14 offen offset:1024 lds
    buffer_load_dwordx4 v10, s[64:67], s14 offen offset:2048 lds
    buffer_load_dwordx4 v11, s[64:67], s14 offen offset:3072 lds
    s_waitcnt vmcnt(8)
    s_barrier
    s_add_u32 m0, s6, 81920
    s_nop 0
    buffer_load_dwordx4 v12, s[68:71], s15 offen offset:0 lds
    buffer_load_dwordx4 v13, s[68:71], s15 offen offset:1024 lds
    buffer_load_dwordx4 v14, s[68:71], s15 offen offset:2048 lds
    buffer_load_dwordx4 v15, s[68:71], s15 offen offset:3072 lds
    s_add_u32 m0, s6, 32768
    s_nop 0
    buffer_load_dwordx4 v8, s[64:67], s15 offen offset:0 lds
    buffer_load_dwordx4 v9, s[64:67], s15 offen offset:1024 lds
    buffer_load_dwordx4 v10, s[64:67], s15 offen offset:2048 lds
    buffer_load_dwordx4 v11, s[64:67], s15 offen offset:3072 lds
    s_waitcnt vmcnt(8)
    s_barrier
    s_add_u32 m0, s6, 49152
    s_nop 0
    buffer_load_dwordx4 v12, s[68:71], s16 offen offset:0 lds
    buffer_load_dwordx4 v13, s[68:71], s16 offen offset:1024 lds
    buffer_load_dwordx4 v14, s[68:71], s16 offen offset:2048 lds
    buffer_load_dwordx4 v15, s[68:71], s16 offen offset:3072 lds
    s_add_u32 m0, s6, 0
    s_nop 0
    buffer_load_dwordx4 v8, s[64:67], s16 offen offset:0 lds
    buffer_load_dwordx4 v9, s[64:67], s16 offen offset:1024 lds
    buffer_load_dwordx4 v10, s[64:67], s16 offen offset:2048 lds
    buffer_load_dwordx4 v11, s[64:67], s16 offen offset:3072 lds
    s_waitcnt vmcnt(8)
    s_barrier
    s_add_u32 m0, s6, 65536
    s_nop 0
    buffer_load_dwordx4 v12, s[68:71], s17 offen offset:0 lds
    buffer_load_dwordx4 v13, s[68:71], s17 offen offset:1024 lds
    buffer_load_dwordx4 v14, s[68:71], s17 offen offset:2048 lds
    buffer_load_dwordx4 v15, s[68:71], s17 offen offset:3072 lds
    s_add_u32 m0, s6, 16384
    s_nop 0
    buffer_load_dwordx4 v8, s[64:67], s17 offen offset:0 lds
    buffer_load_dwordx4 v9, s[64:67], s17 offen offset:1024 lds
    buffer_load_dwordx4 v10, s[64:67], s17 offen offset:2048 lds
    buffer_load_dwordx4 v11, s[64:67], s17 offen offset:3072 lds
    s_waitcnt vmcnt(8)
    s_barrier
    s_add_u32 m0, s6, 81920
    s_nop 0
    buffer_load_dwordx4 v12, s[68:71], s18 offen offset:0 lds
    buffer_load_dwordx4 v13, s[68:71], s18 offen offset:1024 lds
    buffer_load_dwordx4 v14, s[68:71], s18 offen offset:2048 lds
    buffer_load_dwordx4 v15, s[68:71], s18 offen offset:3072 lds
    s_add_u32 m0, s6, 32768
    s_nop 0
    buffer_load_dwordx4 v8, s[64:67], s18 offen offset:0 lds
    buffer_load_dwordx4 v9, s[64:67], s18 offen offset:1024 lds
    buffer_load_dwordx4 v10, s[64:67], s18 offen offset:2048 lds
    buffer_load_dwordx4 v11, s[64:67], s18 offen offset:3072 lds
    s_waitcnt vmcnt(8)
    s_barrier
    s_add_u32 m0, s61, 0
    s_add_u32 s20, s33, 0
    buffer_load_dwordx4 v6, s[72:75], s20 offen lds
    buffer_load_dwordx4 v7, s[72:75], s20 offen offset:1024 lds
    s_add_u32 m0, s61, 2048
    s_add_u32 s20, s33, 18432
    buffer_load_dwordx4 v6, s[72:75], s20 offen lds
    buffer_load_dwordx4 v7, s[72:75], s20 offen offset:1024 lds
    s_add_u32 m0, s61, 4096
    s_add_u32 s20, s33, 36864
    buffer_load_dwordx4 v6, s[72:75], s20 offen lds
    buffer_load_dwordx4 v7, s[72:75], s20 offen offset:1024 lds
    s_add_u32 m0, s61, 6144
    s_add_u32 s20, s34, 0
    buffer_load_dwordx4 v6, s[72:75], s20 offen lds
    buffer_load_dwordx4 v7, s[72:75], s20 offen offset:1024 lds
    s_waitcnt vmcnt(8)
    s_barrier
    s_add_u32 m0, s61, 8192
    s_add_u32 s20, s34, 18432
    buffer_load_dwordx4 v6, s[72:75], s20 offen lds
    buffer_load_dwordx4 v7, s[72:75], s20 offen offset:1024 lds
    s_waitcnt vmcnt(8)
    ds_read_b128 v[88:91], v4 offset:0
    ds_read_b128 v[100:103], v5 offset:0
    s_add_u32 m0, s61, 10240
    s_add_u32 s20, s34, 36864
    buffer_load_dwordx4 v6, s[72:75], s20 offen lds
    buffer_load_dwordx4 v7, s[72:75], s20 offen offset:1024 lds
    s_waitcnt vmcnt(8)
    ds_read_b128 v[92:95], v4 offset:2048
    ds_read_b128 v[104:107], v5 offset:2048
    s_waitcnt lgkmcnt(2)
    s_add_u32 m0, s61, 0
    s_add_u32 s20, s35, 0
    buffer_load_dwordx4 v6, s[72:75], s20 offen lds
    buffer_load_dwordx4 v7, s[72:75], s20 offen offset:1024 lds
    s_waitcnt vmcnt(8)
    ds_read_b128 v[96:99], v4 offset:4096
    ds_read_b128 v[108:111], v5 offset:4096
    s_waitcnt lgkmcnt(2)
    s_add_u32 m0, s61, 2048
    s_add_u32 s20, s35, 18432
    buffer_load_dwordx4 v6, s[72:75], s20 offen lds
    buffer_load_dwordx4 v7, s[72:75], s20 offen offset:1024 lds
    s_waitcnt vmcnt(8)
    ds_read_b128 v[112:115], v4 offset:6144
    ds_read_b128 v[124:127], v5 offset:6144
    s_waitcnt lgkmcnt(2)
    s_add_u32 m0, s61, 4096
    s_add_u32 s20, s35, 36864
    buffer_load_dwordx4 v6, s[72:75], s20 offen lds
    buffer_load_dwordx4 v7, s[72:75], s20 offen offset:1024 lds
    s_waitcnt vmcnt(8)
    ds_read_b128 v[116:119], v4 offset:8192
    ds_read_b128 v[128:131], v5 offset:8192
    s_waitcnt vmcnt(6)
    ds_read_b128 v[120:123], v4 offset:10240
    ds_read_b128 v[132:135], v5 offset:10240
    s_waitcnt lgkmcnt(4)
    s_add_u32 m0, s61, 6144
    s_add_u32 s20, s36, 0
    buffer_load_dwordx4 v6, s[72:75], s20 offen lds
    buffer_load_dwordx4 v7, s[72:75], s20 offen offset:1024 lds
    s_waitcnt vmcnt(6)
    ds_read_b128 v[136:139], v4 offset:0
    ds_read_b128 v[148:151], v5 offset:0
    s_waitcnt lgkmcnt(4)
    s_add_u32 m0, s61, 8192
    s_add_u32 s20, s36, 18432
    buffer_load_dwordx4 v6, s[72:75], s20 offen lds
    buffer_load_dwordx4 v7, s[72:75], s20 offen offset:1024 lds
    s_waitcnt vmcnt(6)
    ds_read_b128 v[140:143], v4 offset:2048
    ds_read_b128 v[152:155], v5 offset:2048
    s_waitcnt lgkmcnt(4)
    s_add_u32 m0, s61, 10240
    s_add_u32 s20, s36, 36864
    buffer_load_dwordx4 v6, s[72:75], s20 offen lds
    buffer_load_dwordx4 v7, s[72:75], s20 offen offset:1024 lds
    s_waitcnt vmcnt(6)
    ds_read_b128 v[144:147], v4 offset:4096
    ds_read_b128 v[156:159], v5 offset:4096
    s_waitcnt lgkmcnt(4)
    s_add_u32 m0, s61, 0
    s_add_u32 s20, s37, 0
    buffer_load_dwordx4 v6, s[72:75], s20 offen lds
    buffer_load_dwordx4 v7, s[72:75], s20 offen offset:1024 lds
    s_waitcnt vmcnt(6)
    ds_read_b128 v[160:163], v4 offset:6144
    ds_read_b128 v[172:175], v5 offset:6144
    s_waitcnt lgkmcnt(4)
    s_add_u32 m0, s61, 2048
    s_add_u32 s20, s37, 18432
    buffer_load_dwordx4 v6, s[72:75], s20 offen lds
    buffer_load_dwordx4 v7, s[72:75], s20 offen offset:1024 lds
    s_waitcnt vmcnt(6)
    ds_read_b128 v[164:167], v4 offset:8192
    ds_read_b128 v[176:179], v5 offset:8192
    s_waitcnt lgkmcnt(4)
    s_add_u32 m0, s61, 4096
    s_add_u32 s20, s37, 36864
    buffer_load_dwordx4 v6, s[72:75], s20 offen lds
    buffer_load_dwordx4 v7, s[72:75], s20 offen offset:1024 lds
    s_waitcnt vmcnt(6)
    ds_read_b128 v[168:171], v4 offset:10240
    ds_read_b128 v[180:183], v5 offset:10240
    s_waitcnt lgkmcnt(4)
    s_add_u32 m0, s61, 6144
    s_add_u32 s20, s40, 0
    buffer_load_dwordx4 v6, s[72:75], s20 offen lds
    buffer_load_dwordx4 v7, s[72:75], s20 offen offset:1024 lds
    s_waitcnt vmcnt(6)
    ds_read_b128 v[184:187], v4 offset:0
    ds_read_b128 v[196:199], v5 offset:0
    s_waitcnt lgkmcnt(4)
    s_add_u32 m0, s61, 8192
    s_add_u32 s20, s40, 18432
    buffer_load_dwordx4 v6, s[72:75], s20 offen lds
    buffer_load_dwordx4 v7, s[72:75], s20 offen offset:1024 lds
    s_waitcnt vmcnt(6)
    ds_read_b128 v[188:191], v4 offset:2048
    ds_read_b128 v[200:203], v5 offset:2048
    s_waitcnt lgkmcnt(4)
    s_add_u32 m0, s61, 10240
    s_add_u32 s20, s40, 36864
    buffer_load_dwordx4 v6, s[72:75], s20 offen lds
    buffer_load_dwordx4 v7, s[72:75], s20 offen offset:1024 lds
    s_waitcnt vmcnt(6)
    ds_read_b128 v[192:195], v4 offset:4096
    ds_read_b128 v[204:207], v5 offset:4096
    s_waitcnt lgkmcnt(4)
    s_add_u32 m0, s61, 0
    s_add_u32 s20, s41, 0
    buffer_load_dwordx4 v6, s[72:75], s20 offen lds
    buffer_load_dwordx4 v7, s[72:75], s20 offen offset:1024 lds
    s_waitcnt vmcnt(6)
    ds_read_b128 v[208:211], v4 offset:6144
    ds_read_b128 v[220:223], v5 offset:6144
    s_waitcnt lgkmcnt(4)
    s_add_u32 m0, s61, 2048
    s_add_u32 s20, s41, 18432
    buffer_load_dwordx4 v6, s[72:75], s20 offen lds
    buffer_load_dwordx4 v7, s[72:75], s20 offen offset:1024 lds
    s_waitcnt vmcnt(6)
    ds_read_b128 v[212:215], v4 offset:8192
    ds_read_b128 v[224:227], v5 offset:8192
    s_waitcnt lgkmcnt(4)
    s_add_u32 m0, s61, 4096
    s_add_u32 s20, s41, 36864
    buffer_load_dwordx4 v6, s[72:75], s20 offen lds
    buffer_load_dwordx4 v7, s[72:75], s20 offen offset:1024 lds
    s_waitcnt vmcnt(6)
    ds_read_b128 v[216:219], v4 offset:10240
    ds_read_b128 v[228:231], v5 offset:10240
    s_waitcnt lgkmcnt(4)
    s_add_u32 m0, s61, 6144
    s_add_u32 s20, s44, 0
    buffer_load_dwordx4 v6, s[72:75], s20 offen lds
    buffer_load_dwordx4 v7, s[72:75], s20 offen offset:1024 lds
    s_waitcnt vmcnt(6)
    ds_read_b128 v[232:235], v4 offset:0
    ds_read_b128 v[244:247], v5 offset:0
    s_waitcnt lgkmcnt(4)
    s_add_u32 m0, s61, 8192
    s_add_u32 s20, s44, 18432
    buffer_load_dwordx4 v6, s[72:75], s20 offen lds
    buffer_load_dwordx4 v7, s[72:75], s20 offen offset:1024 lds
    s_waitcnt vmcnt(6)
    ds_read_b128 v[236:239], v4 offset:2048
    ds_read_b128 v[248:251], v5 offset:2048
    s_waitcnt lgkmcnt(4)
    s_add_u32 m0, s61, 10240
    s_add_u32 s20, s44, 36864
    buffer_load_dwordx4 v6, s[72:75], s20 offen lds
    buffer_load_dwordx4 v7, s[72:75], s20 offen offset:1024 lds
    s_waitcnt vmcnt(6)
    ds_read_b128 v[240:243], v4 offset:4096
    ds_read_b128 v[252:255], v5 offset:4096
    s_waitcnt lgkmcnt(4)
    s_add_u32 m0, s61, 0
    s_add_u32 s20, s45, 0
    buffer_load_dwordx4 v6, s[72:75], s20 offen lds
    buffer_load_dwordx4 v7, s[72:75], s20 offen offset:1024 lds
    s_waitcnt lgkmcnt(2)
    s_add_u32 m0, s61, 2048
    s_add_u32 s20, s45, 18432
    buffer_load_dwordx4 v6, s[72:75], s20 offen lds
    buffer_load_dwordx4 v7, s[72:75], s20 offen offset:1024 lds
    s_waitcnt lgkmcnt(0)
    s_add_u32 m0, s61, 4096
    s_add_u32 s20, s45, 36864
    buffer_load_dwordx4 v6, s[72:75], s20 offen lds
    buffer_load_dwordx4 v7, s[72:75], s20 offen offset:1024 lds
    s_branch L_CPF
.p2align 3
L_R2G:
    s_mul_i32 s60, s50, 72
    s_mul_i32 s4, s49, 6
    s_lshl_b32 s5, s49, 2
    s_sub_u32 s4, s4, 144
    s_sub_u32 s5, s5, 24
    s_cmp_ge_u32 s49, 24
    s_cselect_b32 s4, s4, s5
    s_add_u32 s60, s60, s4
    s_sub_u32 s62, s48, 4
    v_lshrrev_b32 v4, 3, v1
    s_mul_i32 s3, s62, 14
    v_and_b32_e64 v8, 7, v1
    s_add_u32 s3, s3, s49
    v_mul_u32_u24 v6, 1152, v4
    s_sub_u32 s3, s3, 18
    v_xor_b32 v5, v8, v3
    v_lshl_add_u32 v6, v5, 4, v6
    v_mov_b32 v60, 0
    v_mov_b32_e64 v61, 0
    s_lshl_b32 s4, s48, 3
    s_add_u32 s4, s4, 149504
    v_mov_b32_e64 v10, s4
    ds_write_b64 v10, v[60:61]
    s_mul_i32 s4, s62, 8704
    s_add_u32 s4, s4, 34816
    v_lshl_add_u32 v12, v1, 3, s4
    ds_write_b64 v12, v[60:61]
    s_and_b32 s4, s62, 1
    s_mul_i32 s4, s4, 8704
    s_add_u32 s4, s4, 69632
    v_lshl_add_u32 v12, v1, 3, s4
    ds_write_b64 v12, v[60:61]
    s_lshr_b32 s4, s3, 1
    s_mul_i32 s4, s4, 21
    v_mul_u32_u24 v20, 3121, v1
    v_lshrrev_b32 v20, 16, v20
    v_mul_u32_u24 v21, 21, v20
    v_sub_u32 v21, v1, v21
    v_add_u32 v21, s4, v21
    v_lshrrev_b32 v22, 6, v21
    s_mul_i32 s4, s50, 1
    v_add_u32 v22, s4, v22
    v_mul_u32_u24 v25, 683, v21
    v_lshrrev_b32 v25, 16, v25
    v_mul_u32_u24 v25, 3, v25
    v_lshrrev_b32 v25, 1, v25
    s_mul_i32 s4, s50, 3
    v_add_u32 v25, s4, v25
    v_lshlrev_b32 v20, 2, v20
    v_mul_u32_u24 v21, 1152, v21
    s_mov_b32 s70, 663552
    s_mov_b32 s71, 0x20000
    s_mov_b32 s66, 663552
    s_mov_b32 s67, 0x20000
    v_lshlrev_b32 v16, 4, v1
    s_getpc_b64 s[4:5]
    s_add_u32 s4, s4, band_tab@rel32@lo+4
    s_addc_u32 s5, s5, band_tab@rel32@hi+12
    s_lshl_b32 s6, s62, 11
    v_add_u32 v56, s6, v16
    v_mov_b32 v57, s5
    v_add_co_u32 v56, vcc, s4, v56
    s_add_u32 m0, s6, 90112
    s_nop 0
    v_addc_co_u32 v57, vcc, 0, v57, vcc
    s_bitcmp1_b32 s3, 0
    s_waitcnt lgkmcnt(0)
    s_cselect_b32 s68, s30, s28
    s_cselect_b32 s69, s31, s29
    s_cselect_b32 s64, s34, s32
    s_cselect_b32 s65, s35, s33
    s_barrier
    s_mov_b32 s4, 13089
    v_bfe_u32 v23, s4, v20, 4
    v_add_u32 v23, v23, v22
    v_mul_u32_u24 v24, 7282, v23
    v_lshrrev_b32 v24, 16, v24
    v_mul_u32_u24 v24, 9, v24
    v_sub_u32_e64 v23, v23, v24
    v_lshl_add_u32 v23, v23, 7, v21
    buffer_load_dword v64, v23, s[68:71], 0 offen
    s_mov_b32 s4, 26196
    v_bfe_u32 v23, s4, v20, 4
    v_add_u32_e64 v23, v23, v22
    v_mul_u32_u24 v24, 7282, v23
    v_lshrrev_b32 v24, 16, v24
    v_mul_u32_u24 v24, 9, v24
    v_sub_u32_e64 v23, v23, v24
    v_lshl_add_u32 v23, v23, 7, v21
    buffer_load_dword v65, v23, s[68:71], 0 offen
    s_mov_b32 s4, 34951
    v_bfe_u32 v23, s4, v20, 4
    v_add_u32_e64 v23, v23, v22
    v_mul_u32_u24 v24, 7282, v23
    v_lshrrev_b32 v24, 16, v24
    v_mul_u32_u24 v24, 9, v24
    v_sub_u32_e64 v23, v23, v24
    v_lshl_add_u32 v23, v23, 7, v21
    s_waitcnt vmcnt(1)
    buffer_load_dword v66, v23, s[68:71], 0 offen
    global_load_dword v62, v60, s[46:47]
    global_load_lds_dwordx4 v[56:57], off
    global_load_lds_dwordx4 v[56:57], off offset:1024
    s_mov_b32 s76, s46
    s_mov_b32 s77, s47
    s_mov_b32 s78, 268435456
    s_mov_b32 s79, 0x20000
    v_lshrrev_b32 v15, 5, v1
    v_mad_u32_u24 v15, v15, 5, s60
    v_min_u32 v15, 575, v15
    v_lshrrev_b32 v15, 5, v15
    v_and_b32 v14, 31, v1
    v_lshl_add_u32 v15, v15, 5, v14
    v_lshlrev_b32_e64 v15, 5, v15
    v_add_u32 v15, 589824, v15
    s_lshl_b32 s12, s60, 12
    s_add_u32 s12, s12, 6291456
    s_mul_i32 s5, s3, 10752
    s_mul_i32 s14, s50, 589824
    s_add_u32 s4, s14, 589696
    s_add_u32 s5, s5, s14
    v_min_u32_e64 v58, 41, v1
    v_lshl_add_u32 v58, v58, 7, s5
    v_add_u32 v59, 5376, v58
    v_min_u32 v58, s4, v58
    v_min_u32 v59, s4, v59
    v_mov_b32 v19, 149560
    v_mov_b32_e64 v60, 1
    s_cmp_lg_u32 s3, 42
    s_cbranch_scc1 L_ct0
    s_mul_i32 s5, s50, 9216
    s_add_u32 s5, s5, 262144
    v_min_u32_e64 v30, 35, v1
    v_lshl_add_u32 v30, v30, 7, s5
    global_load_dword v31, v30, s[46:47]
L_ct0:
    s_cmp_lg_u32 s3, 43
    s_cbranch_scc1 L_ct1
    s_mul_i32 s5, s50, 9216
    s_add_u32 s5, s5, 266752
    v_min_u32_e64 v30, 35, v1
    v_lshl_add_u32 v30, v30, 7, s5
    global_load_dword v31, v30, s[46:47]
L_ct1:
    s_cmp_lg_u32 s3, 44
    s_cbranch_scc1 L_ct2
    s_mul_i32 s5, s50, 9216
    s_add_u32 s5, s5, 458752
    v_min_u32_e64 v30, 35, v1
    v_lshl_add_u32 v30, v30, 7, s5
    global_load_dword v31, v30, s[46:47]
L_ct2:
    s_cmp_lg_u32 s3, 45
    s_cbranch_scc1 L_ct3
    s_mul_i32 s5, s50, 9216
    s_add_u32 s5, s5, 463360
    v_min_u32_e64 v30, 35, v1
    v_lshl_add_u32 v30, v30, 7, s5
    global_load_dword v31, v30, s[46:47]
L_ct3:
    s_cmp_lg_u32 s3, 46
    s_cbranch_scc1 L_ct4
    s_mul_i32 s5, s50, 4096
    s_add_u32 s5, s5, 655360
    v_min_u32_e64 v30, 31, v1
    v_lshl_add_u32 v30, v30, 7, s5
    global_load_dword v31, v30, s[46:47]
L_ct4:
    s_cmp_lg_u32 s3, 47
    s_cbranch_scc1 L_ct5
    s_mul_i32 s5, s50, 1792
    s_add_u32 s5, s5, 393216
    v_min_u32_e64 v30, 13, v1
    v_lshl_add_u32 v30, v30, 7, s5
    global_load_dword v31, v30, s[46:47]
L_ct5:
    s_sub_u32 s5, s3, 48
    s_cmp_ge_u32 s5, 3
    s_cbranch_scc1 L_cts
    s_mul_i32 s5, s5, 49152
    s_lshl_b32 s4, s50, 11
    s_add_u32 s5, s5, s4
    s_add_u32 s5, s5, 4096
    v_min_u32 v30, 2, v3
    v_lshlrev_b32_e64 v30, 14, v30
    v_lshl_add_u32 v30, v2, 7, v30
    v_add_u32_e64 v30, s5, v30
    global_load_dword v31, v30, s[46:47]
L_cts:
    s_mov_b32 s4, 8720
    v_bfe_u32 v23, s4, v20, 4
    v_add_u32_e64 v23, v23, v25
    v_mul_u32_u24 v24, 7282, v23
    v_lshrrev_b32 v24, 16, v24
    v_mul_u32_u24 v24, 9, v24
    v_sub_u32_e64 v23, v23, v24
    v_lshl_add_u32 v23, v23, 7, v21
    s_waitcnt vmcnt(1)
    buffer_load_dword v67, v23, s[64:67], 0 offen
    s_mov_b32 s4, 21827
    v_bfe_u32 v23, s4, v20, 4
    v_add_u32 v23, v23, v25
    v_mul_u32_u24 v24, 7282, v23
    v_lshrrev_b32 v24, 16, v24
    v_mul_u32_u24 v24, 9, v24
    v_sub_u32_e64 v23, v23, v24
    v_lshl_add_u32 v23, v23, 7, v21
    s_waitcnt vmcnt(1)
    buffer_load_dword v68, v23, s[64:67], 0 offen
    s_waitcnt vmcnt(0)
    v_readfirstlane_b32 s55, v62
    s_nop 0
    s_mul_i32 s55, s55, 1664525
    s_add_u32 s55, s55, 1013904223
    s_max_u32 s55, s55, 1
    s_cmp_lg_u32 s62, 3
    s_cbranch_scc1 L_pollT_skip
    s_mov_b32 s58, 1000000
L_pollT:
    s_sleep 2
    global_load_dword v18, v15, s[46:47] sc1
    s_sub_u32 s58, s58, 1
    s_waitcnt vmcnt(0)
    s_cbranch_scc1 L_pollT_done
    v_cmp_ne_u32 vcc, s55, v18
    s_nop 1
    s_cbranch_vccnz L_pollT
L_pollT_done:
    s_mov_b32 m0, 52736
    s_add_u32 s4, s12, 8192
    buffer_load_dwordx4 v16, s[76:79], s4 offen offset:0 sc1 lds
    buffer_load_dwordx4 v16, s[76:79], s4 offen offset:1024 sc1 lds
    buffer_load_dwordx4 v16, s[76:79], s4 offen offset:2048 sc1 lds
    buffer_load_dwordx4 v16, s[76:79], s4 offen offset:3072 sc1 lds
    s_mov_b32 m0, 61440
    s_add_u32 s4, s12, 12288
    buffer_load_dwordx4 v16, s[76:79], s4 offen offset:0 sc1 lds
    buffer_load_dwordx4 v16, s[76:79], s4 offen offset:1024 sc1 lds
    buffer_load_dwordx4 v16, s[76:79], s4 offen offset:2048 sc1 lds
    buffer_load_dwordx4 v16, s[76:79], s4 offen offset:3072 sc1 lds
    s_mov_b32 m0, 35328
    s_add_u32 s4, s12, 0
    s_nop 0
    buffer_load_dwordx4 v16, s[76:79], s4 offen offset:0 sc1 lds
    buffer_load_dwordx4 v16, s[76:79], s4 offen offset:1024 sc1 lds
    buffer_load_dwordx4 v16, s[76:79], s4 offen offset:2048 sc1 lds
    buffer_load_dwordx4 v16, s[76:79], s4 offen offset:3072 sc1 lds
    s_mov_b32 m0, 44032
    s_add_u32 s4, s12, 4096
    buffer_load_dwordx4 v16, s[76:79], s4 offen offset:0 sc1 lds
    buffer_load_dwordx4 v16, s[76:79], s4 offen offset:1024 sc1 lds
    buffer_load_dwordx4 v16, s[76:79], s4 offen offset:2048 sc1 lds
    buffer_load_dwordx4 v16, s[76:79], s4 offen offset:3072 sc1 lds
    s_cmp_lt_u32 s49, 24
    s_cbranch_scc1 L_u4
    s_mov_b32 m0, 70144
    s_add_u32 s4, s12, 16384
    buffer_load_dwordx4 v16, s[76:79], s4 offen offset:0 sc1 lds
    buffer_load_dwordx4 v16, s[76:79], s4 offen offset:1024 sc1 lds
    buffer_load_dwordx4 v16, s[76:79], s4 offen offset:2048 sc1 lds
    buffer_load_dwordx4 v16, s[76:79], s4 offen offset:3072 sc1 lds
    s_mov_b32 m0, 78848
    s_add_u32 s4, s12, 20480
    buffer_load_dwordx4 v16, s[76:79], s4 offen offset:0 sc1 lds
    buffer_load_dwordx4 v16, s[76:79], s4 offen offset:1024 sc1 lds
    buffer_load_dwordx4 v16, s[76:79], s4 offen offset:2048 sc1 lds
    buffer_load_dwordx4 v16, s[76:79], s4 offen offset:3072 sc1 lds
    ds_write_b32 v10, v60 offset:4
    s_waitcnt vmcnt(8)
    ds_write_b32 v10, v60
    s_waitcnt vmcnt(0)
    v_mov_b32 v18, 149556
    ds_write_b32 v18, v60
L_u4:
    ds_write_b32 v10, v60 offset:4
    s_waitcnt vmcnt(0)
L_pollT_skip:
    ds_write_b32 v10, v60
    s_mov_b32 s58, 1000000
L_pollTw:
    s_sleep 2
    ds_read_b32 v18, v19 offset:4
    s_sub_u32 s58, s58, 1
    s_waitcnt lgkmcnt(0)
    s_cbranch_scc1 L_pollTw_done
    v_cmp_ne_u32 vcc, 1, v18
    s_nop 1
    s_cbranch_vccnz L_pollTw
L_pollTw_done:
    s_cmp_lt_u32 s49, 24
    s_cbranch_scc1 L_R2C
    s_sub_u32 s4, s49, 24
    s_lshl_b32 s4, s4, 2
    s_add_u32 s4, s4, s62
    s_mul_i32 s4, s4, 18
    v_mul_u32_u24 v20, 3641, v1
    v_lshrrev_b32 v20, 16, v20
    v_mul_u32_u24 v21, 18, v20
    v_sub_u32 v21, v1, v21
    v_add_u32 v21, s4, v21
    v_mul_u32_u24 v25, 683, v21
    v_lshrrev_b32 v25, 16, v25
    v_mul_u32_u24 v25, 3, v25
    v_lshrrev_b32 v25, 1, v25
    s_mul_i32 s4, s50, 3
    v_add_u32 v25, s4, v25
    v_lshlrev_b32 v20, 2, v20
    v_mul_u32_u24 v21, 1152, v21
    s_mov_b32 s64, s32
    s_mov_b32 s65, s33
    s_mov_b32 s68, s34
    s_mov_b32 s69, s35
    s_mov_b32 s4, 34934
    v_bfe_u32 v23, s4, v20, 4
    v_add_u32_e64 v23, v23, v25
    v_mul_u32_u24 v24, 7282, v23
    v_lshrrev_b32 v24, 16, v24
    v_mul_u32_u24 v24, 9, v24
    v_sub_u32_e64 v23, v23, v24
    v_lshl_add_u32 v23, v23, 7, v21
    buffer_load_dword v69, v23, s[64:67], 0 offen
    s_mov_b32 s4, 34934
    v_bfe_u32 v23, s4, v20, 4
    v_add_u32_e64 v23, v23, v25
    v_mul_u32_u24 v24, 7282, v23
    v_lshrrev_b32 v24, 16, v24
    v_mul_u32_u24 v24, 9, v24
    v_sub_u32_e64 v23, v23, v24
    v_lshl_add_u32 v23, v23, 7, v21
    buffer_load_dword v70, v23, s[68:71], 0 offen
    s_sub_u32 s4, s49, 24
    s_lshl_b32 s4, s4, 2
    s_add_u32 s4, s4, s62
    s_mul_i32 s4, s4, 18432
    s_add_u32 s4, s4, s14
    v_min_u32_e64 v58, 47, v1
    v_lshl_add_u32 v58, v58, 7, s4
    s_waitcnt vmcnt(1)
    global_load_dword v80, v58, s[42:43]
    v_add_u32 v58, 6144, v58
    s_waitcnt vmcnt(1)
    global_load_dword v81, v58, s[42:43]
    v_add_u32 v58, 6144, v58
    s_waitcnt vmcnt(1)
    global_load_dword v82, v58, s[42:43]
    v_add_u32 v58, 6144, v58
    s_cmp_lt_u32 s49, 24
    s_cbranch_scc1 L_R2C
    s_waitcnt vmcnt(0)
    s_endpgm
L_R2C:
    s_cmp_ge_u32 s49, 12
    s_mov_b32 s4, 3393292320
    s_mov_b32 s5, 155585890
    s_cmov_b32 s4, 899438227
    s_cmov_b32 s5, 250833482
    s_cselect_b32 s52, 12, 0
    s_sub_u32 s52, s49, s52
    s_mul_i32 s52, s52, 5
    s_lshr_b64 s[4:5], s[4:5], s52
    s_and_b32 s52, s4, 7
    s_bfe_u32 s4, s4, 0x20003
    s_and_b32 s51, s4, 1
    s_lshl_b32 s56, s50, 2
    s_add_u32 s56, s56, s4
    s_mul_i32 s57, s52, 3
    s_lshr_b32 s57, s57, 1
    s_mul_i32 s4, s4, 0
    s_add_u32 s57, s57, s4
    s_mul_i32 s4, s50, 3
    s_add_u32 s57, s57, s4
    s_mul_hi_u32 s4, s57, 0x1C71C71D
    s_mul_i32 s4, s4, 9
    s_sub_u32 s57, s57, s4
    s_lshl_b32 s57, s57, 7
    s_mov_b32 s74, 663552
    s_mov_b32 s75, 0x20000
    s_mul_i32 s61, s62, 12288
    s_add_u32 s61, s61, 100352
    s_cmp_lt_u32 s62, 2
    s_cselect_b32 s72, s32, s34
    s_cselect_b32 s73, s33, s35
    s_mov_b32 s33, s57
    s_mul_i32 s4, s52, 96
    s_and_b32 s5, s62, 1
    s_mul_i32 s5, s5, 48
    s_add_u32 s4, s4, s5
    s_mul_i32 s4, s4, 1152
    v_add_u32 v6, s4, v6
    v_xor_b32 v7, 64, v6
    v_add_u32 v7, 8192, v7
    v_lshrrev_b32 v4, 1, v2
    v_xor_b32 v4, v4, v3
    v_lshlrev_b32_e64 v4, 4, v4
    v_lshl_add_u32 v4, v2, 7, v4
    v_add_u32 v4, s61, v4
    v_xor_b32 v5, 64, v4
    s_add_u32 s34, s33, 128
    s_cmp_eq_u32 s34, 1152
    s_cselect_b32 s34, 0, s34
    s_add_u32 s35, s34, 128
    s_cmp_eq_u32 s35, 1152
    s_cselect_b32 s35, 0, s35
    s_add_u32 s36, s35, 128
    s_cmp_eq_u32 s36, 1152
    s_cselect_b32 s36, 0, s36
    s_add_u32 s37, s36, 128
    s_cmp_eq_u32 s37, 1152
    s_cselect_b32 s37, 0, s37
    s_add_u32 s40, s37, 128
    s_cmp_eq_u32 s40, 1152
    s_cselect_b32 s40, 0, s40
    s_add_u32 s41, s40, 128
    s_cmp_eq_u32 s41, 1152
    s_cselect_b32 s41, 0, s41
    s_add_u32 s44, s41, 128
    s_cmp_eq_u32 s44, 1152
    s_cselect_b32 s44, 0, s44
    s_add_u32 s45, s44, 128
    s_cmp_eq_u32 s45, 1152
    s_cselect_b32 s45, 0, s45
    s_add_u32 m0, s61, 0
    s_add_u32 s20, s33, 0
    buffer_load_dwordx4 v6, s[72:75], s20 offen lds
    buffer_load_dwordx4 v7, s[72:75], s20 offen offset:1024 lds
    s_add_u32 m0, s61, 2048
    s_add_u32 s20, s33, 18432
    buffer_load_dwordx4 v6, s[72:75], s20 offen lds
    buffer_load_dwordx4 v7, s[72:75], s20 offen offset:1024 lds
    s_add_u32 m0, s61, 4096
    s_add_u32 s20, s33, 36864
    buffer_load_dwordx4 v6, s[72:75], s20 offen lds
    buffer_load_dwordx4 v7, s[72:75], s20 offen offset:1024 lds
    s_add_u32 m0, s61, 6144
    s_add_u32 s20, s34, 0
    s_nop 0
    buffer_load_dwordx4 v6, s[72:75], s20 offen lds
    buffer_load_dwordx4 v7, s[72:75], s20 offen offset:1024 lds
    s_add_u32 m0, s61, 8192
    s_add_u32 s20, s34, 18432
    buffer_load_dwordx4 v6, s[72:75], s20 offen lds
    buffer_load_dwordx4 v7, s[72:75], s20 offen offset:1024 lds
    s_waitcnt vmcnt(8)
    s_nop 0
    ds_read_b128 v[88:91], v4 offset:0
    ds_read_b128 v[100:103], v5 offset:0
    s_add_u32 m0, s61, 10240
    s_add_u32 s20, s34, 36864
    buffer_load_dwordx4 v6, s[72:75], s20 offen lds
    buffer_load_dwordx4 v7, s[72:75], s20 offen offset:1024 lds
    s_waitcnt vmcnt(8)
    ds_read_b128 v[92:95], v4 offset:2048
    ds_read_b128 v[104:107], v5 offset:2048
    s_waitcnt lgkmcnt(2)
    s_add_u32 m0, s61, 0
    s_add_u32 s20, s35, 0
    buffer_load_dwordx4 v6, s[72:75], s20 offen lds
    buffer_load_dwordx4 v7, s[72:75], s20 offen offset:1024 lds
    s_waitcnt vmcnt(8)
    ds_read_b128 v[96:99], v4 offset:4096
    ds_read_b128 v[108:111], v5 offset:4096
    s_waitcnt lgkmcnt(2)
    s_add_u32 m0, s61, 2048
    s_add_u32 s20, s35, 18432
    buffer_load_dwordx4 v6, s[72:75], s20 offen lds
    buffer_load_dwordx4 v7, s[72:75], s20 offen offset:1024 lds
    s_waitcnt vmcnt(8)
    ds_read_b128 v[112:115], v4 offset:6144
    ds_read_b128 v[124:127], v5 offset:6144
    s_waitcnt lgkmcnt(2)
    s_add_u32 m0, s61, 4096
    s_add_u32 s20, s35, 36864
    buffer_load_dwordx4 v6, s[72:75], s20 offen lds
    buffer_load_dwordx4 v7, s[72:75], s20 offen offset:1024 lds
    s_waitcnt vmcnt(8)
    ds_read_b128 v[116:119], v4 offset:8192
    ds_read_b128 v[128:131], v5 offset:8192
    s_waitcnt lgkmcnt(2)
    s_add_u32 m0, s61, 6144
    s_add_u32 s20, s36, 0
    buffer_load_dwordx4 v6, s[72:75], s20 offen lds
    buffer_load_dwordx4 v7, s[72:75], s20 offen offset:1024 lds
    s_waitcnt vmcnt(8)
    ds_read_b128 v[120:123], v4 offset:10240
    ds_read_b128 v[132:135], v5 offset:10240
    s_waitcnt lgkmcnt(2)
    s_add_u32 m0, s61, 8192
    s_add_u32 s20, s36, 18432
    buffer_load_dwordx4 v6, s[72:75], s20 offen lds
    buffer_load_dwordx4 v7, s[72:75], s20 offen offset:1024 lds
    s_waitcnt vmcnt(8)
    ds_read_b128 v[136:139], v4 offset:0
    ds_read_b128 v[148:151], v5 offset:0
    s_waitcnt lgkmcnt(2)
    s_add_u32 m0, s61, 10240
    s_add_u32 s20, s36, 36864
    buffer_load_dwordx4 v6, s[72:75], s20 offen lds
    buffer_load_dwordx4 v7, s[72:75], s20 offen offset:1024 lds
    s_waitcnt vmcnt(8)
    ds_read_b128 v[140:143], v4 offset:2048
    ds_read_b128 v[152:155], v5 offset:2048
    s_waitcnt lgkmcnt(2)
    s_add_u32 m0, s61, 0
    s_add_u32 s20, s37, 0
    buffer_load_dwordx4 v6, s[72:75], s20 offen lds
    buffer_load_dwordx4 v7, s[72:75], s20 offen offset:1024 lds
    s_waitcnt vmcnt(8)
    ds_read_b128 v[144:147], v4 offset:4096
    ds_read_b128 v[156:159], v5 offset:4096
    s_waitcnt lgkmcnt(2)
    s_add_u32 m0, s61, 2048
    s_add_u32 s20, s37, 18432
    buffer_load_dwordx4 v6, s[72:75], s20 offen lds
    buffer_load_dwordx4 v7, s[72:75], s20 offen offset:1024 lds
    s_waitcnt vmcnt(8)
    ds_read_b128 v[160:163], v4 offset:6144
    ds_read_b128 v[172:175], v5 offset:6144
    s_waitcnt lgkmcnt(2)
    s_add_u32 m0, s61, 4096
    s_add_u32 s20, s37, 36864
    buffer_load_dwordx4 v6, s[72:75], s20 offen lds
    buffer_load_dwordx4 v7, s[72:75], s20 offen offset:1024 lds
    s_waitcnt vmcnt(8)
    ds_read_b128 v[164:167], v4 offset:8192
    ds_read_b128 v[176:179], v5 offset:8192
    s_waitcnt lgkmcnt(2)
    s_add_u32 m0, s61, 6144
    s_add_u32 s20, s40, 0
    buffer_load_dwordx4 v6, s[72:75], s20 offen lds
    buffer_load_dwordx4 v7, s[72:75], s20 offen offset:1024 lds
    s_waitcnt vmcnt(8)
    ds_read_b128 v[168:171], v4 offset:10240
    ds_read_b128 v[180:183], v5 offset:10240
    s_waitcnt lgkmcnt(2)
    s_add_u32 m0, s61, 8192
    s_add_u32 s20, s40, 18432
    buffer_load_dwordx4 v6, s[72:75], s20 offen lds
    buffer_load_dwordx4 v7, s[72:75], s20 offen offset:1024 lds
    s_waitcnt vmcnt(8)
    ds_read_b128 v[184:187], v4 offset:0
    ds_read_b128 v[196:199], v5 offset:0
    s_waitcnt lgkmcnt(2)
    s_add_u32 m0, s61, 10240
    s_add_u32 s20, s40, 36864
    buffer_load_dwordx4 v6, s[72:75], s20 offen lds
    buffer_load_dwordx4 v7, s[72:75], s20 offen offset:1024 lds
    s_waitcnt vmcnt(8)
    ds_read_b128 v[188:191], v4 offset:2048
    ds_read_b128 v[200:203], v5 offset:2048
    s_waitcnt lgkmcnt(2)
    s_add_u32 m0, s61, 0
    s_add_u32 s20, s41, 0
    buffer_load_dwordx4 v6, s[72:75], s20 offen lds
    buffer_load_dwordx4 v7, s[72:75], s20 offen offset:1024 lds
    s_waitcnt vmcnt(8)
    ds_read_b128 v[192:195], v4 offset:4096
    ds_read_b128 v[204:207], v5 offset:4096
    s_waitcnt lgkmcnt(2)
    s_add_u32 m0, s61, 2048
    s_add_u32 s20, s41, 18432
    buffer_load_dwordx4 v6, s[72:75], s20 offen lds
    buffer_load_dwordx4 v7, s[72:75], s20 offen offset:1024 lds
    s_waitcnt vmcnt(8)
    ds_read_b128 v[208:211], v4 offset:6144
    ds_read_b128 v[220:223], v5 offset:6144
    s_waitcnt lgkmcnt(2)
    s_add_u32 m0, s61, 4096
    s_add_u32 s20, s41, 36864
    buffer_load_dwordx4 v6, s[72:75], s20 offen lds
    buffer_load_dwordx4 v7, s[72:75], s20 offen offset:1024 lds
    s_waitcnt vmcnt(8)
    ds_read_b128 v[212:215], v4 offset:8192
    ds_read_b128 v[224:227], v5 offset:8192
    s_waitcnt lgkmcnt(2)
    s_add_u32 m0, s61, 6144
    s_add_u32 s20, s44, 0
    buffer_load_dwordx4 v6, s[72:75], s20 offen lds
    buffer_load_dwordx4 v7, s[72:75], s20 offen offset:1024 lds
    s_waitcnt vmcnt(8)
    ds_read_b128 v[216:219], v4 offset:10240
    ds_read_b128 v[228:231], v5 offset:10240
    s_waitcnt lgkmcnt(2)
    s_add_u32 m0, s61, 8192
    s_add_u32 s20, s44, 18432
    buffer_load_dwordx4 v6, s[72:75], s20 offen lds
    buffer_load_dwordx4 v7, s[72:75], s20 offen offset:1024 lds
    s_waitcnt vmcnt(8)
    ds_read_b128 v[232:235], v4 offset:0
    ds_read_b128 v[244:247], v5 offset:0
    s_waitcnt lgkmcnt(2)
    s_add_u32 m0, s61, 10240
    s_add_u32 s20, s44, 36864
    buffer_load_dwordx4 v6, s[72:75], s20 offen lds
    buffer_load_dwordx4 v7, s[72:75], s20 offen offset:1024 lds
    s_waitcnt vmcnt(8)
    ds_read_b128 v[236:239], v4 offset:2048
    ds_read_b128 v[248:251], v5 offset:2048
    s_waitcnt lgkmcnt(2)
    s_add_u32 m0, s61, 0
    s_add_u32 s20, s45, 0
    buffer_load_dwordx4 v6, s[72:75], s20 offen lds
    buffer_load_dwordx4 v7, s[72:75], s20 offen offset:1024 lds
    s_waitcnt vmcnt(8)
    ds_read_b128 v[240:243], v4 offset:4096
    ds_read_b128 v[252:255], v5 offset:4096
    s_waitcnt lgkmcnt(2)
    s_add_u32 m0, s61, 2048
    s_add_u32 s20, s45, 18432
    buffer_load_dwordx4 v6, s[72:75], s20 offen lds
    buffer_load_dwordx4 v7, s[72:75], s20 offen offset:1024 lds
    s_waitcnt lgkmcnt(0)
    s_add_u32 m0, s61, 4096
    s_add_u32 s20, s45, 36864
    buffer_load_dwordx4 v6, s[72:75], s20 offen lds
    buffer_load_dwordx4 v7, s[72:75], s20 offen offset:1024 lds
L_CPF:
    v_lshrrev_b32 v8, 1, v3
    v_lshlrev_b32 v8, 12, v8
    s_lshr_b32 s4, s62, 1
    s_lshl_b32 s5, s4, 10
    v_add_u32_e64 v8, s5, v8
    v_bfe_u32 v9, v1, 1, 1
    v_lshl_add_u32 v8, v9, 8, v8
    v_and_b32 v10, 1, v3
    v_lshlrev_b32 v10, 3, v10
    v_bfe_u32 v11, v1, 2, 2
    v_add_u32 v10, v10, v11
    v_lshlrev_b32 v9, 2, v9
    v_xor_b32_e64 v10, v10, v9
    v_lshl_add_u32 v8, v10, 4, v8
    v_and_b32_e64 v10, 1, v1
    v_lshl_add_u32 v6, v10, 3, v8
    v_xor_b32_e64 v7, 64, v6
    s_mul_i32 s4, s4, 25600
    s_and_b32 s5, s62, 1
    s_mul_i32 s5, s5, 192
    s_add_u32 s4, s4, s5
    s_add_u32 s4, s4, 98304
    v_mul_u32_u24 v0, 400, v2
    v_lshl_add_u32 v0, v3, 4, v0
    v_add_u32_e64 v0, s4, v0
    v_add_u32 v2, 49152, v6
    v_add_u32 v3, 49152, v7
    s_waitcnt lgkmcnt(0)
    s_barrier
    ds_read_b64_tr_b16 v[8:9], v6 offset:0
    ds_read_b64_tr_b16 v[10:11], v7 offset:0
    ds_read_b64_tr_b16 v[12:13], v6 offset:512
    ds_read_b64_tr_b16 v[14:15], v7 offset:512
    ds_read_b64_tr_b16 v[16:17], v6 offset:2048
    ds_read_b64_tr_b16 v[18:19], v7 offset:2048
    ds_read_b64_tr_b16 v[20:21], v6 offset:2560
    ds_read_b64_tr_b16 v[22:23], v7 offset:2560
    ds_read_b64_tr_b16 v[24:25], v6 offset:8192
    s_waitcnt lgkmcnt(7)
    v_mfma_f32_16x16x32_bf16 v[40:43], v[88:91], v[8:11], 0
    ds_read_b64_tr_b16 v[26:27], v7 offset:8192
    v_mfma_f32_16x16x32_bf16 v[56:59], v[92:95], v[8:11], 0
    ds_read_b64_tr_b16 v[28:29], v6 offset:8704
    v_mfma_f32_16x16x32_bf16 v[72:75], v[96:99], v[8:11], 0
    ds_read_b64_tr_b16 v[30:31], v7 offset:8704
    s_waitcnt lgkmcnt(8)
    v_mfma_f32_16x16x32_bf16 v[44:47], v[88:91], v[12:15], 0
    ds_read_b64_tr_b16 v[32:33], v6 offset:10240
    v_mfma_f32_16x16x32_bf16 v[60:63], v[92:95], v[12:15], 0
    ds_read_b64_tr_b16 v[34:35], v7 offset:10240
    v_mfma_f32_16x16x32_bf16 v[76:79], v[96:99], v[12:15], 0
    ds_read_b64_tr_b16 v[36:37], v6 offset:10752
    s_waitcnt lgkmcnt(9)
    v_mfma_f32_16x16x32_bf16 v[48:51], v[88:91], v[16:19], 0
    ds_read_b64_tr_b16 v[38:39], v7 offset:10752
    v_mfma_f32_16x16x32_bf16 v[64:67], v[92:95], v[16:19], 0
    v_mfma_f32_16x16x32_bf16 v[80:83], v[96:99], v[16:19], 0
    s_waitcnt lgkmcnt(8)
    v_mfma_f32_16x16x32_bf16 v[52:55], v[88:91], v[20:23], 0
    v_mfma_f32_16x16x32_bf16 v[68:71], v[92:95], v[20:23], 0
    v_mfma_f32_16x16x32_bf16 v[84:87], v[96:99], v[20:23], 0
    s_waitcnt lgkmcnt(0)
    s_barrier
    v_mfma_f32_16x16x32_bf16 v[40:43], v[100:103], v[24:27], v[40:43]
    ds_read_b64_tr_b16 v[8:9], v6 offset:16384
    v_mfma_f32_16x16x32_bf16 v[56:59], v[104:107], v[24:27], v[56:59]
    ds_read_b64_tr_b16 v[10:11], v7 offset:16384
    v_mfma_f32_16x16x32_bf16 v[72:75], v[108:111], v[24:27], v[72:75]
    ds_read_b64_tr_b16 v[12:13], v6 offset:16896
    v_mfma_f32_16x16x32_bf16 v[44:47], v[100:103], v[28:31], v[44:47]
    ds_read_b64_tr_b16 v[14:15], v7 offset:16896
    v_mfma_f32_16x16x32_bf16 v[60:63], v[104:107], v[28:31], v[60:63]
    ds_read_b64_tr_b16 v[16:17], v6 offset:18432
    v_mfma_f32_16x16x32_bf16 v[76:79], v[108:111], v[28:31], v[76:79]
    ds_read_b64_tr_b16 v[18:19], v7 offset:18432
    v_mfma_f32_16x16x32_bf16 v[48:51], v[100:103], v[32:35], v[48:51]
    ds_read_b64_tr_b16 v[20:21], v6 offset:18944
    v_mfma_f32_16x16x32_bf16 v[64:67], v[104:107], v[32:35], v[64:67]
    ds_read_b64_tr_b16 v[22:23], v7 offset:18944
    v_mfma_f32_16x16x32_bf16 v[80:83], v[108:111], v[32:35], v[80:83]
    v_mfma_f32_16x16x32_bf16 v[52:55], v[100:103], v[36:39], v[52:55]
    v_mfma_f32_16x16x32_bf16 v[68:71], v[104:107], v[36:39], v[68:71]
    v_mfma_f32_16x16x32_bf16 v[84:87], v[108:111], v[36:39], v[84:87]
    ds_read_b64_tr_b16 v[24:25], v6 offset:24576
    s_waitcnt lgkmcnt(7)
    v_mfma_f32_16x16x32_bf16 v[40:43], v[112:115], v[8:11], v[40:43]
    ds_read_b64_tr_b16 v[26:27], v7 offset:24576
    v_mfma_f32_16x16x32_bf16 v[56:59], v[116:119], v[8:11], v[56:59]
    ds_read_b64_tr_b16 v[28:29], v6 offset:25088
    v_mfma_f32_16x16x32_bf16 v[72:75], v[120:123], v[8:11], v[72:75]
    ds_read_b64_tr_b16 v[30:31], v7 offset:25088
    s_waitcnt lgkmcnt(8)
    v_mfma_f32_16x16x32_bf16 v[44:47], v[112:115], v[12:15], v[44:47]
    ds_read_b64_tr_b16 v[32:33], v6 offset:26624
    v_mfma_f32_16x16x32_bf16 v[60:63], v[116:119], v[12:15], v[60:63]
    ds_read_b64_tr_b16 v[34:35], v7 offset:26624
    v_mfma_f32_16x16x32_bf16 v[76:79], v[120:123], v[12:15], v[76:79]
    ds_read_b64_tr_b16 v[36:37], v6 offset:27136
    s_waitcnt lgkmcnt(9)
    v_mfma_f32_16x16x32_bf16 v[48:51], v[112:115], v[16:19], v[48:51]
    ds_read_b64_tr_b16 v[38:39], v7 offset:27136
    v_mfma_f32_16x16x32_bf16 v[64:67], v[116:119], v[16:19], v[64:67]
    v_mfma_f32_16x16x32_bf16 v[80:83], v[120:123], v[16:19], v[80:83]
    s_waitcnt lgkmcnt(8)
    v_mfma_f32_16x16x32_bf16 v[52:55], v[112:115], v[20:23], v[52:55]
    v_mfma_f32_16x16x32_bf16 v[68:71], v[116:119], v[20:23], v[68:71]
    v_mfma_f32_16x16x32_bf16 v[84:87], v[120:123], v[20:23], v[84:87]
    s_waitcnt lgkmcnt(0)
    s_barrier
    v_mfma_f32_16x16x32_bf16 v[40:43], v[124:127], v[24:27], v[40:43]
    ds_read_b64_tr_b16 v[8:9], v6 offset:32768
    v_mfma_f32_16x16x32_bf16 v[56:59], v[128:131], v[24:27], v[56:59]
    ds_read_b64_tr_b16 v[10:11], v7 offset:32768
    v_mfma_f32_16x16x32_bf16 v[72:75], v[132:135], v[24:27], v[72:75]
    ds_read_b64_tr_b16 v[12:13], v6 offset:33280
    v_mfma_f32_16x16x32_bf16 v[44:47], v[124:127], v[28:31], v[44:47]
    ds_read_b64_tr_b16 v[14:15], v7 offset:33280
    v_mfma_f32_16x16x32_bf16 v[60:63], v[128:131], v[28:31], v[60:63]
    ds_read_b64_tr_b16 v[16:17], v6 offset:34816
    v_mfma_f32_16x16x32_bf16 v[76:79], v[132:135], v[28:31], v[76:79]
    ds_read_b64_tr_b16 v[18:19], v7 offset:34816
    v_mfma_f32_16x16x32_bf16 v[48:51], v[124:127], v[32:35], v[48:51]
    ds_read_b64_tr_b16 v[20:21], v6 offset:35328
    v_mfma_f32_16x16x32_bf16 v[64:67], v[128:131], v[32:35], v[64:67]
    ds_read_b64_tr_b16 v[22:23], v7 offset:35328
    v_mfma_f32_16x16x32_bf16 v[80:83], v[132:135], v[32:35], v[80:83]
    v_mfma_f32_16x16x32_bf16 v[52:55], v[124:127], v[36:39], v[52:55]
    v_mfma_f32_16x16x32_bf16 v[68:71], v[128:131], v[36:39], v[68:71]
    v_mfma_f32_16x16x32_bf16 v[84:87], v[132:135], v[36:39], v[84:87]
    ds_read_b64_tr_b16 v[24:25], v6 offset:40960
    s_waitcnt lgkmcnt(7)
    v_mfma_f32_16x16x32_bf16 v[40:43], v[136:139], v[8:11], v[40:43]
    ds_read_b64_tr_b16 v[26:27], v7 offset:40960
    v_mfma_f32_16x16x32_bf16 v[56:59], v[140:143], v[8:11], v[56:59]
    ds_read_b64_tr_b16 v[28:29], v6 offset:41472
    v_mfma_f32_16x16x32_bf16 v[72:75], v[144:147], v[8:11], v[72:75]
    ds_read_b64_tr_b16 v[30:31], v7 offset:41472
    s_waitcnt lgkmcnt(8)
    v_mfma_f32_16x16x32_bf16 v[44:47], v[136:139], v[12:15], v[44:47]
    ds_read_b64_tr_b16 v[32:33], v6 offset:43008
    s_waitcnt vmcnt(0)
    ds_read_b128 v[88:91], v4 offset:6144
    v_mfma_f32_16x16x32_bf16 v[60:63], v[140:143], v[12:15], v[60:63]
    ds_read_b64_tr_b16 v[34:35], v7 offset:43008
    ds_read_b128 v[100:103], v5 offset:6144
    v_mfma_f32_16x16x32_bf16 v[76:79], v[144:147], v[12:15], v[76:79]
    ds_read_b64_tr_b16 v[36:37], v6 offset:43520
    ds_read_b128 v[92:95], v4 offset:8192
    s_waitcnt lgkmcnt(12)
    v_mfma_f32_16x16x32_bf16 v[48:51], v[136:139], v[16:19], v[48:51]
    ds_read_b64_tr_b16 v[38:39], v7 offset:43520
    ds_read_b128 v[104:107], v5 offset:8192
    v_mfma_f32_16x16x32_bf16 v[64:67], v[140:143], v[16:19], v[64:67]
    ds_read_b128 v[96:99], v4 offset:10240
    v_mfma_f32_16x16x32_bf16 v[80:83], v[144:147], v[16:19], v[80:83]
    ds_read_b128 v[108:111], v5 offset:10240
    s_waitcnt lgkmcnt(14)
    v_mfma_f32_16x16x32_bf16 v[52:55], v[136:139], v[20:23], v[52:55]
    v_mfma_f32_16x16x32_bf16 v[68:71], v[140:143], v[20:23], v[68:71]
    v_mfma_f32_16x16x32_bf16 v[84:87], v[144:147], v[20:23], v[84:87]
    s_waitcnt lgkmcnt(0)
    s_barrier
    v_mfma_f32_16x16x32_bf16 v[40:43], v[148:151], v[24:27], v[40:43]
    ds_read_b64_tr_b16 v[8:9], v2 offset:0
    v_mfma_f32_16x16x32_bf16 v[56:59], v[152:155], v[24:27], v[56:59]
    ds_read_b64_tr_b16 v[10:11], v3 offset:0
    v_mfma_f32_16x16x32_bf16 v[72:75], v[156:159], v[24:27], v[72:75]
    ds_read_b64_tr_b16 v[12:13], v2 offset:512
    v_mfma_f32_16x16x32_bf16 v[44:47], v[148:151], v[28:31], v[44:47]
    ds_read_b64_tr_b16 v[14:15], v3 offset:512
    v_mfma_f32_16x16x32_bf16 v[60:63], v[152:155], v[28:31], v[60:63]
    ds_read_b64_tr_b16 v[16:17], v2 offset:2048
    v_mfma_f32_16x16x32_bf16 v[76:79], v[156:159], v[28:31], v[76:79]
    ds_read_b64_tr_b16 v[18:19], v3 offset:2048
    v_mfma_f32_16x16x32_bf16 v[48:51], v[148:151], v[32:35], v[48:51]
    ds_read_b64_tr_b16 v[20:21], v2 offset:2560
    v_mfma_f32_16x16x32_bf16 v[64:67], v[152:155], v[32:35], v[64:67]
    ds_read_b64_tr_b16 v[22:23], v3 offset:2560
    v_mfma_f32_16x16x32_bf16 v[80:83], v[156:159], v[32:35], v[80:83]
    v_mfma_f32_16x16x32_bf16 v[52:55], v[148:151], v[36:39], v[52:55]
    v_mfma_f32_16x16x32_bf16 v[68:71], v[152:155], v[36:39], v[68:71]
    v_mfma_f32_16x16x32_bf16 v[84:87], v[156:159], v[36:39], v[84:87]
    ds_read_b64_tr_b16 v[24:25], v2 offset:8192
    s_waitcnt lgkmcnt(7)
    v_mfma_f32_16x16x32_bf16 v[40:43], v[160:163], v[8:11], v[40:43]
    ds_read_b64_tr_b16 v[26:27], v3 offset:8192
    v_mfma_f32_16x16x32_bf16 v[56:59], v[164:167], v[8:11], v[56:59]
    ds_read_b64_tr_b16 v[28:29], v2 offset:8704
    v_mfma_f32_16x16x32_bf16 v[72:75], v[168:171], v[8:11], v[72:75]
    ds_read_b64_tr_b16 v[30:31], v3 offset:8704
    s_waitcnt lgkmcnt(8)
    v_mfma_f32_16x16x32_bf16 v[44:47], v[160:163], v[12:15], v[44:47]
    ds_read_b64_tr_b16 v[32:33], v2 offset:10240
    ds_read_b128 v[112:115], v4 offset:0
    v_mfma_f32_16x16x32_bf16 v[60:63], v[164:167], v[12:15], v[60:63]
    ds_read_b64_tr_b16 v[34:35], v3 offset:10240
    ds_read_b128 v[124:127], v5 offset:0
    v_mfma_f32_16x16x32_bf16 v[76:79], v[168:171], v[12:15], v[76:79]
    ds_read_b64_tr_b16 v[36:37], v2 offset:10752
    ds_read_b128 v[116:119], v4 offset:2048
    s_waitcnt lgkmcnt(12)
    v_mfma_f32_16x16x32_bf16 v[48:51], v[160:163], v[16:19], v[48:51]
    ds_read_b64_tr_b16 v[38:39], v3 offset:10752
    ds_read_b128 v[128:131], v5 offset:2048
    v_mfma_f32_16x16x32_bf16 v[64:67], v[164:167], v[16:19], v[64:67]
    ds_read_b128 v[120:123], v4 offset:4096
    v_mfma_f32_16x16x32_bf16 v[80:83], v[168:171], v[16:19], v[80:83]
    ds_read_b128 v[132:135], v5 offset:4096
    s_waitcnt lgkmcnt(14)
    v_mfma_f32_16x16x32_bf16 v[52:55], v[160:163], v[20:23], v[52:55]
    v_mfma_f32_16x16x32_bf16 v[68:71], v[164:167], v[20:23], v[68:71]
    v_mfma_f32_16x16x32_bf16 v[84:87], v[168:171], v[20:23], v[84:87]
    s_waitcnt lgkmcnt(0)
    s_barrier
    v_mfma_f32_16x16x32_bf16 v[40:43], v[172:175], v[24:27], v[40:43]
    ds_read_b64_tr_b16 v[8:9], v2 offset:16384
    v_mfma_f32_16x16x32_bf16 v[56:59], v[176:179], v[24:27], v[56:59]
    ds_read_b64_tr_b16 v[10:11], v3 offset:16384
    v_mfma_f32_16x16x32_bf16 v[72:75], v[180:183], v[24:27], v[72:75]
    ds_read_b64_tr_b16 v[12:13], v2 offset:16896
    v_mfma_f32_16x16x32_bf16 v[44:47], v[172:175], v[28:31], v[44:47]
    ds_read_b64_tr_b16 v[14:15], v3 offset:16896
    v_mfma_f32_16x16x32_bf16 v[60:63], v[176:179], v[28:31], v[60:63]
    ds_read_b64_tr_b16 v[16:17], v2 offset:18432
    v_mfma_f32_16x16x32_bf16 v[76:79], v[180:183], v[28:31], v[76:79]
    ds_read_b64_tr_b16 v[18:19], v3 offset:18432
    v_mfma_f32_16x16x32_bf16 v[48:51], v[172:175], v[32:35], v[48:51]
    ds_read_b64_tr_b16 v[20:21], v2 offset:18944
    v_mfma_f32_16x16x32_bf16 v[64:67], v[176:179], v[32:35], v[64:67]
    ds_read_b64_tr_b16 v[22:23], v3 offset:18944
    v_mfma_f32_16x16x32_bf16 v[80:83], v[180:183], v[32:35], v[80:83]
    v_mfma_f32_16x16x32_bf16 v[52:55], v[172:175], v[36:39], v[52:55]
    v_mfma_f32_16x16x32_bf16 v[68:71], v[176:179], v[36:39], v[68:71]
    v_mfma_f32_16x16x32_bf16 v[84:87], v[180:183], v[36:39], v[84:87]
    ds_read_b64_tr_b16 v[24:25], v2 offset:24576
    s_waitcnt lgkmcnt(7)
    v_mfma_f32_16x16x32_bf16 v[40:43], v[184:187], v[8:11], v[40:43]
    ds_read_b64_tr_b16 v[26:27], v3 offset:24576
    v_mfma_f32_16x16x32_bf16 v[56:59], v[188:191], v[8:11], v[56:59]
    ds_read_b64_tr_b16 v[28:29], v2 offset:25088
    v_mfma_f32_16x16x32_bf16 v[72:75], v[192:195], v[8:11], v[72:75]
    ds_read_b64_tr_b16 v[30:31], v3 offset:25088
    s_waitcnt lgkmcnt(8)
    v_mfma_f32_16x16x32_bf16 v[44:47], v[184:187], v[12:15], v[44:47]
    ds_read_b64_tr_b16 v[32:33], v2 offset:26624
    v_mfma_f32_16x16x32_bf16 v[60:63], v[188:191], v[12:15], v[60:63]
    ds_read_b64_tr_b16 v[34:35], v3 offset:26624
    v_mfma_f32_16x16x32_bf16 v[76:79], v[192:195], v[12:15], v[76:79]
    ds_read_b64_tr_b16 v[36:37], v2 offset:27136
    s_waitcnt lgkmcnt(9)
    v_mfma_f32_16x16x32_bf16 v[48:51], v[184:187], v[16:19], v[48:51]
    ds_read_b64_tr_b16 v[38:39], v3 offset:27136
    v_mfma_f32_16x16x32_bf16 v[64:67], v[188:191], v[16:19], v[64:67]
    v_mfma_f32_16x16x32_bf16 v[80:83], v[192:195], v[16:19], v[80:83]
    s_waitcnt lgkmcnt(8)
    v_mfma_f32_16x16x32_bf16 v[52:55], v[184:187], v[20:23], v[52:55]
    v_mfma_f32_16x16x32_bf16 v[68:71], v[188:191], v[20:23], v[68:71]
    v_mfma_f32_16x16x32_bf16 v[84:87], v[192:195], v[20:23], v[84:87]
    s_waitcnt lgkmcnt(6)
    v_mfma_f32_16x16x32_bf16 v[40:43], v[196:199], v[24:27], v[40:43]
    ds_read_b64_tr_b16 v[8:9], v2 offset:32768
    v_mfma_f32_16x16x32_bf16 v[56:59], v[200:203], v[24:27], v[56:59]
    ds_read_b64_tr_b16 v[10:11], v3 offset:32768
    v_mfma_f32_16x16x32_bf16 v[72:75], v[204:207], v[24:27], v[72:75]
    ds_read_b64_tr_b16 v[12:13], v2 offset:33280
    s_waitcnt lgkmcnt(7)
    v_mfma_f32_16x16x32_bf16 v[44:47], v[196:199], v[28:31], v[44:47]
    ds_read_b64_tr_b16 v[14:15], v3 offset:33280
    v_mfma_f32_16x16x32_bf16 v[60:63], v[200:203], v[28:31], v[60:63]
    ds_read_b64_tr_b16 v[16:17], v2 offset:34816
    v_mfma_f32_16x16x32_bf16 v[76:79], v[204:207], v[28:31], v[76:79]
    ds_read_b64_tr_b16 v[18:19], v3 offset:34816
    s_waitcnt lgkmcnt(8)
    v_mfma_f32_16x16x32_bf16 v[48:51], v[196:199], v[32:35], v[48:51]
    ds_read_b64_tr_b16 v[20:21], v2 offset:35328
    v_mfma_f32_16x16x32_bf16 v[64:67], v[200:203], v[32:35], v[64:67]
    ds_read_b64_tr_b16 v[22:23], v3 offset:35328
    v_mfma_f32_16x16x32_bf16 v[80:83], v[204:207], v[32:35], v[80:83]
    s_waitcnt lgkmcnt(8)
    v_mfma_f32_16x16x32_bf16 v[52:55], v[196:199], v[36:39], v[52:55]
    v_mfma_f32_16x16x32_bf16 v[68:71], v[200:203], v[36:39], v[68:71]
    v_mfma_f32_16x16x32_bf16 v[84:87], v[204:207], v[36:39], v[84:87]
    ds_read_b64_tr_b16 v[24:25], v2 offset:40960
    s_waitcnt lgkmcnt(7)
    v_mfma_f32_16x16x32_bf16 v[40:43], v[208:211], v[8:11], v[40:43]
    ds_read_b64_tr_b16 v[26:27], v3 offset:40960
    v_mfma_f32_16x16x32_bf16 v[56:59], v[212:215], v[8:11], v[56:59]
    ds_read_b64_tr_b16 v[28:29], v2 offset:41472
    v_mfma_f32_16x16x32_bf16 v[72:75], v[216:219], v[8:11], v[72:75]
    ds_read_b64_tr_b16 v[30:31], v3 offset:41472
    s_waitcnt lgkmcnt(8)
    v_mfma_f32_16x16x32_bf16 v[44:47], v[208:211], v[12:15], v[44:47]
    ds_read_b64_tr_b16 v[32:33], v2 offset:43008
    v_mfma_f32_16x16x32_bf16 v[60:63], v[212:215], v[12:15], v[60:63]
    ds_read_b64_tr_b16 v[34:35], v3 offset:43008
    v_mfma_f32_16x16x32_bf16 v[76:79], v[216:219], v[12:15], v[76:79]
    ds_read_b64_tr_b16 v[36:37], v2 offset:43520
    s_waitcnt lgkmcnt(9)
    v_mfma_f32_16x16x32_bf16 v[48:51], v[208:211], v[16:19], v[48:51]
    ds_read_b64_tr_b16 v[38:39], v3 offset:43520
    v_mfma_f32_16x16x32_bf16 v[64:67], v[212:215], v[16:19], v[64:67]
    v_mfma_f32_16x16x32_bf16 v[80:83], v[216:219], v[16:19], v[80:83]
    s_waitcnt lgkmcnt(8)
    v_mfma_f32_16x16x32_bf16 v[52:55], v[208:211], v[20:23], v[52:55]
    v_mfma_f32_16x16x32_bf16 v[68:71], v[212:215], v[20:23], v[68:71]
    v_mfma_f32_16x16x32_bf16 v[84:87], v[216:219], v[20:23], v[84:87]
    s_waitcnt lgkmcnt(0)
    s_barrier
    v_mfma_f32_16x16x32_bf16 v[40:43], v[220:223], v[24:27], v[40:43]
    ds_read_b64_tr_b16 v[8:9], v6 offset:0
    v_mfma_f32_16x16x32_bf16 v[56:59], v[224:227], v[24:27], v[56:59]
    ds_read_b64_tr_b16 v[10:11], v7 offset:0
    v_mfma_f32_16x16x32_bf16 v[72:75], v[228:231], v[24:27], v[72:75]
    ds_read_b64_tr_b16 v[12:13], v6 offset:512
    v_mfma_f32_16x16x32_bf16 v[44:47], v[220:223], v[28:31], v[44:47]
    ds_read_b64_tr_b16 v[14:15], v7 offset:512
    v_mfma_f32_16x16x32_bf16 v[60:63], v[224:227], v[28:31], v[60:63]
    ds_read_b64_tr_b16 v[16:17], v6 offset:2048
    v_mfma_f32_16x16x32_bf16 v[76:79], v[228:231], v[28:31], v[76:79]
    ds_read_b64_tr_b16 v[18:19], v7 offset:2048
    v_mfma_f32_16x16x32_bf16 v[48:51], v[220:223], v[32:35], v[48:51]
    ds_read_b64_tr_b16 v[20:21], v6 offset:2560
    v_mfma_f32_16x16x32_bf16 v[64:67], v[224:227], v[32:35], v[64:67]
    ds_read_b64_tr_b16 v[22:23], v7 offset:2560
    v_mfma_f32_16x16x32_bf16 v[80:83], v[228:231], v[32:35], v[80:83]
    v_mfma_f32_16x16x32_bf16 v[52:55], v[220:223], v[36:39], v[52:55]
    v_mfma_f32_16x16x32_bf16 v[68:71], v[224:227], v[36:39], v[68:71]
    v_mfma_f32_16x16x32_bf16 v[84:87], v[228:231], v[36:39], v[84:87]
    ds_read_b64_tr_b16 v[24:25], v6 offset:8192
    s_waitcnt lgkmcnt(7)
    v_mfma_f32_16x16x32_bf16 v[40:43], v[232:235], v[8:11], v[40:43]
    ds_read_b64_tr_b16 v[26:27], v7 offset:8192
    v_mfma_f32_16x16x32_bf16 v[56:59], v[236:239], v[8:11], v[56:59]
    ds_read_b64_tr_b16 v[28:29], v6 offset:8704
    v_mfma_f32_16x16x32_bf16 v[72:75], v[240:243], v[8:11], v[72:75]
    ds_read_b64_tr_b16 v[30:31], v7 offset:8704
    s_waitcnt lgkmcnt(8)
    v_mfma_f32_16x16x32_bf16 v[44:47], v[232:235], v[12:15], v[44:47]
    ds_read_b64_tr_b16 v[32:33], v6 offset:10240
    v_mfma_f32_16x16x32_bf16 v[60:63], v[236:239], v[12:15], v[60:63]
    ds_read_b64_tr_b16 v[34:35], v7 offset:10240
    v_mfma_f32_16x16x32_bf16 v[76:79], v[240:243], v[12:15], v[76:79]
    ds_read_b64_tr_b16 v[36:37], v6 offset:10752
    s_waitcnt lgkmcnt(9)
    v_mfma_f32_16x16x32_bf16 v[48:51], v[232:235], v[16:19], v[48:51]
    ds_read_b64_tr_b16 v[38:39], v7 offset:10752
    v_mfma_f32_16x16x32_bf16 v[64:67], v[236:239], v[16:19], v[64:67]
    v_mfma_f32_16x16x32_bf16 v[80:83], v[240:243], v[16:19], v[80:83]
    s_waitcnt lgkmcnt(8)
    v_mfma_f32_16x16x32_bf16 v[52:55], v[232:235], v[20:23], v[52:55]
    v_mfma_f32_16x16x32_bf16 v[68:71], v[236:239], v[20:23], v[68:71]
    v_mfma_f32_16x16x32_bf16 v[84:87], v[240:243], v[20:23], v[84:87]
    s_waitcnt lgkmcnt(6)
    v_mfma_f32_16x16x32_bf16 v[40:43], v[244:247], v[24:27], v[40:43]
    ds_read_b64_tr_b16 v[8:9], v6 offset:16384
    v_mfma_f32_16x16x32_bf16 v[56:59], v[248:251], v[24:27], v[56:59]
    ds_read_b64_tr_b16 v[10:11], v7 offset:16384
    v_mfma_f32_16x16x32_bf16 v[72:75], v[252:255], v[24:27], v[72:75]
    ds_read_b64_tr_b16 v[12:13], v6 offset:24576
    s_waitcnt lgkmcnt(7)
    v_mfma_f32_16x16x32_bf16 v[44:47], v[244:247], v[28:31], v[44:47]
    ds_read_b64_tr_b16 v[14:15], v7 offset:24576
    v_mfma_f32_16x16x32_bf16 v[60:63], v[248:251], v[28:31], v[60:63]
    ds_read_b64_tr_b16 v[16:17], v6 offset:32768
    v_mfma_f32_16x16x32_bf16 v[76:79], v[252:255], v[28:31], v[76:79]
    ds_read_b64_tr_b16 v[18:19], v7 offset:32768
    s_waitcnt lgkmcnt(8)
    v_mfma_f32_16x16x32_bf16 v[48:51], v[244:247], v[32:35], v[48:51]
    ds_read_b64_tr_b16 v[20:21], v6 offset:40960
    v_mfma_f32_16x16x32_bf16 v[64:67], v[248:251], v[32:35], v[64:67]
    ds_read_b64_tr_b16 v[22:23], v7 offset:40960
    v_mfma_f32_16x16x32_bf16 v[80:83], v[252:255], v[32:35], v[80:83]
    s_waitcnt lgkmcnt(8)
    v_mfma_f32_16x16x32_bf16 v[52:55], v[244:247], v[36:39], v[52:55]
    v_mfma_f32_16x16x32_bf16 v[68:71], v[248:251], v[36:39], v[68:71]
    v_mfma_f32_16x16x32_bf16 v[84:87], v[252:255], v[36:39], v[84:87]
    s_lshl_b32 s4, s62, 2
    s_add_u32 s4, s4, 150528
    v_mov_b32 v4, s4
    v_mov_b32 v5, 1
    ds_read_b64_tr_b16 v[24:25], v6 offset:16896
    ds_read_b64_tr_b16 v[26:27], v7 offset:16896
    s_waitcnt lgkmcnt(8)
    v_mfma_f32_16x16x32_bf16 v[40:43], v[88:91], v[8:11], v[40:43]
    ds_read_b64_tr_b16 v[28:29], v6 offset:25088
    ds_read_b64_tr_b16 v[30:31], v7 offset:25088
    v_mfma_f32_16x16x32_bf16 v[56:59], v[92:95], v[8:11], v[56:59]
    ds_read_b64_tr_b16 v[32:33], v6 offset:33280
    v_mfma_f32_16x16x32_bf16 v[72:75], v[96:99], v[8:11], v[72:75]
    ds_read_b64_tr_b16 v[34:35], v7 offset:33280
    ds_read_b64_tr_b16 v[36:37], v6 offset:41472
    s_waitcnt lgkmcnt(11)
    v_mfma_f32_16x16x32_bf16 v[40:43], v[100:103], v[12:15], v[40:43]
    ds_read_b64_tr_b16 v[38:39], v7 offset:41472
    v_mfma_f32_16x16x32_bf16 v[56:59], v[104:107], v[12:15], v[56:59]
    v_mfma_f32_16x16x32_bf16 v[72:75], v[108:111], v[12:15], v[72:75]
    s_waitcnt lgkmcnt(10)
    v_mfma_f32_16x16x32_bf16 v[40:43], v[112:115], v[16:19], v[40:43]
    v_mfma_f32_16x16x32_bf16 v[56:59], v[116:119], v[16:19], v[56:59]
    v_mfma_f32_16x16x32_bf16 v[72:75], v[120:123], v[16:19], v[72:75]
    s_waitcnt lgkmcnt(8)
    v_mfma_f32_16x16x32_bf16 v[40:43], v[124:127], v[20:23], v[40:43]
    v_mfma_f32_16x16x32_bf16 v[56:59], v[128:131], v[20:23], v[56:59]
    v_mfma_f32_16x16x32_bf16 v[72:75], v[132:135], v[20:23], v[72:75]
    ds_read_b64_tr_b16 v[8:9], v6 offset:18432
    ds_read_b64_tr_b16 v[10:11], v7 offset:18432
    s_waitcnt lgkmcnt(8)
    v_mfma_f32_16x16x32_bf16 v[44:47], v[88:91], v[24:27], v[44:47]
    ds_read_b64_tr_b16 v[12:13], v6 offset:26624
    ds_read_b64_tr_b16 v[14:15], v7 offset:26624
    v_mfma_f32_16x16x32_bf16 v[60:63], v[92:95], v[24:27], v[60:63]
    ds_read_b64_tr_b16 v[16:17], v6 offset:34816
    v_mfma_f32_16x16x32_bf16 v[76:79], v[96:99], v[24:27], v[76:79]
    ds_read_b64_tr_b16 v[18:19], v7 offset:34816
    ds_read_b64_tr_b16 v[20:21], v6 offset:43008
    ds_write_b128 v0, v[40:43] offset:0
    s_waitcnt lgkmcnt(12)
    v_mfma_f32_16x16x32_bf16 v[44:47], v[100:103], v[28:31], v[44:47]
    ds_read_b64_tr_b16 v[22:23], v7 offset:43008
    v_mfma_f32_16x16x32_bf16 v[60:63], v[104:107], v[28:31], v[60:63]
    v_mfma_f32_16x16x32_bf16 v[76:79], v[108:111], v[28:31], v[76:79]
    ds_write_b128 v0, v[56:59] offset:64
    s_waitcnt lgkmcnt(12)
    v_mfma_f32_16x16x32_bf16 v[44:47], v[112:115], v[32:35], v[44:47]
    v_mfma_f32_16x16x32_bf16 v[60:63], v[116:119], v[32:35], v[60:63]
    v_mfma_f32_16x16x32_bf16 v[76:79], v[120:123], v[32:35], v[76:79]
    ds_write_b128 v0, v[72:75] offset:128
    s_waitcnt lgkmcnt(11)
    v_mfma_f32_16x16x32_bf16 v[44:47], v[124:127], v[36:39], v[44:47]
    v_mfma_f32_16x16x32_bf16 v[60:63], v[128:131], v[36:39], v[60:63]
    v_mfma_f32_16x16x32_bf16 v[76:79], v[132:135], v[36:39], v[76:79]
    ds_read_b64_tr_b16 v[24:25], v6 offset:18944
    ds_read_b64_tr_b16 v[26:27], v7 offset:18944
    s_waitcnt lgkmcnt(11)
    v_mfma_f32_16x16x32_bf16 v[48:51], v[88:91], v[8:11], v[48:51]
    ds_read_b64_tr_b16 v[28:29], v6 offset:27136
    ds_read_b64_tr_b16 v[30:31], v7 offset:27136
    v_mfma_f32_16x16x32_bf16 v[64:67], v[92:95], v[8:11], v[64:67]
    ds_read_b64_tr_b16 v[32:33], v6 offset:35328
    v_mfma_f32_16x16x32_bf16 v[80:83], v[96:99], v[8:11], v[80:83]
    ds_read_b64_tr_b16 v[34:35], v7 offset:35328
    ds_read_b64_tr_b16 v[36:37], v6 offset:43520
    ds_write_b128 v0, v[44:47] offset:6400
    s_waitcnt lgkmcnt(15)
    v_mfma_f32_16x16x32_bf16 v[48:51], v[100:103], v[12:15], v[48:51]
    ds_read_b64_tr_b16 v[38:39], v7 offset:43520
    v_mfma_f32_16x16x32_bf16 v[64:67], v[104:107], v[12:15], v[64:67]
    ds_write_b128 v0, v[60:63] offset:6464
    v_mfma_f32_16x16x32_bf16 v[80:83], v[108:111], v[12:15], v[80:83]
    s_waitcnt lgkmcnt(15)
    v_mfma_f32_16x16x32_bf16 v[48:51], v[112:115], v[16:19], v[48:51]
    ds_write_b128 v0, v[76:79] offset:6528
    v_mfma_f32_16x16x32_bf16 v[64:67], v[116:119], v[16:19], v[64:67]
    v_mfma_f32_16x16x32_bf16 v[80:83], v[120:123], v[16:19], v[80:83]
    ds_write_b32 v4, v5 offset:16
    s_waitcnt lgkmcnt(14)
    v_mfma_f32_16x16x32_bf16 v[48:51], v[124:127], v[20:23], v[48:51]
    v_mfma_f32_16x16x32_bf16 v[64:67], v[128:131], v[20:23], v[64:67]
    v_mfma_f32_16x16x32_bf16 v[80:83], v[132:135], v[20:23], v[80:83]
    s_waitcnt lgkmcnt(10)
    v_mfma_f32_16x16x32_bf16 v[52:55], v[88:91], v[24:27], v[52:55]
    v_mfma_f32_16x16x32_bf16 v[68:71], v[92:95], v[24:27], v[68:71]
    v_mfma_f32_16x16x32_bf16 v[84:87], v[96:99], v[24:27], v[84:87]
    s_nop 1
    ds_write_b128 v0, v[48:51] offset:12800
    s_waitcnt lgkmcnt(9)
    v_mfma_f32_16x16x32_bf16 v[52:55], v[100:103], v[28:31], v[52:55]
    v_mfma_f32_16x16x32_bf16 v[68:71], v[104:107], v[28:31], v[68:71]
    v_mfma_f32_16x16x32_bf16 v[84:87], v[108:111], v[28:31], v[84:87]
    ds_write_b128 v0, v[64:67] offset:12864
    s_waitcnt lgkmcnt(8)
    v_mfma_f32_16x16x32_bf16 v[52:55], v[112:115], v[32:35], v[52:55]
    v_mfma_f32_16x16x32_bf16 v[68:71], v[116:119], v[32:35], v[68:71]
    v_mfma_f32_16x16x32_bf16 v[84:87], v[120:123], v[32:35], v[84:87]
    ds_write_b128 v0, v[80:83] offset:12928
    s_waitcnt lgkmcnt(6)
    v_mfma_f32_16x16x32_bf16 v[52:55], v[124:127], v[36:39], v[52:55]
    v_mfma_f32_16x16x32_bf16 v[68:71], v[128:131], v[36:39], v[68:71]
    v_mfma_f32_16x16x32_bf16 v[84:87], v[132:135], v[36:39], v[84:87]
    s_nop 5
    ds_write_b128 v0, v[52:55] offset:19200
    ds_write_b128 v0, v[68:71] offset:19264
    ds_write_b128 v0, v[84:87] offset:19328
    ds_write_b32 v4, v5 offset:32
    s_endpgm
.p2align 3
L_LO:
    s_cmp_ge_u32 s49, 9
    s_cselect_b32 s5, 1, 0
    s_cselect_b32 s54, 9, 0
    s_lshl_b32 s53, s50, 1
    s_sub_u32 s54, s49, s54
    s_add_u32 s53, s53, s5
    s_add_u32 s59, s54, s50
    s_sub_u32 s4, s59, 9
    s_min_u32 s59, s59, s4
    s_lshl_b32 s59, s59, 7
    s_lshl_b32 s4, s54, 7
    s_lshl_b32 s5, s48, 5
    s_add_u32 s4, s4, s5
    v_lshl_add_u32 v16, v2, 1, s4
    s_add_u32 s4, s59, 128
    s_sub_u32 s5, s4, 1152
    s_min_u32 s4, s4, s5
    v_lshl_add_u32 v17, v3, 4, s4
    s_waitcnt lgkmcnt(0)
    s_nop 0
    global_load_ushort v20, v16, s[36:37]
    global_load_ushort v21, v16, s[24:25]
    global_load_ushort v22, v16, s[26:27]
    s_load_dword s55, s[46:47], 0
    global_load_dwordx4 v[64:67], v17, s[40:41] offset:0
    global_load_dwordx4 v[68:71], v17, s[40:41] offset:64
    v_lshrrev_b32 v6, 1, v2
    v_xor_b32 v6, v6, v3
    v_lshlrev_b32_e64 v6, 4, v6
    v_lshl_add_u32 v8, v2, 7, v6
    v_xor_b32 v9, 64, v8
    s_lshl_b32 s4, s48, 11
    s_add_u32 s4, s4, 49152
    v_add_u32 v10, s4, v8
    v_xor_b32 v11, 64, v10
    s_lshl_b32 s4, s48, 12
    v_add_u32 v12, s4, v8
    v_xor_b32_e64 v13, 64, v12
    s_mov_b32 s76, s46
    s_mov_b32 s77, s47
    s_mov_b32 s78, 268435456
    s_mov_b32 s79, 0x20000
    s_lshl_b32 s13, s53, 11
    s_add_u32 s13, s13, 655360
    s_lshl_b32 s5, s54, 2
    s_add_u32 s5, s5, s48
    s_mul_i32 s6, s53, 294912
    s_lshl_b32 s7, s5, 12
    s_add_u32 s60, s6, s7
    s_mul_i32 s4, s53, 36
    s_add_u32 s4, s4, s5
    s_lshl_b32 s4, s4, 7
    s_add_u32 s6, s4, 262144
    v_mov_b32_e64 v6, s6
    s_add_u32 s4, s4, 458752
    v_and_b32_e64 v106, 7, v1
    v_lshl_add_u32 v106, v106, 2, s4
    v_lshl_add_u32 v106, v3, 5, v106
    s_lshl_b32 s10, s54, 14
    s_lshl_b32 s4, s48, 8
    s_add_u32 s10, s10, s4
    s_add_u32 s10, s10, 4096
    v_lshl_add_u32 v16, v2, 4, s10
    s_lshl_b32 s11, s53, 10
    v_add_u32 v17, s11, v16
    v_lshrrev_b32 v29, 1, v3
    v_mul_u32_u24 v29, 147456, v29
    v_and_b32_e64 v5, 1, v3
    v_lshl_add_u32 v29, v5, 11, v29
    v_lshl_add_u32 v29, v2, 4, v29
    v_xor_b32_e64 v30, 64, v29
    v_cmp_eq_u32 s[64:65], 0, v5
    v_lshlrev_b32 v31, 5, v3
    v_cvt_f32_u32 v31, v31
    v_mul_f32_e64 v32, 4.0, v31
    v_sub_f32 v33, 0x42c00000, v31
    s_sub_u32 s4, s53, 1
    v_sub_u32 v28, s4, v3
    v_mov_b32 v4, 0x80000000
    v_subrev_u32_e64 v5, 0, v28
    v_cmp_le_i32 s[24:25], 0, v5
    v_lshl_add_u32 v5, v5, 10, v16
    s_nop 0
    v_cndmask_b32 v24, v4, v5, s[24:25]
    v_subrev_u32 v5, 4, v28
    v_cmp_le_i32 s[26:27], 0, v5
    v_lshl_add_u32 v5, v5, 10, v16
    s_nop 0
    v_cndmask_b32 v25, v4, v5, s[26:27]
    v_subrev_u32 v5, 8, v28
    v_cmp_le_i32 s[28:29], 0, v5
    v_lshl_add_u32 v5, v5, 10, v16
    s_nop 0
    v_cndmask_b32 v26, v4, v5, s[28:29]
    v_subrev_u32 v5, 12, v28
    v_cmp_le_i32 s[30:31], 0, v5
    v_lshl_add_u32 v5, v5, 10, v16
    s_nop 0
    v_cndmask_b32 v27, v4, v5, s[30:31]
    s_waitcnt lgkmcnt(0)
    s_mul_i32 s55, s55, 1664525
    s_add_u32 s55, s55, 1013904223
    s_max_u32 s55, s55, 1
    s_not_b32 s62, s55
    v_mov_b32 v122, s55
    v_mov_b32_e64 v123, s62
    s_cmp_ge_u32 s49, 12
    s_mov_b32 s4, 3393292320
    s_mov_b32 s5, 155585890
    s_cmov_b32 s4, 899438227
    s_cmov_b32 s5, 250833482
    s_cselect_b32 s52, 12, 0
    s_sub_u32 s52, s49, s52
    s_mul_i32 s52, s52, 5
    s_lshr_b64 s[4:5], s[4:5], s52
    s_and_b32 s52, s4, 7
    s_bfe_u32 s4, s4, 0x20003
    s_and_b32 s51, s4, 1
    s_lshl_b32 s56, s50, 2
    s_add_u32 s56, s56, s4
    s_mul_i32 s57, s52, 3
    s_lshr_b32 s57, s57, 1
    s_mul_i32 s4, s4, 0
    s_add_u32 s57, s57, s4
    s_mul_i32 s4, s50, 3
    s_add_u32 s57, s57, s4
    s_mul_hi_u32 s4, s57, 0x1C71C71D
    s_mul_i32 s4, s4, 9
    s_sub_u32 s57, s57, s4
    s_lshl_b32 s57, s57, 7
    s_mov_b32 s68, s42
    s_mov_b32 s69, s43
    s_mov_b32 s70, 4718592
    s_mov_b32 s71, 0x20000
    s_cmp_lt_u32 s48, 2
    s_cselect_b32 s16, s32, s34
    s_cselect_b32 s17, s33, s35
    s_mov_b32 s18, 663552
    s_mov_b32 s19, 0x20000
    s_getreg_b32 s14, hwreg(HW_REG_XCC_ID, 0, 4)
    s_lshl_b32 s12, s56, 10
    s_add_u32 s12, s12, 655360
    s_lshl_b32 s23, s52, 7
    s_add_u32 s23, s23, s12
    s_lshl_b32 s4, s48, 2
    s_add_u32 s23, s23, s4
    s_mov_b32 s33, s57
    s_lshr_b32 s4, s56, 1
    s_mul_i32 s4, s4, 4608
    s_add_u32 s4, s4, 262144
    v_min_u32_e64 v62, 8, v1
    v_lshl_add_u32 v62, v62, 7, s57
    v_subrev_u32 v63, 1152, v62
    v_min_u32 v62, v62, v63
    v_lshrrev_b32 v62, 5, v62
    v_add_u32_e64 v62, s48, v62
    v_lshl_add_u32 v62, v62, 7, s4
    s_mul_i32 s4, s56, 147456
    s_lshl_b32 s15, s48, 12
    s_add_u32 s4, s4, s15
    s_add_u32 s4, s4, 0
    v_lshl_add_u32 v63, v1, 4, s4
    s_add_u32 s34, s33, 128
    s_cmp_eq_u32 s34, 1152
    s_cselect_b32 s34, 0, s34
    s_add_u32 s35, s34, 128
    s_cmp_eq_u32 s35, 1152
    s_cselect_b32 s35, 0, s35
    s_add_u32 s36, s35, 128
    s_cmp_eq_u32 s36, 1152
    s_cselect_b32 s36, 0, s36
    s_add_u32 s37, s36, 128
    s_cmp_eq_u32 s37, 1152
    s_cselect_b32 s37, 0, s37
    s_add_u32 s40, s37, 128
    s_cmp_eq_u32 s40, 1152
    s_cselect_b32 s40, 0, s40
    s_add_u32 s41, s40, 128
    s_cmp_eq_u32 s41, 1152
    s_cselect_b32 s41, 0, s41
    s_add_u32 s44, s41, 128
    s_cmp_eq_u32 s44, 1152
    s_cselect_b32 s44, 0, s44
    s_add_u32 s45, s44, 128
    s_cmp_eq_u32 s45, 1152
    s_cselect_b32 s45, 0, s45
    s_lshl_b32 s4, s56, 6
    v_lshrrev_b32 v96, 3, v0
    v_add_u32 v97, s4, v96
    v_and_b32_e64 v98, 7, v0
    s_mul_i32 s5, s52, 192
    v_lshl_add_u32 v99, v98, 3, s5
    v_mul_u32_u24 v100, 1152, v97
    v_add_u32_e64 v100, v100, v99
    v_add_u32 v101, 36864, v100
    s_lshr_b32 s4, s56, 1
    s_mul_i32 s4, s4, 4608
    s_lshl_b32 s5, s51, 6
    s_add_u32 s4, s4, s5
    s_lshr_b32 s5, s48, 1
    s_lshl_b32 s5, s5, 2
    s_add_u32 s4, s4, s5
    s_and_b32 s5, s48, 1
    s_lshl_b32 s5, s5, 8
    s_add_u32 s4, s4, s5
    s_add_u32 s4, s4, 458752
    v_lshrrev_b32 v102, 3, v1
    v_and_b32_e64 v109, 3, v102
    v_lshl_add_u32 v109, v109, 3, s4
    v_lshrrev_b32_e64 v104, 5, v1
    v_lshl_add_u32 v109, v104, 7, v109
    v_lshl_add_u32 v104, v98, 9, v109
    v_add_u32 v109, 4096, v109
    s_mul_i32 s4, s52, 43
    s_lshr_b32 s4, s4, 5
    s_mul_i32 s4, s4, 1792
    s_add_u32 s4, s4, 393216
    v_min_u32_e64 v105, 27, v1
    v_lshl_add_u32 v105, v105, 7, s4
    s_mul_i32 s4, s52, 96
    s_mul_i32 s5, s48, 24
    s_add_u32 s4, s4, s5
    s_lshl_b32 s4, s4, 12
    s_lshl_b32 s5, s56, 7
    s_add_u32 s4, s4, s5
    s_add_u32 s4, s4, 6291456
    v_lshl_add_u32 v253, v102, 12, s4
    v_lshrrev_b32 v254, 5, v1
    s_mul_i32 s5, s48, 6
    v_add_u32 v254, s5, v254
    v_add_u32 v255, 0, v254
    v_xor_b32 v255, v255, v1
    v_and_b32_e64 v255, 7, v255
    v_lshl_add_u32 v248, v255, 4, v253
    v_add_u32 v255, 2, v254
    v_xor_b32 v255, v255, v1
    v_and_b32_e64 v255, 7, v255
    v_lshl_add_u32 v249, v255, 4, v253
    v_add_u32 v255, 4, v254
    v_xor_b32 v255, v255, v1
    v_and_b32_e64 v255, 7, v255
    v_lshl_add_u32 v250, v255, 4, v253
    s_mul_i32 s4, s52, 96
    s_and_b32 s5, s48, 1
    s_mul_i32 s5, s5, 48
    s_add_u32 s4, s4, s5
    v_add_u32 v253, s4, v102
    v_mul_u32_u24 v253, 1152, v253
    v_xor_b32_e64 v254, v98, v3
    v_lshl_add_u32 v253, v254, 4, v253
    v_xor_b32_e64 v254, 64, v253
    v_add_u32 v254, 8192, v254
    s_mul_i32 s22, s48, 12288
    s_add_u32 s22, s22, 100352
    s_mul_i32 s21, s48, 3072
    s_and_b32 s4, s48, 1
    s_lshl_b32 s4, s4, 2
    s_lshr_b32 s5, s48, 1
    s_add_u32 s4, s4, s5
    v_xor_b32 v251, s4, v98
    v_lshlrev_b32 v251, 4, v251
    v_lshl_add_u32 v251, v98, 9, v251
    v_lshl_add_u32 v251, v102, 1, v251
    v_add_u32 v251, 151552, v251
    v_xor_b32_e64 v252, 32, v251
    v_mul_u32_u24 v96, 400, v96
    v_lshl_add_u32 v96, v98, 4, v96
    v_add_u32 v96, 98304, v96
    v_mov_b32 v116, s55
    v_mov_b32 v117, s14
    s_lshl_b32 s4, s52, 7
    s_add_u32 s4, s4, s12
    v_mov_b32 v119, s4
    v_and_b32 v118, 7, v1
    v_min_u32 v118, 5, v118
    v_and_b32 v5, 8, v1
    v_add_u32_e64 v118, v118, v5
    v_lshl_add_u32 v118, v118, 7, s13
    v_lshrrev_b32 v52, 3, v1
    v_and_b32 v53, 7, v1
    s_and_b32 s4, s48, 1
    s_lshl_b32 s5, s4, 2
    v_lshrrev_b32 v54, 1, v52
    v_add_u32 v54, s5, v54
    s_and_b32 s5, s48, 2
    v_lshrrev_b32 v55, 2, v53
    v_add_u32 v55, s5, v55
    v_lshlrev_b32 v56, 1, v55
    v_xor_b32 v54, v54, v56
    v_lshlrev_b32 v54, 4, v54
    v_lshl_add_u32 v54, v55, 9, v54
    v_bfe_u32 v55, v53, 1, 1
    v_lshl_add_u32 v54, v55, 7, v54
    v_and_b32_e64 v55, 1, v52
    v_lshl_add_u32 v54, v55, 3, v54
    v_and_b32_e64 v55, 1, v53
    v_lshl_add_u32 v54, v55, 13, v54
    v_xor_b32_e64 v55, 16, v54
    s_lshr_b32 s5, s48, 1
    s_lshr_b32 s6, s59, 6
    s_add_u32 s6, s6, s4
    s_lshl_b32 s7, s53, 1
    s_add_u32 s7, s7, s5
    s_lshl_b32 s4, s6, 17
    s_lshl_b32 s5, s7, 7
    s_add_u32 s4, s4, s5
    s_add_u32 s4, s4, 6291456
    v_lshl_add_u32 v58, v53, 4, s4
    v_lshl_add_u32 v58, v52, 14, v58
    s_lshl_b32 s6, s6, 5
    s_add_u32 s6, s6, s7
    s_lshl_b32 s6, s6, 5
    s_add_u32 s6, s6, 589824
    v_mov_b32 v23, s6
    s_mov_b32 s66, 0x05040100
    s_mov_b32 s67, 0x07060302
    s_mov_b32 s72, 4096
    s_mov_b32 s73, 8192
    s_mov_b32 s74, 12288
    s_barrier
    s_nop 0
    ds_read_b128 v[240:243], v10 offset:0
    ds_read_b128 v[208:211], v8 offset:0
    ds_read_b128 v[244:247], v10 offset:8192
    ds_read_b128 v[212:215], v8 offset:2048
    ds_read_b128 v[216:219], v8 offset:4096
    ds_read_b128 v[220:223], v8 offset:6144
    ds_read_b128 v[224:227], v8 offset:8192
    ds_read_b128 v[228:231], v8 offset:10240
    ds_read_b128 v[232:235], v8 offset:12288
    s_waitcnt lgkmcnt(7)
    v_mfma_f32_16x16x32_bf16 v[128:131], v[208:211], v[240:243], 0
    ds_read_b128 v[236:239], v8 offset:14336
    ds_read_b64 v[80:81], v54 offset:0
    s_waitcnt lgkmcnt(8)
    v_mfma_f32_16x16x32_bf16 v[160:163], v[208:211], v[244:247], 0
    ds_read_b64 v[82:83], v55 offset:256
    s_waitcnt lgkmcnt(8)
    v_mfma_f32_16x16x32_bf16 v[132:135], v[212:215], v[240:243], 0
    ds_read_b128 v[208:211], v9 offset:0
    ds_read_b64 v[84:85], v54 offset:2048
    v_mfma_f32_16x16x32_bf16 v[164:167], v[212:215], v[244:247], 0
    ds_read_b64 v[86:87], v55 offset:2304
    s_waitcnt lgkmcnt(10)
    v_mfma_f32_16x16x32_bf16 v[136:139], v[216:219], v[240:243], 0
    ds_read_b128 v[212:215], v9 offset:2048
    ds_read_b64 v[88:89], v54 offset:4096
    v_mfma_f32_16x16x32_bf16 v[168:171], v[216:219], v[244:247], 0
    ds_read_b64 v[90:91], v55 offset:4352
    s_waitcnt lgkmcnt(12)
    v_mfma_f32_16x16x32_bf16 v[140:143], v[220:223], v[240:243], 0
    ds_read_b128 v[192:195], v11 offset:0
    ds_read_b64 v[92:93], v54 offset:6144
    ds_read_b64 v[94:95], v55 offset:6400
    v_mfma_f32_16x16x32_bf16 v[172:175], v[220:223], v[244:247], 0
    ds_read_b128 v[216:219], v9 offset:4096
    s_waitcnt lgkmcnt(15)
    v_mfma_f32_16x16x32_bf16 v[144:147], v[224:227], v[240:243], 0
    ds_read_b128 v[196:199], v11 offset:8192
    s_waitcnt lgkmcnt(11)
    v_perm_b32 v36, v82, v80, s66
    s_waitcnt lgkmcnt(8)
    v_perm_b32 v37, v86, v84, s66
    v_mfma_f32_16x16x32_bf16 v[176:179], v[224:227], v[244:247], 0
    ds_read_b128 v[220:223], v9 offset:6144
    s_waitcnt lgkmcnt(6)
    v_perm_b32 v38, v90, v88, s66
    v_mfma_f32_16x16x32_bf16 v[148:151], v[228:231], v[240:243], 0
    ds_read_b128 v[224:227], v9 offset:8192
    s_waitcnt lgkmcnt(4)
    v_perm_b32 v39, v94, v92, s66
    buffer_store_dwordx4 v[36:39], v58, s[76:79], 0 offen sc1
    v_mfma_f32_16x16x32_bf16 v[180:183], v[228:231], v[244:247], 0
    v_perm_b32 v40, v82, v80, s67
    v_perm_b32 v41, v86, v84, s67
    v_mfma_f32_16x16x32_bf16 v[152:155], v[232:235], v[240:243], 0
    ds_read_b128 v[228:231], v9 offset:10240
    v_perm_b32 v42, v90, v88, s67
    v_perm_b32 v43, v94, v92, s67
    v_mfma_f32_16x16x32_bf16 v[184:187], v[232:235], v[244:247], 0
    buffer_store_dwordx4 v[40:43], v58, s[76:79], s72 offen sc1
    v_perm_b32 v44, v83, v81, s66
    v_mfma_f32_16x16x32_bf16 v[156:159], v[236:239], v[240:243], 0
    ds_read_b128 v[232:235], v9 offset:12288
    v_perm_b32 v45, v87, v85, s66
    v_perm_b32 v46, v91, v89, s66
    v_mfma_f32_16x16x32_bf16 v[188:191], v[236:239], v[244:247], 0
    v_perm_b32 v47, v95, v93, s66
    buffer_store_dwordx4 v[44:47], v58, s[76:79], s73 offen sc1
    v_mfma_f32_16x16x32_bf16 v[128:131], v[208:211], v[192:195], v[128:131]
    ds_read_b128 v[236:239], v9 offset:14336
    v_perm_b32 v48, v83, v81, s67
    s_waitcnt lgkmcnt(5)
    v_mfma_f32_16x16x32_bf16 v[160:163], v[208:211], v[196:199], v[160:163]
    v_perm_b32 v49, v87, v85, s67
    v_mfma_f32_16x16x32_bf16 v[132:135], v[212:215], v[192:195], v[132:135]
    v_perm_b32 v50, v91, v89, s67
    v_perm_b32 v51, v95, v93, s67
    v_mfma_f32_16x16x32_bf16 v[164:167], v[212:215], v[196:199], v[164:167]
    buffer_store_dwordx4 v[48:51], v58, s[76:79], s74 offen sc1
    v_mfma_f32_16x16x32_bf16 v[136:139], v[216:219], v[192:195], v[136:139]
    v_mfma_f32_16x16x32_bf16 v[168:171], v[216:219], v[196:199], v[168:171]
    s_waitcnt lgkmcnt(0)
    s_barrier
    v_mfma_f32_16x16x32_bf16 v[140:143], v[220:223], v[192:195], v[140:143]
    ds_read_b128 v[240:243], v10 offset:16384
    v_mfma_f32_16x16x32_bf16 v[172:175], v[220:223], v[196:199], v[172:175]
    ds_read_b128 v[208:211], v8 offset:16384
    v_mfma_f32_16x16x32_bf16 v[144:147], v[224:227], v[192:195], v[144:147]
    ds_read_b128 v[244:247], v10 offset:24576
    ds_read_b128 v[212:215], v8 offset:18432
    v_mfma_f32_16x16x32_bf16 v[176:179], v[224:227], v[196:199], v[176:179]
    ds_read_b128 v[216:219], v8 offset:20480
    v_mfma_f32_16x16x32_bf16 v[148:151], v[228:231], v[192:195], v[148:151]
    ds_read_b128 v[220:223], v8 offset:22528
    v_mfma_f32_16x16x32_bf16 v[180:183], v[228:231], v[196:199], v[180:183]
    ds_read_b128 v[224:227], v8 offset:24576
    v_mfma_f32_16x16x32_bf16 v[152:155], v[232:235], v[192:195], v[152:155]
    ds_read_b128 v[228:231], v8 offset:26624
    v_mfma_f32_16x16x32_bf16 v[184:187], v[232:235], v[196:199], v[184:187]
    v_mfma_f32_16x16x32_bf16 v[156:159], v[236:239], v[192:195], v[156:159]
    ds_read_b128 v[232:235], v8 offset:28672
    v_mfma_f32_16x16x32_bf16 v[188:191], v[236:239], v[196:199], v[188:191]
    s_waitcnt lgkmcnt(7)
    v_mfma_f32_16x16x32_bf16 v[128:131], v[208:211], v[240:243], v[128:131]
    ds_read_b128 v[236:239], v8 offset:30720
    s_waitcnt lgkmcnt(7)
    v_mfma_f32_16x16x32_bf16 v[160:163], v[208:211], v[244:247], v[160:163]
    ds_read_b128 v[72:75], v12 offset:16384
    s_waitcnt lgkmcnt(7)
    v_mfma_f32_16x16x32_bf16 v[132:135], v[212:215], v[240:243], v[132:135]
    ds_read_b128 v[208:211], v9 offset:16384
    v_mfma_f32_16x16x32_bf16 v[164:167], v[212:215], v[244:247], v[164:167]
    ds_read_b128 v[76:79], v12 offset:18432
    s_waitcnt lgkmcnt(8)
    v_mfma_f32_16x16x32_bf16 v[136:139], v[216:219], v[240:243], v[136:139]
    ds_read_b128 v[212:215], v9 offset:18432
    v_mfma_f32_16x16x32_bf16 v[168:171], v[216:219], v[244:247], v[168:171]
    s_waitcnt lgkmcnt(8)
    v_mfma_f32_16x16x32_bf16 v[140:143], v[220:223], v[240:243], v[140:143]
    ds_read_b128 v[192:195], v11 offset:16384
    v_mfma_f32_16x16x32_bf16 v[172:175], v[220:223], v[244:247], v[172:175]
    ds_read_b128 v[216:219], v9 offset:20480
    s_waitcnt lgkmcnt(9)
    v_mfma_f32_16x16x32_bf16 v[144:147], v[224:227], v[240:243], v[144:147]
    ds_read_b128 v[196:199], v11 offset:24576
    v_mfma_f32_16x16x32_bf16 v[176:179], v[224:227], v[244:247], v[176:179]
    ds_read_b128 v[220:223], v9 offset:22528
    s_waitcnt lgkmcnt(10)
    v_mfma_f32_16x16x32_bf16 v[148:151], v[228:231], v[240:243], v[148:151]
    ds_read_b128 v[224:227], v9 offset:24576
    v_mfma_f32_16x16x32_bf16 v[180:183], v[228:231], v[244:247], v[180:183]
    s_waitcnt lgkmcnt(10)
    v_mfma_f32_16x16x32_bf16 v[152:155], v[232:235], v[240:243], v[152:155]
    ds_read_b128 v[228:231], v9 offset:26624
    v_mfma_f32_16x16x32_bf16 v[184:187], v[232:235], v[244:247], v[184:187]
    s_waitcnt lgkmcnt(10)
    v_mfma_f32_16x16x32_bf16 v[156:159], v[236:239], v[240:243], v[156:159]
    ds_read_b128 v[232:235], v9 offset:28672
    v_mfma_f32_16x16x32_bf16 v[188:191], v[236:239], v[244:247], v[188:191]
    s_waitcnt vmcnt(5) lgkmcnt(10)
    v_mfma_f32_16x16x32_bf16 v[80:83], v[72:75], v[64:67], 0
    s_waitcnt lgkmcnt(8)
    v_mfma_f32_16x16x32_bf16 v[84:87], v[76:79], v[64:67], 0
    s_waitcnt lgkmcnt(6)
    v_mfma_f32_16x16x32_bf16 v[128:131], v[208:211], v[192:195], v[128:131]
    ds_read_b128 v[236:239], v9 offset:30720
    s_waitcnt vmcnt(0)
    s_waitcnt lgkmcnt(5)
    v_mfma_f32_16x16x32_bf16 v[160:163], v[208:211], v[196:199], v[160:163]
    ds_read_b128 v[72:75], v13 offset:16384
    v_mfma_f32_16x16x32_bf16 v[132:135], v[212:215], v[192:195], v[132:135]
    ds_read_b128 v[76:79], v13 offset:18432
    s_mov_b64 exec, 1
    global_store_dword v23, v122, s[46:47] sc1
    s_mov_b64 exec, -1
    v_mfma_f32_16x16x32_bf16 v[164:167], v[212:215], v[196:199], v[164:167]
    v_mfma_f32_16x16x32_bf16 v[136:139], v[216:219], v[192:195], v[136:139]
    v_mfma_f32_16x16x32_bf16 v[168:171], v[216:219], v[196:199], v[168:171]
    s_waitcnt lgkmcnt(0)
    s_barrier
    v_mfma_f32_16x16x32_bf16 v[140:143], v[220:223], v[192:195], v[140:143]
    ds_read_b128 v[240:243], v10 offset:32768
    v_mfma_f32_16x16x32_bf16 v[172:175], v[220:223], v[196:199], v[172:175]
    ds_read_b128 v[208:211], v8 offset:32768
    v_mfma_f32_16x16x32_bf16 v[144:147], v[224:227], v[192:195], v[144:147]
    ds_read_b128 v[244:247], v10 offset:40960
    ds_read_b128 v[212:215], v8 offset:34816
    v_mfma_f32_16x16x32_bf16 v[176:179], v[224:227], v[196:199], v[176:179]
    ds_read_b128 v[216:219], v8 offset:36864
    v_mfma_f32_16x16x32_bf16 v[148:151], v[228:231], v[192:195], v[148:151]
    ds_read_b128 v[220:223], v8 offset:38912
    v_mfma_f32_16x16x32_bf16 v[180:183], v[228:231], v[196:199], v[180:183]
    ds_read_b128 v[224:227], v8 offset:40960
    v_mfma_f32_16x16x32_bf16 v[152:155], v[232:235], v[192:195], v[152:155]
    ds_read_b128 v[228:231], v8 offset:43008
    v_mfma_f32_16x16x32_bf16 v[184:187], v[232:235], v[196:199], v[184:187]
    v_mfma_f32_16x16x32_bf16 v[156:159], v[236:239], v[192:195], v[156:159]
    ds_read_b128 v[232:235], v8 offset:45056
    v_mfma_f32_16x16x32_bf16 v[188:191], v[236:239], v[196:199], v[188:191]
    v_mfma_f32_16x16x32_bf16 v[80:83], v[72:75], v[68:71], v[80:83]
    v_mfma_f32_16x16x32_bf16 v[84:87], v[76:79], v[68:71], v[84:87]
    s_waitcnt lgkmcnt(7)
    v_mfma_f32_16x16x32_bf16 v[128:131], v[208:211], v[240:243], v[128:131]
    ds_read_b128 v[236:239], v8 offset:47104
    s_waitcnt lgkmcnt(7)
    v_mfma_f32_16x16x32_bf16 v[160:163], v[208:211], v[244:247], v[160:163]
    s_waitcnt lgkmcnt(6)
    v_mfma_f32_16x16x32_bf16 v[132:135], v[212:215], v[240:243], v[132:135]
    ds_read_b128 v[208:211], v9 offset:32768
    v_mfma_f32_16x16x32_bf16 v[164:167], v[212:215], v[244:247], v[164:167]
    s_waitcnt lgkmcnt(6)
    v_mfma_f32_16x16x32_bf16 v[136:139], v[216:219], v[240:243], v[136:139]
    ds_read_b128 v[212:215], v9 offset:34816
    v_mfma_f32_16x16x32_bf16 v[168:171], v[216:219], v[244:247], v[168:171]
    s_waitcnt lgkmcnt(6)
    v_mfma_f32_16x16x32_bf16 v[140:143], v[220:223], v[240:243], v[140:143]
    ds_read_b128 v[192:195], v11 offset:32768
    v_and_b32_e64 v107, 4, v1
    v_mfma_f32_16x16x32_bf16 v[172:175], v[220:223], v[244:247], v[172:175]
    ds_read_b128 v[216:219], v9 offset:36864
    s_waitcnt lgkmcnt(7)
    v_mfma_f32_16x16x32_bf16 v[144:147], v[224:227], v[240:243], v[144:147]
    ds_read_b128 v[196:199], v11 offset:40960
    v_cmp_ne_u32 vcc, 0, v107
    v_mfma_f32_16x16x32_bf16 v[176:179], v[224:227], v[244:247], v[176:179]
    ds_read_b128 v[220:223], v9 offset:38912
    s_waitcnt lgkmcnt(8)
    v_mfma_f32_16x16x32_bf16 v[148:151], v[228:231], v[240:243], v[148:151]
    ds_read_b128 v[224:227], v9 offset:40960
    v_cndmask_b32 v80, v80, v84, vcc
    v_mfma_f32_16x16x32_bf16 v[180:183], v[228:231], v[244:247], v[180:183]
    v_cndmask_b32 v81, v81, v85, vcc
    s_waitcnt lgkmcnt(8)
    v_mfma_f32_16x16x32_bf16 v[152:155], v[232:235], v[240:243], v[152:155]
    ds_read_b128 v[228:231], v9 offset:43008
    v_cndmask_b32 v82, v82, v86, vcc
    v_cndmask_b32 v83, v83, v87, vcc
    v_mfma_f32_16x16x32_bf16 v[184:187], v[232:235], v[244:247], v[184:187]
    v_and_b32 v107, 2, v1
    s_waitcnt lgkmcnt(8)
    v_mfma_f32_16x16x32_bf16 v[156:159], v[236:239], v[240:243], v[156:159]
    ds_read_b128 v[232:235], v9 offset:45056
    v_cmp_ne_u32 vcc, 0, v107
    s_nop 1
    v_cndmask_b32 v80, v80, v82, vcc
    v_mfma_f32_16x16x32_bf16 v[188:191], v[236:239], v[244:247], v[188:191]
    v_cndmask_b32 v81, v81, v83, vcc
    s_waitcnt lgkmcnt(6)
    v_mfma_f32_16x16x32_bf16 v[128:131], v[208:211], v[192:195], v[128:131]
    ds_read_b128 v[236:239], v9 offset:47104
    v_and_b32_e64 v107, 1, v1
    s_waitcnt lgkmcnt(5)
    v_mfma_f32_16x16x32_bf16 v[160:163], v[208:211], v[196:199], v[160:163]
    v_cmp_ne_u32 vcc, 0, v107
    v_mfma_f32_16x16x32_bf16 v[132:135], v[212:215], v[192:195], v[132:135]
    s_nop 0
    v_cndmask_b32 v108, v80, v81, vcc
    v_lshlrev_b32 v20, 16, v20
    v_mfma_f32_16x16x32_bf16 v[164:167], v[212:215], v[196:199], v[164:167]
    v_mul_f32 v20, 0x3fb8aa3b, v20
    v_mfma_f32_16x16x32_bf16 v[136:139], v[216:219], v[192:195], v[136:139]
    v_exp_f32 v20, v20
    v_lshlrev_b32 v18, 16, v21
    v_mfma_f32_16x16x32_bf16 v[168:171], v[216:219], v[196:199], v[168:171]
    v_lshlrev_b32_e64 v19, 16, v22
    s_waitcnt lgkmcnt(0)
    s_barrier
    v_mfma_f32_16x16x32_bf16 v[140:143], v[220:223], v[192:195], v[140:143]
    ds_read_b128 v[240:243], v10 offset:0
    v_cvt_pk_bf16_f32 v20, v20, v20
    v_mfma_f32_16x16x32_bf16 v[172:175], v[220:223], v[196:199], v[172:175]
    ds_read_b128 v[208:211], v8 offset:0
    v_mfma_f32_16x16x32_bf16 v[144:147], v[224:227], v[192:195], v[144:147]
    ds_read_b128 v[244:247], v10 offset:8192
    ds_read_b128 v[212:215], v8 offset:2048
    v_mfma_f32_16x16x32_bf16 v[176:179], v[224:227], v[196:199], v[176:179]
    ds_read_b128 v[216:219], v8 offset:4096
    v_mfma_f32_16x16x32_bf16 v[148:151], v[228:231], v[192:195], v[148:151]
    ds_read_b128 v[220:223], v8 offset:6144
    v_mul_f32_e64 v21, v18, v18
    v_mfma_f32_16x16x32_bf16 v[180:183], v[228:231], v[196:199], v[180:183]
    ds_read_b128 v[224:227], v8 offset:8192
    v_mfma_f32_16x16x32_bf16 v[152:155], v[232:235], v[192:195], v[152:155]
    ds_read_b128 v[228:231], v8 offset:10240
    v_and_b32 v20, 0xffff0000, v20
    v_mfma_f32_16x16x32_bf16 v[184:187], v[232:235], v[196:199], v[184:187]
    v_fmac_f32 v21, v19, v19
    v_mfma_f32_16x16x32_bf16 v[156:159], v[236:239], v[192:195], v[156:159]
    ds_read_b128 v[232:235], v8 offset:12288
    v_mul_f32 v14, v20, v18
    v_mfma_f32_16x16x32_bf16 v[188:191], v[236:239], v[196:199], v[188:191]
    v_mul_f32 v15, v20, v19
    s_waitcnt lgkmcnt(7)
    v_mfma_f32_16x16x32_bf16 v[128:131], v[208:211], v[240:243], v[128:131]
    ds_read_b128 v[236:239], v8 offset:14336
    v_rcp_f32 v21, v21
    s_waitcnt lgkmcnt(7)
    v_mfma_f32_16x16x32_bf16 v[160:163], v[208:211], v[244:247], v[160:163]
    v_mul_f32 v14, 0x3fb8aa3b, v14
    s_waitcnt lgkmcnt(6)
    v_mfma_f32_16x16x32_bf16 v[132:135], v[212:215], v[240:243], v[132:135]
    ds_read_b128 v[208:211], v9 offset:0
    v_mul_f32 v15, 0x3e22f983, v15
    v_mfma_f32_16x16x32_bf16 v[164:167], v[212:215], v[244:247], v[164:167]
    v_add_f32 v21, v21, v21
    s_waitcnt lgkmcnt(6)
    v_mfma_f32_16x16x32_bf16 v[136:139], v[216:219], v[240:243], v[136:139]
    ds_read_b128 v[212:215], v9 offset:2048
    v_mul_f32_e64 v18, v18, v21
    v_mfma_f32_16x16x32_bf16 v[168:171], v[216:219], v[244:247], v[168:171]
    v_mul_f32 v19, -v19, v21
    s_waitcnt lgkmcnt(6)
    v_mfma_f32_16x16x32_bf16 v[140:143], v[220:223], v[240:243], v[140:143]
    ds_read_b128 v[192:195], v11 offset:0
    v_mul_f32 v112, 1.0, v14
    v_mfma_f32_16x16x32_bf16 v[172:175], v[220:223], v[244:247], v[172:175]
    ds_read_b128 v[216:219], v9 offset:4096
    s_waitcnt lgkmcnt(7)
    v_mfma_f32_16x16x32_bf16 v[144:147], v[224:227], v[240:243], v[144:147]
    ds_read_b128 v[196:199], v11 offset:8192
    v_mul_f32 v113, 1.0, v15
    v_mfma_f32_16x16x32_bf16 v[176:179], v[224:227], v[244:247], v[176:179]
    ds_read_b128 v[220:223], v9 offset:6144
    s_waitcnt lgkmcnt(8)
    v_mfma_f32_16x16x32_bf16 v[148:151], v[228:231], v[240:243], v[148:151]
    ds_read_b128 v[224:227], v9 offset:8192
    v_mul_f32 v114, v33, v14
    v_mfma_f32_16x16x32_bf16 v[180:183], v[228:231], v[244:247], v[180:183]
    v_mul_f32 v115, v33, v15
    s_waitcnt lgkmcnt(8)
    v_mfma_f32_16x16x32_bf16 v[152:155], v[232:235], v[240:243], v[152:155]
    ds_read_b128 v[228:231], v9 offset:10240
    v_mul_f32 v60, 0x44000000, v14
    v_mfma_f32_16x16x32_bf16 v[184:187], v[232:235], v[244:247], v[184:187]
    v_mul_f32 v61, 0x44000000, v15
    s_waitcnt lgkmcnt(8)
    v_mfma_f32_16x16x32_bf16 v[156:159], v[236:239], v[240:243], v[156:159]
    ds_read_b128 v[232:235], v9 offset:12288
    v_exp_f32 v112, v112
    v_mfma_f32_16x16x32_bf16 v[188:191], v[236:239], v[244:247], v[188:191]
    v_fract_f32 v113, v113
    s_waitcnt lgkmcnt(6)
    v_mfma_f32_16x16x32_bf16 v[128:131], v[208:211], v[192:195], v[128:131]
    ds_read_b128 v[236:239], v9 offset:14336
    s_cmp_lg_u32 s48, 0
    s_cbranch_scc1 L_xp1
    s_mov_b64 exec, 1
    global_store_dwordx2 v119, v[116:117], s[46:47] sc1
    s_mov_b64 exec, -1
L_xp1:
    s_waitcnt lgkmcnt(5)
    v_mfma_f32_16x16x32_bf16 v[160:163], v[208:211], v[196:199], v[160:163]
    v_exp_f32 v114, v114
    v_mfma_f32_16x16x32_bf16 v[132:135], v[212:215], v[192:195], v[132:135]
    v_fract_f32 v115, v115
    v_exp_f32 v60, v60
    v_mfma_f32_16x16x32_bf16 v[164:167], v[212:215], v[196:199], v[164:167]
    v_fract_f32_e64 v61, v61
    v_mfma_f32_16x16x32_bf16 v[136:139], v[216:219], v[192:195], v[136:139]
    v_cos_f32 v64, v113
    v_sin_f32 v65, v113
    v_mfma_f32_16x16x32_bf16 v[168:171], v[216:219], v[196:199], v[168:171]
    v_cos_f32_e64 v45, v115
    s_waitcnt lgkmcnt(0)
    s_barrier
    v_mfma_f32_16x16x32_bf16 v[140:143], v[220:223], v[192:195], v[140:143]
    ds_read_b128 v[240:243], v10 offset:16384
    v_sin_f32_e64 v47, v115
    v_mfma_f32_16x16x32_bf16 v[172:175], v[220:223], v[196:199], v[172:175]
    ds_read_b128 v[208:211], v8 offset:16384
    v_mfma_f32_16x16x32_bf16 v[144:147], v[224:227], v[192:195], v[144:147]
    ds_read_b128 v[244:247], v10 offset:24576
    ds_read_b128 v[212:215], v8 offset:18432
    v_mfma_f32_16x16x32_bf16 v[176:179], v[224:227], v[196:199], v[176:179]
    ds_read_b128 v[216:219], v8 offset:20480
    v_mfma_f32_16x16x32_bf16 v[148:151], v[228:231], v[192:195], v[148:151]
    ds_read_b128 v[220:223], v8 offset:22528
    v_cos_f32_e64 v36, v61
    v_mfma_f32_16x16x32_bf16 v[180:183], v[228:231], v[196:199], v[180:183]
    ds_read_b128 v[224:227], v8 offset:24576
    v_mfma_f32_16x16x32_bf16 v[152:155], v[232:235], v[192:195], v[152:155]
    ds_read_b128 v[228:231], v8 offset:26624
    v_sin_f32_e64 v37, v61
    v_mfma_f32_16x16x32_bf16 v[184:187], v[232:235], v[196:199], v[184:187]
    v_mul_f32_e64 v64, v64, v112
    v_mfma_f32_16x16x32_bf16 v[156:159], v[236:239], v[192:195], v[156:159]
    ds_read_b128 v[232:235], v8 offset:28672
    v_mul_f32_e64 v65, v65, v112
    v_mfma_f32_16x16x32_bf16 v[188:191], v[236:239], v[196:199], v[188:191]
    v_mul_f32 v45, v45, v114
    s_waitcnt lgkmcnt(7)
    v_mfma_f32_16x16x32_bf16 v[128:131], v[208:211], v[240:243], v[128:131]
    ds_read_b128 v[236:239], v8 offset:30720
    v_mul_f32 v47, v47, v114
    s_waitcnt lgkmcnt(7)
    v_mfma_f32_16x16x32_bf16 v[160:163], v[208:211], v[244:247], v[160:163]
    v_mul_f32 v36, v36, v60
    s_waitcnt lgkmcnt(6)
    v_mfma_f32_16x16x32_bf16 v[132:135], v[212:215], v[240:243], v[132:135]
    ds_read_b128 v[208:211], v9 offset:16384
    v_mul_f32_e64 v37, v37, v60
    v_mfma_f32_16x16x32_bf16 v[164:167], v[212:215], v[244:247], v[164:167]
    v_mul_f32 v112, v32, v14
    s_waitcnt lgkmcnt(6)
    v_mfma_f32_16x16x32_bf16 v[136:139], v[216:219], v[240:243], v[136:139]
    ds_read_b128 v[212:215], v9 offset:18432
    v_mul_f32_e64 v113, v32, v15
    v_mfma_f32_16x16x32_bf16 v[168:171], v[216:219], v[244:247], v[168:171]
    v_mul_f32 v114, v31, v14
    s_waitcnt lgkmcnt(6)
    v_mfma_f32_16x16x32_bf16 v[140:143], v[220:223], v[240:243], v[140:143]
    ds_read_b128 v[192:195], v11 offset:16384
    v_mul_f32_e64 v115, v31, v15
    v_mfma_f32_16x16x32_bf16 v[172:175], v[220:223], v[244:247], v[172:175]
    ds_read_b128 v[216:219], v9 offset:20480
    s_waitcnt lgkmcnt(7)
    v_mfma_f32_16x16x32_bf16 v[144:147], v[224:227], v[240:243], v[144:147]
    ds_read_b128 v[196:199], v11 offset:24576
    v_mul_f32 v60, 0x41000000, v14
    v_mfma_f32_16x16x32_bf16 v[176:179], v[224:227], v[244:247], v[176:179]
    ds_read_b128 v[220:223], v9 offset:22528
    s_waitcnt lgkmcnt(8)
    v_mfma_f32_16x16x32_bf16 v[148:151], v[228:231], v[240:243], v[148:151]
    ds_read_b128 v[224:227], v9 offset:24576
    v_mul_f32 v61, 0x41000000, v15
    v_mfma_f32_16x16x32_bf16 v[180:183], v[228:231], v[244:247], v[180:183]
    v_exp_f32 v112, v112
    s_waitcnt lgkmcnt(8)
    v_mfma_f32_16x16x32_bf16 v[152:155], v[232:235], v[240:243], v[152:155]
    ds_read_b128 v[228:231], v9 offset:26624
    v_fract_f32_e64 v113, v113
    v_mfma_f32_16x16x32_bf16 v[184:187], v[232:235], v[244:247], v[184:187]
    v_exp_f32 v114, v114
    s_waitcnt lgkmcnt(8)
    v_mfma_f32_16x16x32_bf16 v[156:159], v[236:239], v[240:243], v[156:159]
    ds_read_b128 v[232:235], v9 offset:28672
    v_fract_f32_e64 v115, v115
    v_mfma_f32_16x16x32_bf16 v[188:191], v[236:239], v[244:247], v[188:191]
    v_exp_f32 v60, v60
    s_waitcnt lgkmcnt(6)
    v_mfma_f32_16x16x32_bf16 v[128:131], v[208:211], v[192:195], v[128:131]
    ds_read_b128 v[236:239], v9 offset:30720
    v_fract_f32 v61, v61
    s_waitcnt lgkmcnt(5)
    v_mfma_f32_16x16x32_bf16 v[160:163], v[208:211], v[196:199], v[160:163]
    v_cos_f32_e64 v38, v113
    v_mfma_f32_16x16x32_bf16 v[132:135], v[212:215], v[192:195], v[132:135]
    v_sin_f32 v39, v113
    v_cos_f32 v40, v115
    v_mfma_f32_16x16x32_bf16 v[164:167], v[212:215], v[196:199], v[164:167]
    v_sin_f32_e64 v41, v115
    v_mfma_f32_16x16x32_bf16 v[136:139], v[216:219], v[192:195], v[136:139]
    v_cos_f32 v78, v61
    v_sin_f32 v79, v61
    v_mfma_f32_16x16x32_bf16 v[168:171], v[216:219], v[196:199], v[168:171]
    v_mul_f32_e64 v38, v38, v112
    s_waitcnt lgkmcnt(0)
    s_barrier
    v_mfma_f32_16x16x32_bf16 v[140:143], v[220:223], v[192:195], v[140:143]
    ds_read_b128 v[240:243], v10 offset:32768
    v_mul_f32_e64 v39, v39, v112
    v_mfma_f32_16x16x32_bf16 v[172:175], v[220:223], v[196:199], v[172:175]
    ds_read_b128 v[208:211], v8 offset:32768
    v_mfma_f32_16x16x32_bf16 v[144:147], v[224:227], v[192:195], v[144:147]
    ds_read_b128 v[244:247], v10 offset:40960
    ds_read_b128 v[212:215], v8 offset:34816
    v_mfma_f32_16x16x32_bf16 v[176:179], v[224:227], v[196:199], v[176:179]
    ds_read_b128 v[216:219], v8 offset:36864
    v_mfma_f32_16x16x32_bf16 v[148:151], v[228:231], v[192:195], v[148:151]
    ds_read_b128 v[220:223], v8 offset:38912
    v_mul_f32_e64 v40, v40, v114
    v_mfma_f32_16x16x32_bf16 v[180:183], v[228:231], v[196:199], v[180:183]
    ds_read_b128 v[224:227], v8 offset:40960
    v_mfma_f32_16x16x32_bf16 v[152:155], v[232:235], v[192:195], v[152:155]
    ds_read_b128 v[228:231], v8 offset:43008
    v_mul_f32_e64 v41, v41, v114
    v_mfma_f32_16x16x32_bf16 v[184:187], v[232:235], v[196:199], v[184:187]
    v_mul_f32_e64 v78, v78, v60
    v_mfma_f32_16x16x32_bf16 v[156:159], v[236:239], v[192:195], v[156:159]
    ds_read_b128 v[232:235], v8 offset:45056
    v_mul_f32_e64 v79, v79, v60
    v_mfma_f32_16x16x32_bf16 v[188:191], v[236:239], v[196:199], v[188:191]
    s_waitcnt lgkmcnt(7)
    v_mfma_f32_16x16x32_bf16 v[128:131], v[208:211], v[240:243], v[128:131]
    ds_read_b128 v[236:239], v8 offset:47104
    v_add_f32_e64 v112, -1.0, v64
    s_waitcnt lgkmcnt(7)
    v_mfma_f32_16x16x32_bf16 v[160:163], v[208:211], v[244:247], v[160:163]
    v_mul_f32 v42, v112, v18
    s_waitcnt lgkmcnt(6)
    v_mfma_f32_16x16x32_bf16 v[132:135], v[212:215], v[240:243], v[132:135]
    ds_read_b128 v[208:211], v9 offset:32768
    v_mul_f32_e64 v43, v112, v19
    v_mfma_f32_16x16x32_bf16 v[164:167], v[212:215], v[244:247], v[164:167]
    v_fma_f32 v42, -v65, v19, v42
    s_waitcnt lgkmcnt(6)
    v_mfma_f32_16x16x32_bf16 v[136:139], v[216:219], v[240:243], v[136:139]
    ds_read_b128 v[212:215], v9 offset:34816
    v_fma_f32 v43, v65, v18, v43
    v_mfma_f32_16x16x32_bf16 v[168:171], v[216:219], v[244:247], v[168:171]
    v_mul_f32_e64 v66, v64, v64
    s_waitcnt lgkmcnt(6)
    v_mfma_f32_16x16x32_bf16 v[140:143], v[220:223], v[240:243], v[140:143]
    ds_read_b128 v[192:195], v11 offset:32768
    v_mul_f32_e64 v67, v64, v65
    v_mfma_f32_16x16x32_bf16 v[172:175], v[220:223], v[244:247], v[172:175]
    ds_read_b128 v[216:219], v9 offset:36864
    s_waitcnt lgkmcnt(7)
    v_mfma_f32_16x16x32_bf16 v[144:147], v[224:227], v[240:243], v[144:147]
    ds_read_b128 v[196:199], v11 offset:40960
    v_fma_f32 v66, -v65, v65, v66
    v_mfma_f32_16x16x32_bf16 v[176:179], v[224:227], v[244:247], v[176:179]
    ds_read_b128 v[220:223], v9 offset:38912
    s_waitcnt lgkmcnt(8)
    v_mfma_f32_16x16x32_bf16 v[148:151], v[228:231], v[240:243], v[148:151]
    ds_read_b128 v[224:227], v9 offset:40960
    v_fma_f32 v67, v65, v64, v67
    v_mfma_f32_16x16x32_bf16 v[180:183], v[228:231], v[244:247], v[180:183]
    v_mul_f32 v94, v78, v78
    s_waitcnt lgkmcnt(8)
    v_mfma_f32_16x16x32_bf16 v[152:155], v[232:235], v[240:243], v[152:155]
    ds_read_b128 v[228:231], v9 offset:43008
    v_mul_f32_e64 v95, v78, v79
    v_mfma_f32_16x16x32_bf16 v[184:187], v[232:235], v[244:247], v[184:187]
    v_fma_f32 v94, -v79, v79, v94
    s_waitcnt lgkmcnt(8)
    v_mfma_f32_16x16x32_bf16 v[156:159], v[236:239], v[240:243], v[156:159]
    ds_read_b128 v[232:235], v9 offset:45056
    v_fma_f32 v95, v79, v78, v95
    v_mfma_f32_16x16x32_bf16 v[188:191], v[236:239], v[244:247], v[188:191]
    s_waitcnt lgkmcnt(6)
    v_mfma_f32_16x16x32_bf16 v[128:131], v[208:211], v[192:195], v[128:131]
    ds_read_b128 v[236:239], v9 offset:47104
    v_mul_f32 v68, v66, v64
    s_waitcnt lgkmcnt(5)
    v_mfma_f32_16x16x32_bf16 v[160:163], v[208:211], v[196:199], v[160:163]
    v_mul_f32_e64 v69, v66, v65
    v_mfma_f32_16x16x32_bf16 v[132:135], v[212:215], v[192:195], v[132:135]
    v_fma_f32 v68, -v67, v65, v68
    v_fma_f32 v69, v67, v64, v69
    v_mfma_f32_16x16x32_bf16 v[164:167], v[212:215], v[196:199], v[164:167]
    v_mul_f32_e64 v70, v66, v66
    v_mfma_f32_16x16x32_bf16 v[136:139], v[216:219], v[192:195], v[136:139]
    v_mul_f32_e64 v71, v66, v67
    v_fma_f32 v70, -v67, v67, v70
    v_mfma_f32_16x16x32_bf16 v[168:171], v[216:219], v[196:199], v[168:171]
    v_fma_f32 v71, v67, v66, v71
    s_waitcnt lgkmcnt(0)
    s_barrier
    v_mfma_f32_16x16x32_bf16 v[140:143], v[220:223], v[192:195], v[140:143]
    ds_read_b128 v[240:243], v10 offset:0
    v_mul_f32_e64 v80, v78, v64
    v_mfma_f32_16x16x32_bf16 v[172:175], v[220:223], v[196:199], v[172:175]
    ds_read_b128 v[208:211], v8 offset:0
    v_mfma_f32_16x16x32_bf16 v[144:147], v[224:227], v[192:195], v[144:147]
    ds_read_b128 v[244:247], v10 offset:8192
    ds_read_b128 v[212:215], v8 offset:2048
    v_mfma_f32_16x16x32_bf16 v[176:179], v[224:227], v[196:199], v[176:179]
    ds_read_b128 v[216:219], v8 offset:4096
    v_mfma_f32_16x16x32_bf16 v[148:151], v[228:231], v[192:195], v[148:151]
    ds_read_b128 v[220:223], v8 offset:6144
    v_mul_f32_e64 v81, v78, v65
    v_mfma_f32_16x16x32_bf16 v[180:183], v[228:231], v[196:199], v[180:183]
    ds_read_b128 v[224:227], v8 offset:8192
    v_mfma_f32_16x16x32_bf16 v[152:155], v[232:235], v[192:195], v[152:155]
    ds_read_b128 v[228:231], v8 offset:10240
    v_fma_f32 v80, -v79, v65, v80
    v_mfma_f32_16x16x32_bf16 v[184:187], v[232:235], v[196:199], v[184:187]
    v_fma_f32 v81, v79, v64, v81
    v_mfma_f32_16x16x32_bf16 v[156:159], v[236:239], v[192:195], v[156:159]
    ds_read_b128 v[232:235], v8 offset:12288
    v_mul_f32_e64 v82, v78, v66
    v_mfma_f32_16x16x32_bf16 v[188:191], v[236:239], v[196:199], v[188:191]
    s_waitcnt lgkmcnt(7)
    v_mfma_f32_16x16x32_bf16 v[128:131], v[208:211], v[240:243], v[128:131]
    ds_read_b128 v[236:239], v8 offset:14336
    v_mul_f32_e64 v83, v78, v67
    s_waitcnt lgkmcnt(7)
    v_mfma_f32_16x16x32_bf16 v[160:163], v[208:211], v[244:247], v[160:163]
    v_fma_f32 v82, -v79, v67, v82
    s_waitcnt lgkmcnt(6)
    v_mfma_f32_16x16x32_bf16 v[132:135], v[212:215], v[240:243], v[132:135]
    ds_read_b128 v[208:211], v9 offset:0
    v_fma_f32 v83, v79, v66, v83
    v_mfma_f32_16x16x32_bf16 v[164:167], v[212:215], v[244:247], v[164:167]
    v_mul_f32_e64 v72, v70, v64
    s_waitcnt lgkmcnt(6)
    v_mfma_f32_16x16x32_bf16 v[136:139], v[216:219], v[240:243], v[136:139]
    ds_read_b128 v[212:215], v9 offset:2048
    v_mul_f32_e64 v73, v70, v65
    v_mfma_f32_16x16x32_bf16 v[168:171], v[216:219], v[244:247], v[168:171]
    v_fma_f32 v72, -v71, v65, v72
    s_waitcnt lgkmcnt(6)
    v_mfma_f32_16x16x32_bf16 v[140:143], v[220:223], v[240:243], v[140:143]
    ds_read_b128 v[192:195], v11 offset:0
    v_fma_f32 v73, v71, v64, v73
    v_mfma_f32_16x16x32_bf16 v[172:175], v[220:223], v[244:247], v[172:175]
    ds_read_b128 v[216:219], v9 offset:4096
    s_waitcnt lgkmcnt(7)
    v_mfma_f32_16x16x32_bf16 v[144:147], v[224:227], v[240:243], v[144:147]
    ds_read_b128 v[196:199], v11 offset:8192
    v_mul_f32_e64 v74, v70, v66
    v_mfma_f32_16x16x32_bf16 v[176:179], v[224:227], v[244:247], v[176:179]
    ds_read_b128 v[220:223], v9 offset:6144
    s_waitcnt lgkmcnt(8)
    v_mfma_f32_16x16x32_bf16 v[148:151], v[228:231], v[240:243], v[148:151]
    ds_read_b128 v[224:227], v9 offset:8192
    v_mul_f32 v75, v70, v67
    v_mfma_f32_16x16x32_bf16 v[180:183], v[228:231], v[244:247], v[180:183]
    v_fma_f32 v74, -v71, v67, v74
    s_waitcnt lgkmcnt(8)
    v_mfma_f32_16x16x32_bf16 v[152:155], v[232:235], v[240:243], v[152:155]
    ds_read_b128 v[228:231], v9 offset:10240
    v_fma_f32 v75, v71, v66, v75
    v_mfma_f32_16x16x32_bf16 v[184:187], v[232:235], v[244:247], v[184:187]
    v_mul_f32_e64 v76, v70, v68
    s_waitcnt lgkmcnt(8)
    v_mfma_f32_16x16x32_bf16 v[156:159], v[236:239], v[240:243], v[156:159]
    ds_read_b128 v[232:235], v9 offset:12288
    v_mul_f32_e64 v77, v70, v69
    v_mfma_f32_16x16x32_bf16 v[188:191], v[236:239], v[244:247], v[188:191]
    s_waitcnt lgkmcnt(6)
    v_mfma_f32_16x16x32_bf16 v[128:131], v[208:211], v[192:195], v[128:131]
    ds_read_b128 v[236:239], v9 offset:14336
    v_fma_f32 v76, -v71, v69, v76
    s_waitcnt lgkmcnt(5)
    v_mfma_f32_16x16x32_bf16 v[160:163], v[208:211], v[196:199], v[160:163]
    v_fma_f32 v77, v71, v68, v77
    v_mfma_f32_16x16x32_bf16 v[132:135], v[212:215], v[192:195], v[132:135]
    v_mul_f32 v84, v78, v68
    v_mul_f32 v85, v78, v69
    v_mfma_f32_16x16x32_bf16 v[164:167], v[212:215], v[196:199], v[164:167]
    v_fma_f32 v84, -v79, v69, v84
    v_mfma_f32_16x16x32_bf16 v[136:139], v[216:219], v[192:195], v[136:139]
    v_fma_f32 v85, v79, v68, v85
    v_mul_f32_e64 v86, v78, v70
    v_mfma_f32_16x16x32_bf16 v[168:171], v[216:219], v[196:199], v[168:171]
    v_mul_f32_e64 v87, v78, v71
    s_waitcnt lgkmcnt(0)
    s_barrier
    v_mfma_f32_16x16x32_bf16 v[140:143], v[220:223], v[192:195], v[140:143]
    ds_read_b128 v[240:243], v10 offset:16384
    v_fma_f32 v86, -v79, v71, v86
    v_mfma_f32_16x16x32_bf16 v[172:175], v[220:223], v[196:199], v[172:175]
    ds_read_b128 v[208:211], v8 offset:16384
    v_mfma_f32_16x16x32_bf16 v[144:147], v[224:227], v[192:195], v[144:147]
    ds_read_b128 v[244:247], v10 offset:24576
    ds_read_b128 v[212:215], v8 offset:18432
    v_mfma_f32_16x16x32_bf16 v[176:179], v[224:227], v[196:199], v[176:179]
    ds_read_b128 v[216:219], v8 offset:20480
    v_mfma_f32_16x16x32_bf16 v[148:151], v[228:231], v[192:195], v[148:151]
    ds_read_b128 v[220:223], v8 offset:22528
    v_fma_f32 v87, v79, v70, v87
    v_mfma_f32_16x16x32_bf16 v[180:183], v[228:231], v[196:199], v[180:183]
    ds_read_b128 v[224:227], v8 offset:24576
    v_mfma_f32_16x16x32_bf16 v[152:155], v[232:235], v[192:195], v[152:155]
    ds_read_b128 v[228:231], v8 offset:26624
    v_mul_f32_e64 v88, v78, v72
    v_mfma_f32_16x16x32_bf16 v[184:187], v[232:235], v[196:199], v[184:187]
    v_mul_f32_e64 v89, v78, v73
    v_mfma_f32_16x16x32_bf16 v[156:159], v[236:239], v[192:195], v[156:159]
    ds_read_b128 v[232:235], v8 offset:28672
    v_fma_f32 v88, -v79, v73, v88
    v_mfma_f32_16x16x32_bf16 v[188:191], v[236:239], v[196:199], v[188:191]
    s_waitcnt lgkmcnt(7)
    v_mfma_f32_16x16x32_bf16 v[128:131], v[208:211], v[240:243], v[128:131]
    ds_read_b128 v[236:239], v8 offset:30720
    v_fma_f32 v89, v79, v72, v89
    s_waitcnt lgkmcnt(7)
    v_mfma_f32_16x16x32_bf16 v[160:163], v[208:211], v[244:247], v[160:163]
    v_mul_f32 v90, v78, v74
    s_waitcnt lgkmcnt(6)
    v_mfma_f32_16x16x32_bf16 v[132:135], v[212:215], v[240:243], v[132:135]
    ds_read_b128 v[208:211], v9 offset:16384
    v_mul_f32_e64 v91, v78, v75
    v_mfma_f32_16x16x32_bf16 v[164:167], v[212:215], v[244:247], v[164:167]
    v_fma_f32 v90, -v79, v75, v90
    s_waitcnt lgkmcnt(6)
    v_mfma_f32_16x16x32_bf16 v[136:139], v[216:219], v[240:243], v[136:139]
    ds_read_b128 v[212:215], v9 offset:18432
    v_fma_f32 v91, v79, v74, v91
    v_mfma_f32_16x16x32_bf16 v[168:171], v[216:219], v[244:247], v[168:171]
    v_mul_f32_e64 v92, v78, v76
    s_waitcnt lgkmcnt(6)
    v_mfma_f32_16x16x32_bf16 v[140:143], v[220:223], v[240:243], v[140:143]
    ds_read_b128 v[192:195], v11 offset:16384
    v_mul_f32_e64 v93, v78, v77
    v_mfma_f32_16x16x32_bf16 v[172:175], v[220:223], v[244:247], v[172:175]
    ds_read_b128 v[216:219], v9 offset:20480
    s_waitcnt lgkmcnt(7)
    v_mfma_f32_16x16x32_bf16 v[144:147], v[224:227], v[240:243], v[144:147]
    ds_read_b128 v[196:199], v11 offset:24576
    v_fma_f32 v92, -v79, v77, v92
    v_mfma_f32_16x16x32_bf16 v[176:179], v[224:227], v[244:247], v[176:179]
    ds_read_b128 v[220:223], v9 offset:22528
    s_waitcnt lgkmcnt(8)
    v_mfma_f32_16x16x32_bf16 v[148:151], v[228:231], v[240:243], v[148:151]
    ds_read_b128 v[224:227], v9 offset:24576
    v_fma_f32 v93, v79, v76, v93
    v_mfma_f32_16x16x32_bf16 v[180:183], v[228:231], v[244:247], v[180:183]
    v_mul_f32 v34, v94, v94
    s_waitcnt lgkmcnt(8)
    v_mfma_f32_16x16x32_bf16 v[152:155], v[232:235], v[240:243], v[152:155]
    ds_read_b128 v[228:231], v9 offset:26624
    v_mul_f32_e64 v35, v94, v95
    v_mfma_f32_16x16x32_bf16 v[184:187], v[232:235], v[244:247], v[184:187]
    v_fma_f32 v34, -v95, v95, v34
    s_waitcnt lgkmcnt(8)
    v_mfma_f32_16x16x32_bf16 v[156:159], v[236:239], v[240:243], v[156:159]
    ds_read_b128 v[232:235], v9 offset:28672
    v_fma_f32 v35, v95, v94, v35
    v_mfma_f32_16x16x32_bf16 v[188:191], v[236:239], v[244:247], v[188:191]
    s_waitcnt lgkmcnt(6)
    v_mfma_f32_16x16x32_bf16 v[128:131], v[208:211], v[192:195], v[128:131]
    ds_read_b128 v[236:239], v9 offset:30720
    v_mul_f32 v44, v94, v45
    s_waitcnt lgkmcnt(5)
    v_mfma_f32_16x16x32_bf16 v[160:163], v[208:211], v[196:199], v[160:163]
    v_mul_f32_e64 v46, v94, v47
    v_mfma_f32_16x16x32_bf16 v[132:135], v[212:215], v[192:195], v[132:135]
    v_fma_f32 v44, -v95, v47, v44
    v_fma_f32 v46, v95, v45, v46
    v_mfma_f32_16x16x32_bf16 v[164:167], v[212:215], v[196:199], v[164:167]
    v_mul_f32_e64 v48, v40, v42
    v_mfma_f32_16x16x32_bf16 v[136:139], v[216:219], v[192:195], v[136:139]
    v_mul_f32_e64 v50, v40, v43
    v_fma_f32 v48, -v41, v43, v48
    v_mfma_f32_16x16x32_bf16 v[168:171], v[216:219], v[196:199], v[168:171]
    v_fma_f32 v50, v41, v42, v50
    s_waitcnt lgkmcnt(0)
    s_barrier
    v_mfma_f32_16x16x32_bf16 v[140:143], v[220:223], v[192:195], v[140:143]
    ds_read_b128 v[240:243], v10 offset:32768
    v_mul_f32_e64 v49, v94, v48
    v_mfma_f32_16x16x32_bf16 v[172:175], v[220:223], v[196:199], v[172:175]
    ds_read_b128 v[208:211], v8 offset:32768
    v_mfma_f32_16x16x32_bf16 v[144:147], v[224:227], v[192:195], v[144:147]
    ds_read_b128 v[244:247], v10 offset:40960
    ds_read_b128 v[212:215], v8 offset:34816
    v_mfma_f32_16x16x32_bf16 v[176:179], v[224:227], v[196:199], v[176:179]
    ds_read_b128 v[216:219], v8 offset:36864
    v_mfma_f32_16x16x32_bf16 v[148:151], v[228:231], v[192:195], v[148:151]
    ds_read_b128 v[220:223], v8 offset:38912
    v_mul_f32_e64 v51, v94, v50
    v_mfma_f32_16x16x32_bf16 v[180:183], v[228:231], v[196:199], v[180:183]
    ds_read_b128 v[224:227], v8 offset:40960
    v_mfma_f32_16x16x32_bf16 v[152:155], v[232:235], v[192:195], v[152:155]
    ds_read_b128 v[228:231], v8 offset:43008
    v_fma_f32 v49, -v95, v50, v49
    v_mfma_f32_16x16x32_bf16 v[184:187], v[232:235], v[196:199], v[184:187]
    v_fma_f32 v51, v95, v48, v51
    v_mfma_f32_16x16x32_bf16 v[156:159], v[236:239], v[192:195], v[156:159]
    ds_read_b128 v[232:235], v8 offset:45056
    v_cndmask_b32 v40, v34, 1.0, s[64:65]
    v_mfma_f32_16x16x32_bf16 v[188:191], v[236:239], v[196:199], v[188:191]
    s_waitcnt lgkmcnt(7)
    v_mfma_f32_16x16x32_bf16 v[128:131], v[208:211], v[240:243], v[128:131]
    ds_read_b128 v[236:239], v8 offset:47104
    v_cndmask_b32 v41, v35, 0, s[64:65]
    s_waitcnt lgkmcnt(7)
    v_mfma_f32_16x16x32_bf16 v[160:163], v[208:211], v[244:247], v[160:163]
    v_cndmask_b32 v52, 0, v122, s[24:25]
    s_waitcnt lgkmcnt(6)
    v_mfma_f32_16x16x32_bf16 v[132:135], v[212:215], v[240:243], v[132:135]
    ds_read_b128 v[208:211], v9 offset:32768
    v_cndmask_b32 v53, 0, v123, s[24:25]
    v_mfma_f32_16x16x32_bf16 v[164:167], v[212:215], v[244:247], v[164:167]
    v_cndmask_b32 v54, 0, v122, s[26:27]
    s_waitcnt lgkmcnt(6)
    v_mfma_f32_16x16x32_bf16 v[136:139], v[216:219], v[240:243], v[136:139]
    ds_read_b128 v[212:215], v9 offset:34816
    v_cndmask_b32 v55, 0, v123, s[26:27]
    v_mfma_f32_16x16x32_bf16 v[168:171], v[216:219], v[244:247], v[168:171]
    v_cndmask_b32 v56, 0, v122, s[28:29]
    s_waitcnt lgkmcnt(6)
    v_mfma_f32_16x16x32_bf16 v[140:143], v[220:223], v[240:243], v[140:143]
    ds_read_b128 v[192:195], v11 offset:32768
    v_cndmask_b32 v57, 0, v123, s[28:29]
    v_mfma_f32_16x16x32_bf16 v[172:175], v[220:223], v[244:247], v[172:175]
    ds_read_b128 v[216:219], v9 offset:36864
    s_waitcnt lgkmcnt(7)
    v_mfma_f32_16x16x32_bf16 v[144:147], v[224:227], v[240:243], v[144:147]
    ds_read_b128 v[196:199], v11 offset:40960
    v_cndmask_b32 v58, 0, v122, s[30:31]
    v_mfma_f32_16x16x32_bf16 v[176:179], v[224:227], v[244:247], v[176:179]
    ds_read_b128 v[220:223], v9 offset:38912
    s_waitcnt lgkmcnt(8)
    v_mfma_f32_16x16x32_bf16 v[148:151], v[228:231], v[240:243], v[148:151]
    ds_read_b128 v[224:227], v9 offset:40960
    v_cndmask_b32 v59, 0, v123, s[30:31]
    v_mfma_f32_16x16x32_bf16 v[180:183], v[228:231], v[244:247], v[180:183]
    s_waitcnt lgkmcnt(8)
    v_mfma_f32_16x16x32_bf16 v[152:155], v[232:235], v[240:243], v[152:155]
    ds_read_b128 v[228:231], v9 offset:43008
    v_mfma_f32_16x16x32_bf16 v[184:187], v[232:235], v[244:247], v[184:187]
    s_waitcnt lgkmcnt(8)
    v_mfma_f32_16x16x32_bf16 v[156:159], v[236:239], v[240:243], v[156:159]
    ds_read_b128 v[232:235], v9 offset:45056
    v_mfma_f32_16x16x32_bf16 v[188:191], v[236:239], v[244:247], v[188:191]
    s_waitcnt lgkmcnt(6)
    v_mfma_f32_16x16x32_bf16 v[128:131], v[208:211], v[192:195], v[128:131]
    ds_read_b128 v[236:239], v9 offset:47104
    s_waitcnt lgkmcnt(5)
    v_mfma_f32_16x16x32_bf16 v[160:163], v[208:211], v[196:199], v[160:163]
    v_mfma_f32_16x16x32_bf16 v[132:135], v[212:215], v[192:195], v[132:135]
    v_mfma_f32_16x16x32_bf16 v[164:167], v[212:215], v[196:199], v[164:167]
    v_mfma_f32_16x16x32_bf16 v[136:139], v[216:219], v[192:195], v[136:139]
    v_mfma_f32_16x16x32_bf16 v[168:171], v[216:219], v[196:199], v[168:171]
    s_waitcnt lgkmcnt(4)
    v_mfma_f32_16x16x32_bf16 v[140:143], v[220:223], v[192:195], v[140:143]
    v_mfma_f32_16x16x32_bf16 v[172:175], v[220:223], v[196:199], v[172:175]
    s_waitcnt lgkmcnt(3)
    v_mfma_f32_16x16x32_bf16 v[144:147], v[224:227], v[192:195], v[144:147]
    v_mfma_f32_16x16x32_bf16 v[176:179], v[224:227], v[196:199], v[176:179]
    s_waitcnt lgkmcnt(2)
    v_mfma_f32_16x16x32_bf16 v[148:151], v[228:231], v[192:195], v[148:151]
    v_mfma_f32_16x16x32_bf16 v[180:183], v[228:231], v[196:199], v[180:183]
    s_waitcnt lgkmcnt(1)
    v_mfma_f32_16x16x32_bf16 v[152:155], v[232:235], v[192:195], v[152:155]
    v_mfma_f32_16x16x32_bf16 v[184:187], v[232:235], v[196:199], v[184:187]
    s_waitcnt lgkmcnt(0)
    v_mfma_f32_16x16x32_bf16 v[156:159], v[236:239], v[192:195], v[156:159]
    v_mfma_f32_16x16x32_bf16 v[188:191], v[236:239], v[196:199], v[188:191]
    v_pk_fma_f32 v[130:131], v[64:65], v[128:129], v[130:131] op_sel:[0,0,0] op_sel_hi:[0,1,1]
    v_pk_fma_f32 v[162:163], v[64:65], v[160:161], v[162:163] op_sel:[0,0,0] op_sel_hi:[0,1,1]
    v_pk_fma_f32 v[130:131], v[64:65], v[160:161], v[130:131] op_sel:[1,0,0] op_sel_hi:[1,1,1] neg_lo:[1,0,0] neg_hi:[1,0,0]
    v_pk_fma_f32 v[162:163], v[64:65], v[128:129], v[162:163] op_sel:[1,0,0] op_sel_hi:[1,1,1]
    v_pk_fma_f32 v[132:133], v[64:65], v[130:131], v[132:133] op_sel:[0,0,0] op_sel_hi:[0,1,1]
    v_pk_fma_f32 v[164:165], v[64:65], v[162:163], v[164:165] op_sel:[0,0,0] op_sel_hi:[0,1,1]
    v_pk_fma_f32 v[132:133], v[64:65], v[162:163], v[132:133] op_sel:[1,0,0] op_sel_hi:[1,1,1] neg_lo:[1,0,0] neg_hi:[1,0,0]
    v_pk_fma_f32 v[164:165], v[64:65], v[130:131], v[164:165] op_sel:[1,0,0] op_sel_hi:[1,1,1]
    v_pk_fma_f32 v[134:135], v[64:65], v[132:133], v[134:135] op_sel:[0,0,0] op_sel_hi:[0,1,1]
    v_pk_fma_f32 v[166:167], v[64:65], v[164:165], v[166:167] op_sel:[0,0,0] op_sel_hi:[0,1,1]
    v_pk_fma_f32 v[134:135], v[64:65], v[164:165], v[134:135] op_sel:[1,0,0] op_sel_hi:[1,1,1] neg_lo:[1,0,0] neg_hi:[1,0,0]
    v_pk_fma_f32 v[166:167], v[64:65], v[132:133], v[166:167] op_sel:[1,0,0] op_sel_hi:[1,1,1]
    v_pk_fma_f32 v[136:137], v[64:65], v[134:135], v[136:137] op_sel:[0,0,0] op_sel_hi:[0,1,1]
    v_pk_fma_f32 v[168:169], v[64:65], v[166:167], v[168:169] op_sel:[0,0,0] op_sel_hi:[0,1,1]
    v_pk_fma_f32 v[136:137], v[64:65], v[166:167], v[136:137] op_sel:[1,0,0] op_sel_hi:[1,1,1] neg_lo:[1,0,0] neg_hi:[1,0,0]
    v_pk_fma_f32 v[168:169], v[64:65], v[134:135], v[168:169] op_sel:[1,0,0] op_sel_hi:[1,1,1]
    v_pk_fma_f32 v[138:139], v[64:65], v[136:137], v[138:139] op_sel:[0,0,0] op_sel_hi:[0,1,1]
    v_pk_fma_f32 v[170:171], v[64:65], v[168:169], v[170:171] op_sel:[0,0,0] op_sel_hi:[0,1,1]
    v_pk_fma_f32 v[138:139], v[64:65], v[168:169], v[138:139] op_sel:[1,0,0] op_sel_hi:[1,1,1] neg_lo:[1,0,0] neg_hi:[1,0,0]
    v_pk_fma_f32 v[170:171], v[64:65], v[136:137], v[170:171] op_sel:[1,0,0] op_sel_hi:[1,1,1]
    v_pk_fma_f32 v[140:141], v[64:65], v[138:139], v[140:141] op_sel:[0,0,0] op_sel_hi:[0,1,1]
    v_pk_fma_f32 v[172:173], v[64:65], v[170:171], v[172:173] op_sel:[0,0,0] op_sel_hi:[0,1,1]
    v_pk_fma_f32 v[140:141], v[64:65], v[170:171], v[140:141] op_sel:[1,0,0] op_sel_hi:[1,1,1] neg_lo:[1,0,0] neg_hi:[1,0,0]
    v_pk_fma_f32 v[172:173], v[64:65], v[138:139], v[172:173] op_sel:[1,0,0] op_sel_hi:[1,1,1]
    v_pk_fma_f32 v[142:143], v[64:65], v[140:141], v[142:143] op_sel:[0,0,0] op_sel_hi:[0,1,1]
    v_pk_fma_f32 v[174:175], v[64:65], v[172:173], v[174:175] op_sel:[0,0,0] op_sel_hi:[0,1,1]
    v_pk_fma_f32 v[142:143], v[64:65], v[172:173], v[142:143] op_sel:[1,0,0] op_sel_hi:[1,1,1] neg_lo:[1,0,0] neg_hi:[1,0,0]
    v_pk_fma_f32 v[174:175], v[64:65], v[140:141], v[174:175] op_sel:[1,0,0] op_sel_hi:[1,1,1]
    v_pk_fma_f32 v[144:145], v[64:65], v[142:143], v[144:145] op_sel:[0,0,0] op_sel_hi:[0,1,1]
    v_pk_fma_f32 v[176:177], v[64:65], v[174:175], v[176:177] op_sel:[0,0,0] op_sel_hi:[0,1,1]
    v_pk_fma_f32 v[144:145], v[64:65], v[174:175], v[144:145] op_sel:[1,0,0] op_sel_hi:[1,1,1] neg_lo:[1,0,0] neg_hi:[1,0,0]
    v_pk_fma_f32 v[176:177], v[64:65], v[142:143], v[176:177] op_sel:[1,0,0] op_sel_hi:[1,1,1]
    v_pk_fma_f32 v[146:147], v[64:65], v[144:145], v[146:147] op_sel:[0,0,0] op_sel_hi:[0,1,1]
    v_pk_fma_f32 v[178:179], v[64:65], v[176:177], v[178:179] op_sel:[0,0,0] op_sel_hi:[0,1,1]
    v_pk_fma_f32 v[146:147], v[64:65], v[176:177], v[146:147] op_sel:[1,0,0] op_sel_hi:[1,1,1] neg_lo:[1,0,0] neg_hi:[1,0,0]
    v_pk_fma_f32 v[178:179], v[64:65], v[144:145], v[178:179] op_sel:[1,0,0] op_sel_hi:[1,1,1]
    v_pk_fma_f32 v[148:149], v[64:65], v[146:147], v[148:149] op_sel:[0,0,0] op_sel_hi:[0,1,1]
    v_pk_fma_f32 v[180:181], v[64:65], v[178:179], v[180:181] op_sel:[0,0,0] op_sel_hi:[0,1,1]
    v_pk_fma_f32 v[148:149], v[64:65], v[178:179], v[148:149] op_sel:[1,0,0] op_sel_hi:[1,1,1] neg_lo:[1,0,0] neg_hi:[1,0,0]
    v_pk_fma_f32 v[180:181], v[64:65], v[146:147], v[180:181] op_sel:[1,0,0] op_sel_hi:[1,1,1]
    v_pk_fma_f32 v[150:151], v[64:65], v[148:149], v[150:151] op_sel:[0,0,0] op_sel_hi:[0,1,1]
    v_pk_fma_f32 v[182:183], v[64:65], v[180:181], v[182:183] op_sel:[0,0,0] op_sel_hi:[0,1,1]
    v_pk_fma_f32 v[150:151], v[64:65], v[180:181], v[150:151] op_sel:[1,0,0] op_sel_hi:[1,1,1] neg_lo:[1,0,0] neg_hi:[1,0,0]
    v_pk_fma_f32 v[182:183], v[64:65], v[148:149], v[182:183] op_sel:[1,0,0] op_sel_hi:[1,1,1]
    v_pk_fma_f32 v[152:153], v[64:65], v[150:151], v[152:153] op_sel:[0,0,0] op_sel_hi:[0,1,1]
    v_pk_fma_f32 v[184:185], v[64:65], v[182:183], v[184:185] op_sel:[0,0,0] op_sel_hi:[0,1,1]
    v_pk_fma_f32 v[152:153], v[64:65], v[182:183], v[152:153] op_sel:[1,0,0] op_sel_hi:[1,1,1] neg_lo:[1,0,0] neg_hi:[1,0,0]
    v_pk_fma_f32 v[184:185], v[64:65], v[150:151], v[184:185] op_sel:[1,0,0] op_sel_hi:[1,1,1]
    v_pk_fma_f32 v[154:155], v[64:65], v[152:153], v[154:155] op_sel:[0,0,0] op_sel_hi:[0,1,1]
    v_pk_fma_f32 v[186:187], v[64:65], v[184:185], v[186:187] op_sel:[0,0,0] op_sel_hi:[0,1,1]
    v_pk_fma_f32 v[154:155], v[64:65], v[184:185], v[154:155] op_sel:[1,0,0] op_sel_hi:[1,1,1] neg_lo:[1,0,0] neg_hi:[1,0,0]
    v_pk_fma_f32 v[186:187], v[64:65], v[152:153], v[186:187] op_sel:[1,0,0] op_sel_hi:[1,1,1]
    v_pk_fma_f32 v[156:157], v[64:65], v[154:155], v[156:157] op_sel:[0,0,0] op_sel_hi:[0,1,1]
    v_pk_fma_f32 v[188:189], v[64:65], v[186:187], v[188:189] op_sel:[0,0,0] op_sel_hi:[0,1,1]
    v_pk_fma_f32 v[156:157], v[64:65], v[186:187], v[156:157] op_sel:[1,0,0] op_sel_hi:[1,1,1] neg_lo:[1,0,0] neg_hi:[1,0,0]
    v_pk_fma_f32 v[188:189], v[64:65], v[154:155], v[188:189] op_sel:[1,0,0] op_sel_hi:[1,1,1]
    v_pk_fma_f32 v[158:159], v[64:65], v[156:157], v[158:159] op_sel:[0,0,0] op_sel_hi:[0,1,1]
    v_pk_fma_f32 v[190:191], v[64:65], v[188:189], v[190:191] op_sel:[0,0,0] op_sel_hi:[0,1,1]
    v_pk_fma_f32 v[158:159], v[64:65], v[188:189], v[158:159] op_sel:[1,0,0] op_sel_hi:[1,1,1] neg_lo:[1,0,0] neg_hi:[1,0,0]
    v_pk_fma_f32 v[190:191], v[64:65], v[156:157], v[190:191] op_sel:[1,0,0] op_sel_hi:[1,1,1]
    v_pk_mul_f32 v[208:209], v[158:159], v[44:45]
    v_pk_mul_f32 v[210:211], v[190:191], v[44:45]
    v_pk_fma_f32 v[208:209], v[190:191], v[46:47], v[208:209] neg_lo:[1,0,0] neg_hi:[1,0,0]
    v_pk_fma_f32 v[210:211], v[158:159], v[46:47], v[210:211]
    v_add_f32 v208, v208, v209
    v_add_f32 v209, v210, v211
    s_nop 1
    v_permlane32_swap_b32 v208, v209
    v_add_f32 v210, v208, v209
    v_add_f32 v211, v208, v209
    s_nop 1
    v_permlane16_swap_b32 v210, v211
    v_add_f32 v120, v210, v211
    v_add_f32 v121, v210, v211
    s_nop 1
    v_permlane32_swap_b32 v120, v121
    s_mov_b64 exec, 0xffff
    global_store_dwordx4 v17, v[120:123], s[46:47] sc1
    s_mov_b64 exec, -1
    global_load_dwordx2 v[228:229], v118, s[46:47] sc1
    s_mov_b32 exec_lo, 0xff00ff
    s_mov_b32 exec_hi, 0xff00ff
    global_store_dword v106, v108, s[46:47] sc1
    s_mov_b64 exec, -1
    v_pk_mul_f32 v[208:209], v[42:43], v[128:129] op_sel:[0,0] op_sel_hi:[0,1]
    v_pk_mul_f32 v[210:211], v[42:43], v[128:129] op_sel:[1,0] op_sel_hi:[1,1]
    v_pk_fma_f32 v[128:129], v[42:43], v[160:161], v[208:209] op_sel:[1,0,0] op_sel_hi:[1,1,1] neg_lo:[1,0,0] neg_hi:[1,0,0]
    v_pk_fma_f32 v[160:161], v[42:43], v[160:161], v[210:211] op_sel:[0,0,0] op_sel_hi:[0,1,1]
    v_pk_mul_f32 v[212:213], v[42:43], v[130:131] op_sel:[0,0] op_sel_hi:[0,1]
    v_pk_mul_f32 v[214:215], v[42:43], v[130:131] op_sel:[1,0] op_sel_hi:[1,1]
    v_pk_fma_f32 v[130:131], v[42:43], v[162:163], v[212:213] op_sel:[1,0,0] op_sel_hi:[1,1,1] neg_lo:[1,0,0] neg_hi:[1,0,0]
    v_pk_fma_f32 v[162:163], v[42:43], v[162:163], v[214:215] op_sel:[0,0,0] op_sel_hi:[0,1,1]
    v_pk_mul_f32 v[208:209], v[42:43], v[132:133] op_sel:[0,0] op_sel_hi:[0,1]
    v_pk_mul_f32 v[210:211], v[42:43], v[132:133] op_sel:[1,0] op_sel_hi:[1,1]
    v_pk_fma_f32 v[132:133], v[42:43], v[164:165], v[208:209] op_sel:[1,0,0] op_sel_hi:[1,1,1] neg_lo:[1,0,0] neg_hi:[1,0,0]
    v_pk_fma_f32 v[164:165], v[42:43], v[164:165], v[210:211] op_sel:[0,0,0] op_sel_hi:[0,1,1]
    v_pk_mul_f32 v[212:213], v[42:43], v[134:135] op_sel:[0,0] op_sel_hi:[0,1]
    v_pk_mul_f32 v[214:215], v[42:43], v[134:135] op_sel:[1,0] op_sel_hi:[1,1]
    v_pk_fma_f32 v[134:135], v[42:43], v[166:167], v[212:213] op_sel:[1,0,0] op_sel_hi:[1,1,1] neg_lo:[1,0,0] neg_hi:[1,0,0]
    v_pk_fma_f32 v[166:167], v[42:43], v[166:167], v[214:215] op_sel:[0,0,0] op_sel_hi:[0,1,1]
    v_pk_mul_f32 v[208:209], v[42:43], v[136:137] op_sel:[0,0] op_sel_hi:[0,1]
    v_pk_mul_f32 v[210:211], v[42:43], v[136:137] op_sel:[1,0] op_sel_hi:[1,1]
    v_pk_fma_f32 v[136:137], v[42:43], v[168:169], v[208:209] op_sel:[1,0,0] op_sel_hi:[1,1,1] neg_lo:[1,0,0] neg_hi:[1,0,0]
    v_pk_fma_f32 v[168:169], v[42:43], v[168:169], v[210:211] op_sel:[0,0,0] op_sel_hi:[0,1,1]
    v_pk_mul_f32 v[212:213], v[42:43], v[138:139] op_sel:[0,0] op_sel_hi:[0,1]
    v_pk_mul_f32 v[214:215], v[42:43], v[138:139] op_sel:[1,0] op_sel_hi:[1,1]
    v_pk_fma_f32 v[138:139], v[42:43], v[170:171], v[212:213] op_sel:[1,0,0] op_sel_hi:[1,1,1] neg_lo:[1,0,0] neg_hi:[1,0,0]
    v_pk_fma_f32 v[170:171], v[42:43], v[170:171], v[214:215] op_sel:[0,0,0] op_sel_hi:[0,1,1]
    v_pk_mul_f32 v[208:209], v[42:43], v[140:141] op_sel:[0,0] op_sel_hi:[0,1]
    v_pk_mul_f32 v[210:211], v[42:43], v[140:141] op_sel:[1,0] op_sel_hi:[1,1]
    v_pk_fma_f32 v[140:141], v[42:43], v[172:173], v[208:209] op_sel:[1,0,0] op_sel_hi:[1,1,1] neg_lo:[1,0,0] neg_hi:[1,0,0]
    v_pk_fma_f32 v[172:173], v[42:43], v[172:173], v[210:211] op_sel:[0,0,0] op_sel_hi:[0,1,1]
    v_pk_mul_f32 v[212:213], v[42:43], v[142:143] op_sel:[0,0] op_sel_hi:[0,1]
    v_pk_mul_f32 v[214:215], v[42:43], v[142:143] op_sel:[1,0] op_sel_hi:[1,1]
    v_pk_fma_f32 v[142:143], v[42:43], v[174:175], v[212:213] op_sel:[1,0,0] op_sel_hi:[1,1,1] neg_lo:[1,0,0] neg_hi:[1,0,0]
    v_pk_fma_f32 v[174:175], v[42:43], v[174:175], v[214:215] op_sel:[0,0,0] op_sel_hi:[0,1,1]
    v_pk_mul_f32 v[208:209], v[42:43], v[144:145] op_sel:[0,0] op_sel_hi:[0,1]
    v_pk_mul_f32 v[210:211], v[42:43], v[144:145] op_sel:[1,0] op_sel_hi:[1,1]
    v_pk_fma_f32 v[144:145], v[42:43], v[176:177], v[208:209] op_sel:[1,0,0] op_sel_hi:[1,1,1] neg_lo:[1,0,0] neg_hi:[1,0,0]
    v_pk_fma_f32 v[176:177], v[42:43], v[176:177], v[210:211] op_sel:[0,0,0] op_sel_hi:[0,1,1]
    v_pk_mul_f32 v[212:213], v[42:43], v[146:147] op_sel:[0,0] op_sel_hi:[0,1]
    v_pk_mul_f32 v[214:215], v[42:43], v[146:147] op_sel:[1,0] op_sel_hi:[1,1]
    v_pk_fma_f32 v[146:147], v[42:43], v[178:179], v[212:213] op_sel:[1,0,0] op_sel_hi:[1,1,1] neg_lo:[1,0,0] neg_hi:[1,0,0]
    v_pk_fma_f32 v[178:179], v[42:43], v[178:179], v[214:215] op_sel:[0,0,0] op_sel_hi:[0,1,1]
    v_pk_mul_f32 v[208:209], v[42:43], v[148:149] op_sel:[0,0] op_sel_hi:[0,1]
    v_pk_mul_f32 v[210:211], v[42:43], v[148:149] op_sel:[1,0] op_sel_hi:[1,1]
    v_pk_fma_f32 v[148:149], v[42:43], v[180:181], v[208:209] op_sel:[1,0,0] op_sel_hi:[1,1,1] neg_lo:[1,0,0] neg_hi:[1,0,0]
    v_pk_fma_f32 v[180:181], v[42:43], v[180:181], v[210:211] op_sel:[0,0,0] op_sel_hi:[0,1,1]
    v_pk_mul_f32 v[212:213], v[42:43], v[150:151] op_sel:[0,0] op_sel_hi:[0,1]
    v_pk_mul_f32 v[214:215], v[42:43], v[150:151] op_sel:[1,0] op_sel_hi:[1,1]
    v_pk_fma_f32 v[150:151], v[42:43], v[182:183], v[212:213] op_sel:[1,0,0] op_sel_hi:[1,1,1] neg_lo:[1,0,0] neg_hi:[1,0,0]
    v_pk_fma_f32 v[182:183], v[42:43], v[182:183], v[214:215] op_sel:[0,0,0] op_sel_hi:[0,1,1]
    v_pk_mul_f32 v[208:209], v[42:43], v[152:153] op_sel:[0,0] op_sel_hi:[0,1]
    v_pk_mul_f32 v[210:211], v[42:43], v[152:153] op_sel:[1,0] op_sel_hi:[1,1]
    v_pk_fma_f32 v[152:153], v[42:43], v[184:185], v[208:209] op_sel:[1,0,0] op_sel_hi:[1,1,1] neg_lo:[1,0,0] neg_hi:[1,0,0]
    v_pk_fma_f32 v[184:185], v[42:43], v[184:185], v[210:211] op_sel:[0,0,0] op_sel_hi:[0,1,1]
    v_pk_mul_f32 v[212:213], v[42:43], v[154:155] op_sel:[0,0] op_sel_hi:[0,1]
    v_pk_mul_f32 v[214:215], v[42:43], v[154:155] op_sel:[1,0] op_sel_hi:[1,1]
    v_pk_fma_f32 v[154:155], v[42:43], v[186:187], v[212:213] op_sel:[1,0,0] op_sel_hi:[1,1,1] neg_lo:[1,0,0] neg_hi:[1,0,0]
    v_pk_fma_f32 v[186:187], v[42:43], v[186:187], v[214:215] op_sel:[0,0,0] op_sel_hi:[0,1,1]
    v_pk_mul_f32 v[208:209], v[42:43], v[156:157] op_sel:[0,0] op_sel_hi:[0,1]
    v_pk_mul_f32 v[210:211], v[42:43], v[156:157] op_sel:[1,0] op_sel_hi:[1,1]
    v_pk_fma_f32 v[156:157], v[42:43], v[188:189], v[208:209] op_sel:[1,0,0] op_sel_hi:[1,1,1] neg_lo:[1,0,0] neg_hi:[1,0,0]
    v_pk_fma_f32 v[188:189], v[42:43], v[188:189], v[210:211] op_sel:[0,0,0] op_sel_hi:[0,1,1]
    v_pk_mul_f32 v[212:213], v[42:43], v[158:159] op_sel:[0,0] op_sel_hi:[0,1]
    v_pk_mul_f32 v[214:215], v[42:43], v[158:159] op_sel:[1,0] op_sel_hi:[1,1]
    v_pk_fma_f32 v[158:159], v[42:43], v[190:191], v[212:213] op_sel:[1,0,0] op_sel_hi:[1,1,1] neg_lo:[1,0,0] neg_hi:[1,0,0]
    v_pk_fma_f32 v[190:191], v[42:43], v[190:191], v[214:215] op_sel:[0,0,0] op_sel_hi:[0,1,1]
    v_fma_f32 v208, v94, v158, v159
    v_fma_f32 v209, v94, v190, v191
    v_fma_f32 v208, -v95, v190, v208
    v_fma_f32 v209, v95, v158, v209
    v_mov_b64 v[210:211], 0
    v_mov_b64 v[212:213], v[208:209]
    v_mov_b64 v[214:215], 0
    s_nop 0
    v_permlane16_swap_b32 v210, v212
    v_permlane16_swap_b32 v211, v213
    v_pk_fma_f32 v[208:209], v[210:211], v[34:35], v[208:209] op_sel:[0,0,0] op_sel_hi:[0,1,1]
    v_pk_fma_f32 v[208:209], v[210:211], v[34:35], v[208:209] op_sel:[1,1,0] op_sel_hi:[1,0,1] neg_lo:[1,0,0]
    v_mov_b64 v[212:213], v[208:209]
    s_nop 1
    v_permlane16_swap_b32 v208, v212
    v_permlane16_swap_b32 v209, v213
    s_nop 0
    v_permlane32_swap_b32 v214, v212
    v_permlane32_swap_b32 v215, v213
    s_nop 0
    v_fma_f32 v44, v40, v214, v210
    v_fma_f32 v46, v40, v215, v211
    v_fma_f32 v44, -v41, v215, v44
    v_fma_f32 v46, v41, v214, v46
    v_fma_f32 v45, v94, v44, v158
    v_fma_f32 v47, v94, v46, v190
    v_fma_f32 v45, -v95, v46, v45
    v_fma_f32 v47, v95, v44, v47
    buffer_load_dwordx4 v[232:235], v24, s[76:79], 0 offen sc1
    buffer_load_dwordx4 v[236:239], v25, s[76:79], 0 offen sc1
    buffer_load_dwordx4 v[240:243], v26, s[76:79], 0 offen sc1
    buffer_load_dwordx4 v[244:247], v27, s[76:79], 0 offen sc1
    global_load_dwordx2 v[200:201], v100, s[8:9] offset:0
    global_load_dwordx2 v[206:207], v101, s[8:9] offset:0
    global_load_dwordx2 v[102:103], v99, s[38:39] offset:0
    global_load_dwordx2 v[202:203], v100, s[8:9] offset:64
    global_load_dwordx2 v[124:125], v101, s[8:9] offset:64
    global_load_dwordx2 v[110:111], v99, s[38:39] offset:64
    global_load_dwordx2 v[204:205], v100, s[8:9] offset:128
    global_load_dwordx2 v[126:127], v101, s[8:9] offset:128
    global_load_dwordx2 v[98:99], v99, s[38:39] offset:128
    v_lshlrev_b32 v100, 1, v100
    v_lshlrev_b32_e64 v101, 1, v101
    s_waitcnt vmcnt(12)
    v_cmp_ne_u64 s[24:25], v[234:235], v[52:53]
    s_waitcnt vmcnt(11)
    v_cmp_ne_u64 s[26:27], v[238:239], v[54:55]
    s_waitcnt vmcnt(10)
    v_cmp_ne_u64 s[28:29], v[242:243], v[56:57]
    s_waitcnt vmcnt(9)
    v_cmp_ne_u64 s[30:31], v[246:247], v[58:59]
    s_or_b64 s[24:25], s[24:25], s[26:27]
    s_or_b64 vcc, s[28:29], s[30:31]
    s_or_b64 vcc, vcc, s[24:25]
    s_cbranch_vccz L_pollS_done
    s_mov_b32 s58, 1000000
L_pollS:
    buffer_load_dwordx4 v[232:235], v24, s[76:79], 0 offen sc1
    buffer_load_dwordx4 v[236:239], v25, s[76:79], 0 offen sc1
    buffer_load_dwordx4 v[240:243], v26, s[76:79], 0 offen sc1
    buffer_load_dwordx4 v[244:247], v27, s[76:79], 0 offen sc1
    s_sub_u32 s58, s58, 1
    s_waitcnt vmcnt(0)
    s_cbranch_scc1 L_pollS_done
    v_cmp_ne_u64 s[24:25], v[234:235], v[52:53]
    v_cmp_ne_u64 s[26:27], v[238:239], v[54:55]
    v_cmp_ne_u64 s[28:29], v[242:243], v[56:57]
    v_cmp_ne_u64 s[30:31], v[246:247], v[58:59]
    s_or_b64 s[24:25], s[24:25], s[26:27]
    s_or_b64 vcc, s[28:29], s[30:31]
    s_or_b64 vcc, vcc, s[24:25]
    s_cbranch_vccnz L_pollS
L_pollS_done:
    v_pk_fma_f32 v[240:241], v[244:245], v[36:37], v[240:241] op_sel:[0,0,0] op_sel_hi:[0,1,1]
    v_pk_fma_f32 v[240:241], v[244:245], v[36:37], v[240:241] op_sel:[1,1,0] op_sel_hi:[1,0,1] neg_lo:[1,0,0]
    v_pk_fma_f32 v[236:237], v[240:241], v[36:37], v[236:237] op_sel:[0,0,0] op_sel_hi:[0,1,1]
    v_pk_fma_f32 v[236:237], v[240:241], v[36:37], v[236:237] op_sel:[1,1,0] op_sel_hi:[1,0,1] neg_lo:[1,0,0]
    v_pk_fma_f32 v[232:233], v[236:237], v[36:37], v[232:233] op_sel:[0,0,0] op_sel_hi:[0,1,1]
    v_pk_fma_f32 v[232:233], v[236:237], v[36:37], v[232:233] op_sel:[1,1,0] op_sel_hi:[1,0,1] neg_lo:[1,0,0]
    v_pk_mul_f32 v[210:211], v[232:233], v[38:39] op_sel:[0,0] op_sel_hi:[0,1]
    v_pk_fma_f32 v[208:209], v[232:233], v[38:39], v[210:211] op_sel:[1,1,0] op_sel_hi:[1,0,1] neg_lo:[1,0,0]
    s_nop 1
    v_permlane32_swap_b32 v208, v209
    v_add_f32 v210, v208, v209
    v_add_f32 v211, v208, v209
    s_nop 1
    v_permlane16_swap_b32 v210, v211
    v_add_f32 v212, v210, v211
    v_add_f32 v213, v210, v211
    s_nop 1
    v_permlane32_swap_b32 v212, v213
    v_cmp_ne_u64 s[72:73], v[228:229], v[116:117]
    v_pk_fma_f32 v[44:45], v[212:213], v[48:49], v[44:45] op_sel:[0,0,0] op_sel_hi:[0,1,1]
    v_pk_fma_f32 v[46:47], v[212:213], v[50:51], v[46:47] op_sel:[0,0,0] op_sel_hi:[0,1,1]
    v_pk_fma_f32 v[44:45], v[212:213], v[50:51], v[44:45] op_sel:[1,0,0] op_sel_hi:[1,1,1] neg_lo:[1,0,0] neg_hi:[1,0,0]
    v_pk_fma_f32 v[46:47], v[212:213], v[48:49], v[46:47] op_sel:[1,0,0] op_sel_hi:[1,1,1]
    s_cmp_lg_u64 s[72:73], 0
    s_cbranch_scc1 L_slow
    v_pk_fma_f32 v[128:129], v[64:65], v[44:45], v[128:129] op_sel:[0,0,0] op_sel_hi:[0,1,1]
    v_pk_fma_f32 v[130:131], v[66:67], v[44:45], v[130:131] op_sel:[0,0,0] op_sel_hi:[0,1,1]
    v_pk_fma_f32 v[132:133], v[68:69], v[44:45], v[132:133] op_sel:[0,0,0] op_sel_hi:[0,1,1]
    v_pk_fma_f32 v[134:135], v[70:71], v[44:45], v[134:135] op_sel:[0,0,0] op_sel_hi:[0,1,1]
    v_pk_fma_f32 v[136:137], v[72:73], v[44:45], v[136:137] op_sel:[0,0,0] op_sel_hi:[0,1,1]
    v_pk_fma_f32 v[138:139], v[74:75], v[44:45], v[138:139] op_sel:[0,0,0] op_sel_hi:[0,1,1]
    v_pk_fma_f32 v[140:141], v[76:77], v[44:45], v[140:141] op_sel:[0,0,0] op_sel_hi:[0,1,1]
    v_pk_fma_f32 v[142:143], v[78:79], v[44:45], v[142:143] op_sel:[0,0,0] op_sel_hi:[0,1,1]
    v_pk_fma_f32 v[128:129], v[64:65], v[46:47], v[128:129] op_sel:[1,0,0] op_sel_hi:[1,1,1] neg_lo:[1,0,0] neg_hi:[1,0,0]
    v_pk_fma_f32 v[130:131], v[66:67], v[46:47], v[130:131] op_sel:[1,0,0] op_sel_hi:[1,1,1] neg_lo:[1,0,0] neg_hi:[1,0,0]
    v_pk_fma_f32 v[132:133], v[68:69], v[46:47], v[132:133] op_sel:[1,0,0] op_sel_hi:[1,1,1] neg_lo:[1,0,0] neg_hi:[1,0,0]
    v_pk_fma_f32 v[134:135], v[70:71], v[46:47], v[134:135] op_sel:[1,0,0] op_sel_hi:[1,1,1] neg_lo:[1,0,0] neg_hi:[1,0,0]
    v_pk_fma_f32 v[136:137], v[72:73], v[46:47], v[136:137] op_sel:[1,0,0] op_sel_hi:[1,1,1] neg_lo:[1,0,0] neg_hi:[1,0,0]
    v_pk_fma_f32 v[138:139], v[74:75], v[46:47], v[138:139] op_sel:[1,0,0] op_sel_hi:[1,1,1] neg_lo:[1,0,0] neg_hi:[1,0,0]
    v_pk_fma_f32 v[140:141], v[76:77], v[46:47], v[140:141] op_sel:[1,0,0] op_sel_hi:[1,1,1] neg_lo:[1,0,0] neg_hi:[1,0,0]
    v_pk_fma_f32 v[142:143], v[78:79], v[46:47], v[142:143] op_sel:[1,0,0] op_sel_hi:[1,1,1] neg_lo:[1,0,0] neg_hi:[1,0,0]
    v_cvt_pk_bf16_f32 v216, v128, v130
    v_cvt_pk_bf16_f32 v217, v132, v134
    v_cvt_pk_bf16_f32 v218, v136, v138
    v_cvt_pk_bf16_f32 v219, v140, v142
    buffer_store_dwordx4 v[216:219], v29, s[68:71], s60 offen offset:0
    v_cvt_pk_bf16_f32 v220, v129, v131
    v_cvt_pk_bf16_f32 v221, v133, v135
    v_cvt_pk_bf16_f32 v222, v137, v139
    v_cvt_pk_bf16_f32 v223, v141, v143
    buffer_store_dwordx4 v[220:223], v29, s[68:71], s60 offen offset:512
    v_pk_fma_f32 v[144:145], v[80:81], v[44:45], v[144:145] op_sel:[0,0,0] op_sel_hi:[0,1,1]
    v_pk_fma_f32 v[146:147], v[82:83], v[44:45], v[146:147] op_sel:[0,0,0] op_sel_hi:[0,1,1]
    v_pk_fma_f32 v[148:149], v[84:85], v[44:45], v[148:149] op_sel:[0,0,0] op_sel_hi:[0,1,1]
    v_pk_fma_f32 v[150:151], v[86:87], v[44:45], v[150:151] op_sel:[0,0,0] op_sel_hi:[0,1,1]
    v_pk_fma_f32 v[152:153], v[88:89], v[44:45], v[152:153] op_sel:[0,0,0] op_sel_hi:[0,1,1]
    v_pk_fma_f32 v[154:155], v[90:91], v[44:45], v[154:155] op_sel:[0,0,0] op_sel_hi:[0,1,1]
    v_pk_fma_f32 v[156:157], v[92:93], v[44:45], v[156:157] op_sel:[0,0,0] op_sel_hi:[0,1,1]
    v_pk_fma_f32 v[158:159], v[94:95], v[44:45], v[158:159] op_sel:[0,0,0] op_sel_hi:[0,1,1]
    v_pk_fma_f32 v[144:145], v[80:81], v[46:47], v[144:145] op_sel:[1,0,0] op_sel_hi:[1,1,1] neg_lo:[1,0,0] neg_hi:[1,0,0]
    v_pk_fma_f32 v[146:147], v[82:83], v[46:47], v[146:147] op_sel:[1,0,0] op_sel_hi:[1,1,1] neg_lo:[1,0,0] neg_hi:[1,0,0]
    v_pk_fma_f32 v[148:149], v[84:85], v[46:47], v[148:149] op_sel:[1,0,0] op_sel_hi:[1,1,1] neg_lo:[1,0,0] neg_hi:[1,0,0]
    v_pk_fma_f32 v[150:151], v[86:87], v[46:47], v[150:151] op_sel:[1,0,0] op_sel_hi:[1,1,1] neg_lo:[1,0,0] neg_hi:[1,0,0]
    v_pk_fma_f32 v[152:153], v[88:89], v[46:47], v[152:153] op_sel:[1,0,0] op_sel_hi:[1,1,1] neg_lo:[1,0,0] neg_hi:[1,0,0]
    v_pk_fma_f32 v[154:155], v[90:91], v[46:47], v[154:155] op_sel:[1,0,0] op_sel_hi:[1,1,1] neg_lo:[1,0,0] neg_hi:[1,0,0]
    v_pk_fma_f32 v[156:157], v[92:93], v[46:47], v[156:157] op_sel:[1,0,0] op_sel_hi:[1,1,1] neg_lo:[1,0,0] neg_hi:[1,0,0]
    v_pk_fma_f32 v[158:159], v[94:95], v[46:47], v[158:159] op_sel:[1,0,0] op_sel_hi:[1,1,1] neg_lo:[1,0,0] neg_hi:[1,0,0]
    v_cvt_pk_bf16_f32 v224, v144, v146
    v_cvt_pk_bf16_f32 v225, v148, v150
    v_cvt_pk_bf16_f32 v226, v152, v154
    v_cvt_pk_bf16_f32 v227, v156, v158
    buffer_store_dwordx4 v[224:227], v30, s[68:71], s60 offen offset:256
    v_cvt_pk_bf16_f32 v228, v145, v147
    v_cvt_pk_bf16_f32 v229, v149, v151
    v_cvt_pk_bf16_f32 v230, v153, v155
    v_cvt_pk_bf16_f32 v231, v157, v159
    buffer_store_dwordx4 v[228:231], v30, s[68:71], s60 offen offset:768
    v_pk_fma_f32 v[160:161], v[64:65], v[46:47], v[160:161] op_sel:[0,0,0] op_sel_hi:[0,1,1]
    v_pk_fma_f32 v[162:163], v[66:67], v[46:47], v[162:163] op_sel:[0,0,0] op_sel_hi:[0,1,1]
    v_pk_fma_f32 v[164:165], v[68:69], v[46:47], v[164:165] op_sel:[0,0,0] op_sel_hi:[0,1,1]
    v_pk_fma_f32 v[166:167], v[70:71], v[46:47], v[166:167] op_sel:[0,0,0] op_sel_hi:[0,1,1]
    v_pk_fma_f32 v[168:169], v[72:73], v[46:47], v[168:169] op_sel:[0,0,0] op_sel_hi:[0,1,1]
    v_pk_fma_f32 v[170:171], v[74:75], v[46:47], v[170:171] op_sel:[0,0,0] op_sel_hi:[0,1,1]
    v_pk_fma_f32 v[172:173], v[76:77], v[46:47], v[172:173] op_sel:[0,0,0] op_sel_hi:[0,1,1]
    v_pk_fma_f32 v[174:175], v[78:79], v[46:47], v[174:175] op_sel:[0,0,0] op_sel_hi:[0,1,1]
    v_pk_fma_f32 v[160:161], v[64:65], v[44:45], v[160:161] op_sel:[1,0,0] op_sel_hi:[1,1,1]
    v_pk_fma_f32 v[162:163], v[66:67], v[44:45], v[162:163] op_sel:[1,0,0] op_sel_hi:[1,1,1]
    v_pk_fma_f32 v[164:165], v[68:69], v[44:45], v[164:165] op_sel:[1,0,0] op_sel_hi:[1,1,1]
    v_pk_fma_f32 v[166:167], v[70:71], v[44:45], v[166:167] op_sel:[1,0,0] op_sel_hi:[1,1,1]
    v_pk_fma_f32 v[168:169], v[72:73], v[44:45], v[168:169] op_sel:[1,0,0] op_sel_hi:[1,1,1]
    v_pk_fma_f32 v[170:171], v[74:75], v[44:45], v[170:171] op_sel:[1,0,0] op_sel_hi:[1,1,1]
    v_pk_fma_f32 v[172:173], v[76:77], v[44:45], v[172:173] op_sel:[1,0,0] op_sel_hi:[1,1,1]
    v_pk_fma_f32 v[174:175], v[78:79], v[44:45], v[174:175] op_sel:[1,0,0] op_sel_hi:[1,1,1]
    v_cvt_pk_bf16_f32 v232, -v160, -v162
    v_cvt_pk_bf16_f32 v233, -v164, -v166
    v_cvt_pk_bf16_f32 v234, -v168, -v170
    v_cvt_pk_bf16_f32 v235, -v172, -v174
    buffer_store_dwordx4 v[232:235], v29, s[68:71], s60 offen offset:1024
    v_cvt_pk_bf16_f32 v236, -v161, -v163
    v_cvt_pk_bf16_f32 v237, -v165, -v167
    v_cvt_pk_bf16_f32 v238, -v169, -v171
    v_cvt_pk_bf16_f32 v239, -v173, -v175
    buffer_store_dwordx4 v[236:239], v29, s[68:71], s60 offen offset:1536
    v_pk_fma_f32 v[176:177], v[80:81], v[46:47], v[176:177] op_sel:[0,0,0] op_sel_hi:[0,1,1]
    v_pk_fma_f32 v[178:179], v[82:83], v[46:47], v[178:179] op_sel:[0,0,0] op_sel_hi:[0,1,1]
    v_pk_fma_f32 v[180:181], v[84:85], v[46:47], v[180:181] op_sel:[0,0,0] op_sel_hi:[0,1,1]
    v_pk_fma_f32 v[182:183], v[86:87], v[46:47], v[182:183] op_sel:[0,0,0] op_sel_hi:[0,1,1]
    v_pk_fma_f32 v[184:185], v[88:89], v[46:47], v[184:185] op_sel:[0,0,0] op_sel_hi:[0,1,1]
    v_pk_fma_f32 v[186:187], v[90:91], v[46:47], v[186:187] op_sel:[0,0,0] op_sel_hi:[0,1,1]
    v_pk_fma_f32 v[188:189], v[92:93], v[46:47], v[188:189] op_sel:[0,0,0] op_sel_hi:[0,1,1]
    v_pk_fma_f32 v[190:191], v[94:95], v[46:47], v[190:191] op_sel:[0,0,0] op_sel_hi:[0,1,1]
    v_pk_fma_f32 v[176:177], v[80:81], v[44:45], v[176:177] op_sel:[1,0,0] op_sel_hi:[1,1,1]
    v_pk_fma_f32 v[178:179], v[82:83], v[44:45], v[178:179] op_sel:[1,0,0] op_sel_hi:[1,1,1]
    v_pk_fma_f32 v[180:181], v[84:85], v[44:45], v[180:181] op_sel:[1,0,0] op_sel_hi:[1,1,1]
    v_pk_fma_f32 v[182:183], v[86:87], v[44:45], v[182:183] op_sel:[1,0,0] op_sel_hi:[1,1,1]
    v_pk_fma_f32 v[184:185], v[88:89], v[44:45], v[184:185] op_sel:[1,0,0] op_sel_hi:[1,1,1]
    v_pk_fma_f32 v[186:187], v[90:91], v[44:45], v[186:187] op_sel:[1,0,0] op_sel_hi:[1,1,1]
    v_pk_fma_f32 v[188:189], v[92:93], v[44:45], v[188:189] op_sel:[1,0,0] op_sel_hi:[1,1,1]
    v_pk_fma_f32 v[190:191], v[94:95], v[44:45], v[190:191] op_sel:[1,0,0] op_sel_hi:[1,1,1]
    v_cvt_pk_bf16_f32 v240, -v176, -v178
    v_cvt_pk_bf16_f32 v241, -v180, -v182
    v_cvt_pk_bf16_f32 v242, -v184, -v186
    v_cvt_pk_bf16_f32 v243, -v188, -v190
    buffer_store_dwordx4 v[240:243], v30, s[68:71], s60 offen offset:1280
    v_cvt_pk_bf16_f32 v244, -v177, -v179
    v_cvt_pk_bf16_f32 v245, -v181, -v183
    v_cvt_pk_bf16_f32 v246, -v185, -v187
    v_cvt_pk_bf16_f32 v247, -v189, -v191
    buffer_store_dwordx4 v[244:247], v30, s[68:71], s60 offen offset:1792
    s_waitcnt vmcnt(8)
    v_lshlrev_b32 v64, 16, v102
    v_and_b32 v65, 0xffff0000, v102
    v_lshlrev_b32_e64 v66, 16, v103
    v_and_b32 v67, 0xffff0000, v103
    v_lshlrev_b32_e64 v68, 16, v110
    v_and_b32 v69, 0xffff0000, v110
    v_lshlrev_b32_e64 v70, 16, v111
    v_and_b32 v71, 0xffff0000, v111
    v_lshlrev_b32_e64 v72, 16, v98
    v_and_b32 v73, 0xffff0000, v98
    v_lshlrev_b32_e64 v74, 16, v99
    v_and_b32 v75, 0xffff0000, v99
    v_lshlrev_b32_e64 v76, 16, v200
    v_and_b32 v77, 0xffff0000, v200
    v_lshlrev_b32_e64 v78, 16, v201
    v_and_b32 v79, 0xffff0000, v201
    v_lshlrev_b32_e64 v80, 16, v202
    v_and_b32 v81, 0xffff0000, v202
    v_lshlrev_b32_e64 v82, 16, v203
    v_and_b32 v83, 0xffff0000, v203
    v_lshlrev_b32_e64 v84, 16, v204
    v_and_b32 v85, 0xffff0000, v204
    v_lshlrev_b32_e64 v86, 16, v205
    v_and_b32 v87, 0xffff0000, v205
    v_lshlrev_b32_e64 v88, 16, v206
    v_and_b32 v89, 0xffff0000, v206
    v_lshlrev_b32_e64 v90, 16, v207
    v_and_b32 v91, 0xffff0000, v207
    v_lshlrev_b32_e64 v92, 16, v124
    v_and_b32 v93, 0xffff0000, v124
    v_lshlrev_b32_e64 v94, 16, v125
    v_and_b32 v95, 0xffff0000, v125
    v_lshlrev_b32_e64 v20, 16, v126
    v_and_b32 v21, 0xffff0000, v126
    v_lshlrev_b32_e64 v22, 16, v127
    v_and_b32 v23, 0xffff0000, v127
    v_pk_mul_f32 v[76:77], v[76:77], v[64:65]
    v_pk_mul_f32 v[78:79], v[78:79], v[66:67]
    v_pk_mul_f32 v[80:81], v[80:81], v[68:69]
    v_pk_mul_f32 v[82:83], v[82:83], v[70:71]
    v_pk_mul_f32 v[84:85], v[84:85], v[72:73]
    v_pk_mul_f32 v[86:87], v[86:87], v[74:75]
    v_pk_mul_f32 v[88:89], v[88:89], v[64:65]
    v_pk_mul_f32 v[90:91], v[90:91], v[66:67]
    v_pk_mul_f32 v[92:93], v[92:93], v[68:69]
    v_pk_mul_f32 v[94:95], v[94:95], v[70:71]
    v_pk_mul_f32 v[20:21], v[20:21], v[72:73]
    v_pk_mul_f32 v[22:23], v[22:23], v[74:75]
    s_mov_b64 exec, 1
    s_waitcnt vmcnt(0)
    global_store_dword v6, v122, s[46:47]
    s_mov_b64 exec, -1
    v_mov_b64 v[32:33], 0
    v_mov_b64 v[34:35], 0
    v_mov_b64 v[36:37], 0
    v_mov_b64 v[38:39], 0
    v_mov_b64 v[40:41], 0
    v_mov_b64 v[42:43], 0
    v_mov_b64 v[44:45], 0
    v_mov_b64 v[46:47], 0
    v_mov_b64 v[48:49], 0
    v_mov_b64 v[50:51], 0
    v_mov_b64 v[52:53], 0
    v_mov_b64 v[54:55], 0
L_tail_done:
L_P2:
    s_mov_b32 s74, -1
    v_lshlrev_b32_e64 v26, 2, v2
    v_add_u32 v26, 150528, v26
    v_mov_b32_e64 v28, 0
    ds_write_b32 v26, v28
    s_lshl_b32 s4, s48, 2
    s_add_u32 s4, s4, 150528
    v_mov_b32 v25, s4
    v_and_b32 v26, 3, v1
    v_lshlrev_b32 v26, 2, v26
    v_add_u32 v26, 150528, v26
    v_mov_b32 v64, s55
    v_mov_b32 v31, s23
    v_min_u32 v30, 23, v1
    v_lshrrev_b32 v66, 2, v30
    v_and_b32 v30, 3, v30
    v_lshlrev_b32 v30, 2, v30
    v_lshl_add_u32 v30, v66, 7, v30
    v_add_u32_e64 v30, s12, v30
    s_bitcmp0_b32 s74, 0
    s_cbranch_scc1 L_pollH0_done
    s_mov_b32 s58, 1000000
L_pollH0:
    global_load_dword v97, v62, s[46:47] sc1
    s_sub_u32 s58, s58, 1
    s_waitcnt vmcnt(0) lgkmcnt(0)
    s_cbranch_scc1 L_pollH0_done
    v_cmp_ne_u32 s[74:75], s55, v97
    s_mov_b32 vcc_hi, 0
    s_and_b32 vcc_lo, s74, 1
    s_cbranch_vccnz L_pollH0
L_pollH0_done:
    s_add_u32 m0, s15, 0
    s_lshl_b32 s63, s33, 7
    buffer_load_dwordx4 v63, s[68:71], s63 offen offset:0 sc1 lds
    buffer_load_dwordx4 v63, s[68:71], s63 offen offset:1024 sc1 lds
    buffer_load_dwordx4 v63, s[68:71], s63 offen offset:2048 sc1 lds
    buffer_load_dwordx4 v63, s[68:71], s63 offen offset:3072 sc1 lds
    s_bitcmp0_b32 s74, 1
    s_cbranch_scc1 L_pollH1_done
    s_mov_b32 s58, 1000000
L_pollH1:
    global_load_dword v97, v62, s[46:47] sc1
    s_sub_u32 s58, s58, 1
    s_waitcnt vmcnt(0)
    s_cbranch_scc1 L_pollH1_done
    v_cmp_ne_u32 s[74:75], s55, v97
    s_mov_b32 vcc_hi, 0
    s_and_b32 vcc_lo, s74, 2
    s_cbranch_vccnz L_pollH1
L_pollH1_done:
    s_add_u32 m0, s15, 16384
    s_lshl_b32 s63, s34, 7
    buffer_load_dwordx4 v63, s[68:71], s63 offen offset:0 sc1 lds
    buffer_load_dwordx4 v63, s[68:71], s63 offen offset:1024 sc1 lds
    buffer_load_dwordx4 v63, s[68:71], s63 offen offset:2048 sc1 lds
    buffer_load_dwordx4 v63, s[68:71], s63 offen offset:3072 sc1 lds
    s_waitcnt vmcnt(4)
    s_barrier
    s_bitcmp0_b32 s74, 2
    s_cbranch_scc1 L_pollH2_done
    s_mov_b32 s58, 1000000
L_pollH2:
    global_load_dword v97, v62, s[46:47] sc1
    s_sub_u32 s58, s58, 1
    s_waitcnt vmcnt(0)
    s_cbranch_scc1 L_pollH2_done
    v_cmp_ne_u32 s[74:75], s55, v97
    s_mov_b32 vcc_hi, 0
    s_and_b32 vcc_lo, s74, 4
    s_cbranch_vccnz L_pollH2
L_pollH2_done:
    s_add_u32 m0, s15, 32768
    s_lshl_b32 s63, s35, 7
    buffer_load_dwordx4 v63, s[68:71], s63 offen offset:0 sc1 lds
    buffer_load_dwordx4 v63, s[68:71], s63 offen offset:1024 sc1 lds
    buffer_load_dwordx4 v63, s[68:71], s63 offen offset:2048 sc1 lds
    buffer_load_dwordx4 v63, s[68:71], s63 offen offset:3072 sc1 lds
    s_waitcnt vmcnt(4)
    s_barrier
    s_bitcmp0_b32 s74, 3
    s_cbranch_scc1 L_pollH3_done
    s_mov_b32 s58, 1000000
L_pollH3:
    global_load_dword v97, v62, s[46:47] sc1
    s_sub_u32 s58, s58, 1
    s_waitcnt vmcnt(0)
    s_cbranch_scc1 L_pollH3_done
    v_cmp_ne_u32 s[74:75], s55, v97
    s_mov_b32 vcc_hi, 0
    s_and_b32 vcc_lo, s74, 8
    s_cbranch_vccnz L_pollH3
L_pollH3_done:
    s_add_u32 m0, s15, 49152
    s_lshl_b32 s63, s36, 7
    buffer_load_dwordx4 v63, s[68:71], s63 offen offset:0 sc1 lds
    buffer_load_dwordx4 v63, s[68:71], s63 offen offset:1024 sc1 lds
    buffer_load_dwordx4 v63, s[68:71], s63 offen offset:2048 sc1 lds
    buffer_load_dwordx4 v63, s[68:71], s63 offen offset:3072 sc1 lds
    s_waitcnt vmcnt(4)
    s_barrier
    s_bitcmp0_b32 s74, 4
    s_cbranch_scc1 L_pollH4_done
    s_mov_b32 s58, 1000000
L_pollH4:
    global_load_dword v97, v62, s[46:47] sc1
    s_sub_u32 s58, s58, 1
    s_waitcnt vmcnt(0)
    s_cbranch_scc1 L_pollH4_done
    v_cmp_ne_u32 s[74:75], s55, v97
    s_mov_b32 vcc_hi, 0
    s_and_b32 vcc_lo, s74, 16
    s_cbranch_vccnz L_pollH4
L_pollH4_done:
    s_add_u32 m0, s15, 65536
    s_lshl_b32 s63, s37, 7
    buffer_load_dwordx4 v63, s[68:71], s63 offen offset:0 sc1 lds
    buffer_load_dwordx4 v63, s[68:71], s63 offen offset:1024 sc1 lds
    buffer_load_dwordx4 v63, s[68:71], s63 offen offset:2048 sc1 lds
    buffer_load_dwordx4 v63, s[68:71], s63 offen offset:3072 sc1 lds
    s_bitcmp0_b32 s74, 5
    s_cbranch_scc1 L_pollH5_done
    s_mov_b32 s58, 1000000
L_pollH5:
    global_load_dword v97, v62, s[46:47] sc1
    s_sub_u32 s58, s58, 1
    s_waitcnt vmcnt(0)
    s_cbranch_scc1 L_pollH5_done
    v_cmp_ne_u32 s[74:75], s55, v97
    s_mov_b32 vcc_hi, 0
    s_and_b32 vcc_lo, s74, 32
    s_cbranch_vccnz L_pollH5
L_pollH5_done:
    s_add_u32 m0, s15, 81920
    s_lshl_b32 s63, s40, 7
    buffer_load_dwordx4 v63, s[68:71], s63 offen offset:0 sc1 lds
    buffer_load_dwordx4 v63, s[68:71], s63 offen offset:1024 sc1 lds
    buffer_load_dwordx4 v63, s[68:71], s63 offen offset:2048 sc1 lds
    buffer_load_dwordx4 v63, s[68:71], s63 offen offset:3072 sc1 lds
    s_waitcnt vmcnt(8)
    s_barrier
    s_bitcmp0_b32 s74, 6
    s_cbranch_scc1 L_pollH6_done
    s_mov_b32 s58, 1000000
L_pollH6:
    global_load_dword v97, v62, s[46:47] sc1
    s_sub_u32 s58, s58, 1
    s_waitcnt vmcnt(0)
    s_cbranch_scc1 L_pollH6_done
    v_cmp_ne_u32 s[74:75], s55, v97
    s_mov_b32 vcc_hi, 0
    s_and_b32 vcc_lo, s74, 64
    s_cbranch_vccnz L_pollH6
L_pollH6_done:
    s_add_u32 m0, s15, 0
    s_lshl_b32 s63, s41, 7
    buffer_load_dwordx4 v63, s[68:71], s63 offen offset:0 sc1 lds
    buffer_load_dwordx4 v63, s[68:71], s63 offen offset:1024 sc1 lds
    buffer_load_dwordx4 v63, s[68:71], s63 offen offset:2048 sc1 lds
    buffer_load_dwordx4 v63, s[68:71], s63 offen offset:3072 sc1 lds
    s_bitcmp0_b32 s74, 7
    s_cbranch_scc1 L_pollH7_done
    s_mov_b32 s58, 1000000
L_pollH7:
    global_load_dword v97, v62, s[46:47] sc1
    s_sub_u32 s58, s58, 1
    s_waitcnt vmcnt(0)
    s_cbranch_scc1 L_pollH7_done
    v_cmp_ne_u32 s[74:75], s55, v97
    s_mov_b32 vcc_hi, 0
    s_and_b32 vcc_lo, s74, 128
    s_cbranch_vccnz L_pollH7
L_pollH7_done:
    s_add_u32 m0, s15, 16384
    s_lshl_b32 s63, s44, 7
    buffer_load_dwordx4 v63, s[68:71], s63 offen offset:0 sc1 lds
    buffer_load_dwordx4 v63, s[68:71], s63 offen offset:1024 sc1 lds
    buffer_load_dwordx4 v63, s[68:71], s63 offen offset:2048 sc1 lds
    buffer_load_dwordx4 v63, s[68:71], s63 offen offset:3072 sc1 lds
    s_waitcnt vmcnt(8)
    s_barrier
    s_bitcmp0_b32 s74, 8
    s_cbranch_scc1 L_pollH8_done
    s_mov_b32 s58, 1000000
L_pollH8:
    global_load_dword v97, v62, s[46:47] sc1
    s_sub_u32 s58, s58, 1
    s_waitcnt vmcnt(0)
    s_cbranch_scc1 L_pollH8_done
    v_cmp_ne_u32 s[74:75], s55, v97
    s_mov_b32 vcc_hi, 0
    s_and_b32 vcc_lo, s74, 256
    s_cbranch_vccnz L_pollH8
L_pollH8_done:
    s_add_u32 m0, s15, 32768
    s_lshl_b32 s63, s45, 7
    buffer_load_dwordx4 v63, s[68:71], s63 offen offset:0 sc1 lds
    buffer_load_dwordx4 v63, s[68:71], s63 offen offset:1024 sc1 lds
    buffer_load_dwordx4 v63, s[68:71], s63 offen offset:2048 sc1 lds
    buffer_load_dwordx4 v63, s[68:71], s63 offen offset:3072 sc1 lds
    s_waitcnt vmcnt(0)
    s_barrier
    global_load_dword v58, v104, s[46:47] offset:0 sc1
    global_load_dword v56, v109, s[46:47] offset:0 sc1
    global_load_dword v59, v104, s[46:47] offset:32 sc1
    global_load_dword v57, v109, s[46:47] offset:32 sc1
    global_load_dwordx4 v[68:71], v105, s[46:47] sc1
    s_cmp_lg_u64 s[72:73], 0
    s_mov_b64 exec, 1
    s_cbranch_scc1 L_dfs
    global_store_dword v31, v64, s[46:47] offset:16
    s_branch L_dfd
L_dfs:
    global_store_dword v31, v64, s[46:47] offset:16 sc1
L_dfd:
    s_mov_b64 exec, -1
    s_waitcnt vmcnt(5)
    v_add_f32_dpp v58, v58, v58 quad_perm:[1,0,3,2] row_mask:0xf bank_mask:0xf
    s_waitcnt vmcnt(3)
    v_add_f32_dpp v59, v59, v59 quad_perm:[1,0,3,2] row_mask:0xf bank_mask:0xf
    v_add_f32_dpp v58, v58, v58 quad_perm:[2,3,0,1] row_mask:0xf bank_mask:0xf
    s_nop 0
    v_add_f32_dpp v59, v59, v59 quad_perm:[2,3,0,1] row_mask:0xf bank_mask:0xf
    v_add_f32_dpp v58, v58, v58 row_half_mirror row_mask:0xf bank_mask:0xf
    s_nop 0
    v_add_f32_dpp v59, v59, v59 row_half_mirror row_mask:0xf bank_mask:0xf
    v_add_f32_e64 v58, v58, v56
    v_mul_f32 v58, 0xbfb8aa3b, v58
    s_waitcnt vmcnt(2)
    v_add_f32 v59, v59, v57
    v_mul_f32 v59, 0xbfb8aa3b, v59
    v_exp_f32 v58, v58
    v_exp_f32 v59, v59
    v_add_f32 v58, 1.0, v58
    v_add_f32 v59, 1.0, v59
    v_rcp_f32 v58, v58
    v_rcp_f32 v59, v59
    v_sub_f32 v60, 1.0, v58
    v_sub_f32 v61, 1.0, v59
    v_mul_f32 v76, v76, v60
    v_mul_f32 v77, v77, v60
    v_mul_f32 v78, v78, v60
    v_mul_f32 v79, v79, v60
    v_mul_f32 v80, v80, v60
    v_mul_f32 v81, v81, v60
    v_mul_f32 v82, v82, v60
    v_mul_f32 v83, v83, v60
    v_mul_f32 v84, v84, v60
    v_mul_f32 v85, v85, v60
    v_mul_f32 v86, v86, v60
    v_mul_f32 v87, v87, v60
    v_mul_f32 v88, v88, v61
    v_mul_f32 v89, v89, v61
    v_mul_f32 v90, v90, v61
    v_mul_f32 v91, v91, v61
    v_mul_f32 v92, v92, v61
    v_mul_f32 v93, v93, v61
    v_mul_f32 v94, v94, v61
    v_mul_f32 v95, v95, v61
    v_mul_f32 v20, v20, v61
    v_mul_f32 v21, v21, v61
    v_mul_f32 v22, v22, v61
    v_mul_f32 v23, v23, v61
    s_waitcnt vmcnt(1)
    v_xor_b32 v68, s55, v68
    v_xor_b32 v69, s55, v69
    v_xor_b32 v70, s55, v70
    v_xor_b32_e64 v71, s55, v71
    v_or3_b32 v68, v68, v69, v70
    v_or_b32 v68, v68, v71
    v_cmp_ne_u32 vcc, 0, v68
    s_nop 0
    s_cbranch_vccz L_pollA_done
    s_mov_b32 s58, 1000000
L_pollA:
    s_sleep 16
    global_load_dwordx4 v[68:71], v105, s[46:47] sc1
    s_sub_u32 s58, s58, 1
    s_waitcnt vmcnt(0)
    s_cbranch_scc1 L_pollA_done
    v_xor_b32 v68, s55, v68
    v_xor_b32 v69, s55, v69
    v_xor_b32 v70, s55, v70
    v_xor_b32 v71, s55, v71
    v_or3_b32 v68, v68, v69, v70
    v_or_b32 v68, v68, v71
    v_cmp_ne_u32 vcc, 0, v68
    s_nop 0
    s_cbranch_vccnz L_pollA
L_pollA_done:
    s_add_u32 m0, s21, 151552
    s_mov_b32 s4, 0
    s_nop 0
    buffer_load_dwordx4 v248, s[76:79], s4 offen offset:0 sc1 lds
    s_mov_b32 s4, 31744
    buffer_load_dwordx4 v249, s[76:79], s4 offen offset:1024 sc1 lds
    s_mov_b32 s4, 63488
    buffer_load_dwordx4 v250, s[76:79], s4 offen offset:2048 sc1 lds
    global_load_dword v66, v30, s[46:47] offset:16 sc1
    s_waitcnt vmcnt(1)
    ds_write_b32 v25, v64
    s_waitcnt vmcnt(0)
    v_cmp_ne_u32 vcc, s55, v66
    s_nop 0
    s_cbranch_vccz L_pollF_done
    s_mov_b32 s58, 1000000
L_pollF:
    global_load_dword v66, v30, s[46:47] offset:16 sc1
    s_sub_u32 s58, s58, 1
    s_waitcnt vmcnt(0) lgkmcnt(0)
    s_cbranch_scc1 L_pollF_done
    v_cmp_ne_u32 vcc, s55, v66
    s_nop 0
    s_cbranch_vccnz L_pollF
L_pollF_done:
    s_nop 0
    ds_read_b32 v27, v26 offset:0
    ds_read_u16_d16_hi v32, v251 offset:0
    ds_read_u16_d16_hi v33, v251 offset:128
    ds_read_u16_d16_hi v34, v251 offset:256
    ds_read_u16_d16_hi v35, v251 offset:384
    ds_read_u16_d16_hi v36, v251 offset:4096
    ds_read_u16_d16_hi v37, v251 offset:4224
    ds_read_u16_d16_hi v38, v251 offset:4352
    ds_read_u16_d16_hi v39, v251 offset:4480
    ds_read_u16_d16_hi v40, v251 offset:8192
    ds_read_u16_d16_hi v41, v251 offset:8320
    ds_read_u16_d16_hi v42, v251 offset:8448
    ds_read_u16_d16_hi v43, v251 offset:8576
    s_waitcnt lgkmcnt(12)
    v_cmp_ne_u32 vcc, s55, v27
    s_nop 0
    s_cbranch_vccz L_pollY_ok
    s_mov_b32 s58, 1000000
L_pollY:
    ds_read_b32 v27, v26 offset:0
    s_sub_u32 s58, s58, 1
    s_waitcnt lgkmcnt(0)
    s_cbranch_scc1 L_pollY_done
    v_cmp_ne_u32 vcc, s55, v27
    s_nop 0
    s_cbranch_vccz L_pollY_done
    s_sleep 1
    s_branch L_pollY
L_pollY_done:
    ds_read_u16_d16_hi v32, v251 offset:0
    ds_read_u16_d16_hi v33, v251 offset:128
    ds_read_u16_d16_hi v34, v251 offset:256
    ds_read_u16_d16_hi v35, v251 offset:384
    ds_read_u16_d16_hi v36, v251 offset:4096
    ds_read_u16_d16_hi v37, v251 offset:4224
    ds_read_u16_d16_hi v38, v251 offset:4352
    ds_read_u16_d16_hi v39, v251 offset:4480
    ds_read_u16_d16_hi v40, v251 offset:8192
    ds_read_u16_d16_hi v41, v251 offset:8320
    ds_read_u16_d16_hi v42, v251 offset:8448
    ds_read_u16_d16_hi v43, v251 offset:8576
L_pollY_ok:
    ds_read_u16_d16_hi v44, v252 offset:0
    ds_read_u16_d16_hi v45, v252 offset:128
    ds_read_u16_d16_hi v46, v252 offset:256
    ds_read_u16_d16_hi v47, v252 offset:384
    ds_read_u16_d16_hi v48, v252 offset:4096
    ds_read_u16_d16_hi v49, v252 offset:4224
    ds_read_u16_d16_hi v50, v252 offset:4352
    ds_read_u16_d16_hi v51, v252 offset:4480
    ds_read_u16_d16_hi v52, v252 offset:8192
    ds_read_u16_d16_hi v53, v252 offset:8320
    ds_read_u16_d16_hi v54, v252 offset:8448
    ds_read_u16_d16_hi v55, v252 offset:8576
    s_waitcnt lgkmcnt(15)
    v_fmac_f32 v76, v32, v58
    v_fmac_f32 v77, v33, v58
    v_fmac_f32 v78, v34, v58
    v_fmac_f32 v79, v35, v58
    v_fmac_f32 v80, v36, v58
    v_fmac_f32 v81, v37, v58
    v_fmac_f32 v82, v38, v58
    v_fmac_f32 v83, v39, v58
    v_fmac_f32 v84, v40, v58
    s_waitcnt lgkmcnt(14)
    v_fmac_f32 v85, v41, v58
    s_waitcnt lgkmcnt(13)
    v_fmac_f32 v86, v42, v58
    s_waitcnt lgkmcnt(12)
    v_fmac_f32 v87, v43, v58
    s_waitcnt lgkmcnt(0)
    s_nop 0
    ds_read_b32 v27, v26 offset:16
    ds_read_b128 v[128:131], v96 offset:0
    ds_read_b128 v[132:135], v96 offset:25600
    ds_read_b128 v[136:139], v96 offset:128
    ds_read_b128 v[140:143], v96 offset:25728
    ds_read_b128 v[144:147], v96 offset:256
    ds_read_b128 v[148:151], v96 offset:25856
    s_waitcnt lgkmcnt(6)
    v_cmp_ne_u32 vcc, 1, v27
    s_nop 0
    s_cbranch_vccz L_pollI0_ok
    s_mov_b32 s58, 1000000
L_pollI0:
    ds_read_b32 v27, v26 offset:16
    s_sub_u32 s58, s58, 1
    s_waitcnt lgkmcnt(0)
    s_cbranch_scc1 L_pollI0_done
    v_cmp_ne_u32 vcc, 1, v27
    s_nop 0
    s_cbranch_vccz L_pollI0_done
    s_sleep 1
    s_branch L_pollI0
L_pollI0_done:
    ds_read_b128 v[128:131], v96 offset:0
    ds_read_b128 v[132:135], v96 offset:25600
    ds_read_b128 v[136:139], v96 offset:128
    ds_read_b128 v[140:143], v96 offset:25728
    ds_read_b128 v[144:147], v96 offset:256
    ds_read_b128 v[148:151], v96 offset:25856
L_pollI0_ok:
    v_fmac_f32 v88, v44, v59
    v_fmac_f32 v89, v45, v59
    v_fmac_f32 v90, v46, v59
    v_fmac_f32 v91, v47, v59
    v_fmac_f32 v92, v48, v59
    v_fmac_f32 v93, v49, v59
    v_fmac_f32 v94, v50, v59
    v_fmac_f32 v95, v51, v59
    v_fmac_f32 v20, v52, v59
    v_fmac_f32 v21, v53, v59
    v_fmac_f32 v22, v54, v59
    v_fmac_f32 v23, v55, v59
    s_waitcnt lgkmcnt(4)
    v_add_f32 v128, v128, v132
    v_add_f32 v129, v129, v133
    v_add_f32 v130, v130, v134
    v_add_f32_e64 v131, v131, v135
    v_fma_f32 v128, v128, v60, v76
    v_fma_f32 v129, v129, v60, v77
    v_fma_f32 v130, v130, v60, v78
    v_fma_f32 v131, v131, v60, v79
    global_store_dwordx4 v100, v[128:131], s[42:43] offset:0
    s_waitcnt lgkmcnt(2)
    v_add_f32 v136, v136, v140
    v_add_f32 v137, v137, v141
    v_add_f32 v138, v138, v142
    v_add_f32_e64 v139, v139, v143
    v_fma_f32 v136, v136, v60, v80
    v_fma_f32 v137, v137, v60, v81
    v_fma_f32 v138, v138, v60, v82
    v_fma_f32 v139, v139, v60, v83
    global_store_dwordx4 v100, v[136:139], s[42:43] offset:128
    s_waitcnt lgkmcnt(0)
    v_add_f32 v144, v144, v148
    v_add_f32 v145, v145, v149
    v_add_f32 v146, v146, v150
    v_add_f32_e64 v147, v147, v151
    v_fma_f32 v144, v144, v60, v84
    v_fma_f32 v145, v145, v60, v85
    v_fma_f32 v146, v146, v60, v86
    v_fma_f32 v147, v147, v60, v87
    global_store_dwordx4 v100, v[144:147], s[42:43] offset:256
    ds_read_b32 v27, v26 offset:32
    ds_read_b128 v[152:155], v96 offset:12800
    ds_read_b128 v[156:159], v96 offset:38400
    ds_read_b128 v[160:163], v96 offset:12928
    ds_read_b128 v[164:167], v96 offset:38528
    ds_read_b128 v[168:171], v96 offset:13056
    ds_read_b128 v[172:175], v96 offset:38656
    s_waitcnt lgkmcnt(6)
    v_cmp_ne_u32 vcc, 1, v27
    s_nop 0
    s_cbranch_vccz L_pollI1_ok
    s_mov_b32 s58, 1000000
L_pollI1:
    ds_read_b32 v27, v26 offset:32
    s_sub_u32 s58, s58, 1
    s_waitcnt lgkmcnt(0)
    s_cbranch_scc1 L_pollI1_done
    v_cmp_ne_u32 vcc, 1, v27
    s_nop 0
    s_cbranch_vccz L_pollI1_done
    s_sleep 1
    s_branch L_pollI1
L_pollI1_done:
    ds_read_b128 v[152:155], v96 offset:12800
    ds_read_b128 v[156:159], v96 offset:38400
    ds_read_b128 v[160:163], v96 offset:12928
    ds_read_b128 v[164:167], v96 offset:38528
    ds_read_b128 v[168:171], v96 offset:13056
    ds_read_b128 v[172:175], v96 offset:38656
L_pollI1_ok:
    s_waitcnt lgkmcnt(4)
    v_pk_add_f32 v[152:153], v[152:153], v[156:157]
    v_pk_add_f32 v[154:155], v[154:155], v[158:159]
    v_pk_fma_f32 v[152:153], v[60:61], v[152:153], v[88:89] op_sel:[1,0,0] op_sel_hi:[1,1,1]
    v_pk_fma_f32 v[154:155], v[60:61], v[154:155], v[90:91] op_sel:[1,0,0] op_sel_hi:[1,1,1]
    global_store_dwordx4 v101, v[152:155], s[42:43] offset:0
    s_waitcnt lgkmcnt(2)
    v_pk_add_f32 v[160:161], v[160:161], v[164:165]
    v_pk_add_f32 v[162:163], v[162:163], v[166:167]
    v_pk_fma_f32 v[160:161], v[60:61], v[160:161], v[92:93] op_sel:[1,0,0] op_sel_hi:[1,1,1]
    v_pk_fma_f32 v[162:163], v[60:61], v[162:163], v[94:95] op_sel:[1,0,0] op_sel_hi:[1,1,1]
    global_store_dwordx4 v101, v[160:163], s[42:43] offset:128
    s_waitcnt lgkmcnt(0)
    v_pk_add_f32 v[168:169], v[168:169], v[172:173]
    v_pk_add_f32 v[170:171], v[170:171], v[174:175]
    v_pk_fma_f32 v[168:169], v[60:61], v[168:169], v[20:21] op_sel:[1,0,0] op_sel_hi:[1,1,1]
    v_pk_fma_f32 v[170:171], v[60:61], v[170:171], v[22:23] op_sel:[1,0,0] op_sel_hi:[1,1,1]
    global_store_dwordx4 v101, v[168:171], s[42:43] offset:256
L_fin2:
    s_endpgm
.p2align 3
L_slow:
    s_nop 1
    s_nop 0
    v_pk_fma_f32 v[128:129], v[64:65], v[44:45], v[128:129] op_sel:[0,0,0] op_sel_hi:[0,1,1]
    v_pk_fma_f32 v[130:131], v[66:67], v[44:45], v[130:131] op_sel:[0,0,0] op_sel_hi:[0,1,1]
    v_pk_fma_f32 v[132:133], v[68:69], v[44:45], v[132:133] op_sel:[0,0,0] op_sel_hi:[0,1,1]
    v_pk_fma_f32 v[134:135], v[70:71], v[44:45], v[134:135] op_sel:[0,0,0] op_sel_hi:[0,1,1]
    v_pk_fma_f32 v[136:137], v[72:73], v[44:45], v[136:137] op_sel:[0,0,0] op_sel_hi:[0,1,1]
    v_pk_fma_f32 v[138:139], v[74:75], v[44:45], v[138:139] op_sel:[0,0,0] op_sel_hi:[0,1,1]
    v_pk_fma_f32 v[140:141], v[76:77], v[44:45], v[140:141] op_sel:[0,0,0] op_sel_hi:[0,1,1]
    v_pk_fma_f32 v[142:143], v[78:79], v[44:45], v[142:143] op_sel:[0,0,0] op_sel_hi:[0,1,1]
    v_pk_fma_f32 v[128:129], v[64:65], v[46:47], v[128:129] op_sel:[1,0,0] op_sel_hi:[1,1,1] neg_lo:[1,0,0] neg_hi:[1,0,0]
    v_pk_fma_f32 v[130:131], v[66:67], v[46:47], v[130:131] op_sel:[1,0,0] op_sel_hi:[1,1,1] neg_lo:[1,0,0] neg_hi:[1,0,0]
    v_pk_fma_f32 v[132:133], v[68:69], v[46:47], v[132:133] op_sel:[1,0,0] op_sel_hi:[1,1,1] neg_lo:[1,0,0] neg_hi:[1,0,0]
    v_pk_fma_f32 v[134:135], v[70:71], v[46:47], v[134:135] op_sel:[1,0,0] op_sel_hi:[1,1,1] neg_lo:[1,0,0] neg_hi:[1,0,0]
    v_pk_fma_f32 v[136:137], v[72:73], v[46:47], v[136:137] op_sel:[1,0,0] op_sel_hi:[1,1,1] neg_lo:[1,0,0] neg_hi:[1,0,0]
    v_pk_fma_f32 v[138:139], v[74:75], v[46:47], v[138:139] op_sel:[1,0,0] op_sel_hi:[1,1,1] neg_lo:[1,0,0] neg_hi:[1,0,0]
    v_pk_fma_f32 v[140:141], v[76:77], v[46:47], v[140:141] op_sel:[1,0,0] op_sel_hi:[1,1,1] neg_lo:[1,0,0] neg_hi:[1,0,0]
    v_pk_fma_f32 v[142:143], v[78:79], v[46:47], v[142:143] op_sel:[1,0,0] op_sel_hi:[1,1,1] neg_lo:[1,0,0] neg_hi:[1,0,0]
    v_cvt_pk_bf16_f32 v216, v128, v130
    v_cvt_pk_bf16_f32 v217, v132, v134
    v_cvt_pk_bf16_f32 v218, v136, v138
    v_cvt_pk_bf16_f32 v219, v140, v142
    buffer_store_dwordx4 v[216:219], v29, s[68:71], s60 offen offset:0 sc1
    v_cvt_pk_bf16_f32 v220, v129, v131
    v_cvt_pk_bf16_f32 v221, v133, v135
    v_cvt_pk_bf16_f32 v222, v137, v139
    v_cvt_pk_bf16_f32 v223, v141, v143
    buffer_store_dwordx4 v[220:223], v29, s[68:71], s60 offen offset:512 sc1
    v_pk_fma_f32 v[144:145], v[80:81], v[44:45], v[144:145] op_sel:[0,0,0] op_sel_hi:[0,1,1]
    v_pk_fma_f32 v[146:147], v[82:83], v[44:45], v[146:147] op_sel:[0,0,0] op_sel_hi:[0,1,1]
    v_pk_fma_f32 v[148:149], v[84:85], v[44:45], v[148:149] op_sel:[0,0,0] op_sel_hi:[0,1,1]
    v_pk_fma_f32 v[150:151], v[86:87], v[44:45], v[150:151] op_sel:[0,0,0] op_sel_hi:[0,1,1]
    v_pk_fma_f32 v[152:153], v[88:89], v[44:45], v[152:153] op_sel:[0,0,0] op_sel_hi:[0,1,1]
    v_pk_fma_f32 v[154:155], v[90:91], v[44:45], v[154:155] op_sel:[0,0,0] op_sel_hi:[0,1,1]
    v_pk_fma_f32 v[156:157], v[92:93], v[44:45], v[156:157] op_sel:[0,0,0] op_sel_hi:[0,1,1]
    v_pk_fma_f32 v[158:159], v[94:95], v[44:45], v[158:159] op_sel:[0,0,0] op_sel_hi:[0,1,1]
    v_pk_fma_f32 v[144:145], v[80:81], v[46:47], v[144:145] op_sel:[1,0,0] op_sel_hi:[1,1,1] neg_lo:[1,0,0] neg_hi:[1,0,0]
    v_pk_fma_f32 v[146:147], v[82:83], v[46:47], v[146:147] op_sel:[1,0,0] op_sel_hi:[1,1,1] neg_lo:[1,0,0] neg_hi:[1,0,0]
    v_pk_fma_f32 v[148:149], v[84:85], v[46:47], v[148:149] op_sel:[1,0,0] op_sel_hi:[1,1,1] neg_lo:[1,0,0] neg_hi:[1,0,0]
    v_pk_fma_f32 v[150:151], v[86:87], v[46:47], v[150:151] op_sel:[1,0,0] op_sel_hi:[1,1,1] neg_lo:[1,0,0] neg_hi:[1,0,0]
    v_pk_fma_f32 v[152:153], v[88:89], v[46:47], v[152:153] op_sel:[1,0,0] op_sel_hi:[1,1,1] neg_lo:[1,0,0] neg_hi:[1,0,0]
    v_pk_fma_f32 v[154:155], v[90:91], v[46:47], v[154:155] op_sel:[1,0,0] op_sel_hi:[1,1,1] neg_lo:[1,0,0] neg_hi:[1,0,0]
    v_pk_fma_f32 v[156:157], v[92:93], v[46:47], v[156:157] op_sel:[1,0,0] op_sel_hi:[1,1,1] neg_lo:[1,0,0] neg_hi:[1,0,0]
    v_pk_fma_f32 v[158:159], v[94:95], v[46:47], v[158:159] op_sel:[1,0,0] op_sel_hi:[1,1,1] neg_lo:[1,0,0] neg_hi:[1,0,0]
    v_cvt_pk_bf16_f32 v224, v144, v146
    v_cvt_pk_bf16_f32 v225, v148, v150
    v_cvt_pk_bf16_f32 v226, v152, v154
    v_cvt_pk_bf16_f32 v227, v156, v158
    buffer_store_dwordx4 v[224:227], v30, s[68:71], s60 offen offset:256 sc1
    v_cvt_pk_bf16_f32 v228, v145, v147
    v_cvt_pk_bf16_f32 v229, v149, v151
    v_cvt_pk_bf16_f32 v230, v153, v155
    v_cvt_pk_bf16_f32 v231, v157, v159
    buffer_store_dwordx4 v[228:231], v30, s[68:71], s60 offen offset:768 sc1
    v_pk_fma_f32 v[160:161], v[64:65], v[46:47], v[160:161] op_sel:[0,0,0] op_sel_hi:[0,1,1]
    v_pk_fma_f32 v[162:163], v[66:67], v[46:47], v[162:163] op_sel:[0,0,0] op_sel_hi:[0,1,1]
    v_pk_fma_f32 v[164:165], v[68:69], v[46:47], v[164:165] op_sel:[0,0,0] op_sel_hi:[0,1,1]
    v_pk_fma_f32 v[166:167], v[70:71], v[46:47], v[166:167] op_sel:[0,0,0] op_sel_hi:[0,1,1]
    v_pk_fma_f32 v[168:169], v[72:73], v[46:47], v[168:169] op_sel:[0,0,0] op_sel_hi:[0,1,1]
    v_pk_fma_f32 v[170:171], v[74:75], v[46:47], v[170:171] op_sel:[0,0,0] op_sel_hi:[0,1,1]
    v_pk_fma_f32 v[172:173], v[76:77], v[46:47], v[172:173] op_sel:[0,0,0] op_sel_hi:[0,1,1]
    v_pk_fma_f32 v[174:175], v[78:79], v[46:47], v[174:175] op_sel:[0,0,0] op_sel_hi:[0,1,1]
    v_pk_fma_f32 v[160:161], v[64:65], v[44:45], v[160:161] op_sel:[1,0,0] op_sel_hi:[1,1,1]
    v_pk_fma_f32 v[162:163], v[66:67], v[44:45], v[162:163] op_sel:[1,0,0] op_sel_hi:[1,1,1]
    v_pk_fma_f32 v[164:165], v[68:69], v[44:45], v[164:165] op_sel:[1,0,0] op_sel_hi:[1,1,1]
    v_pk_fma_f32 v[166:167], v[70:71], v[44:45], v[166:167] op_sel:[1,0,0] op_sel_hi:[1,1,1]
    v_pk_fma_f32 v[168:169], v[72:73], v[44:45], v[168:169] op_sel:[1,0,0] op_sel_hi:[1,1,1]
    v_pk_fma_f32 v[170:171], v[74:75], v[44:45], v[170:171] op_sel:[1,0,0] op_sel_hi:[1,1,1]
    v_pk_fma_f32 v[172:173], v[76:77], v[44:45], v[172:173] op_sel:[1,0,0] op_sel_hi:[1,1,1]
    v_pk_fma_f32 v[174:175], v[78:79], v[44:45], v[174:175] op_sel:[1,0,0] op_sel_hi:[1,1,1]
    v_cvt_pk_bf16_f32 v232, -v160, -v162
    v_cvt_pk_bf16_f32 v233, -v164, -v166
    v_cvt_pk_bf16_f32 v234, -v168, -v170
    v_cvt_pk_bf16_f32 v235, -v172, -v174
    buffer_store_dwordx4 v[232:235], v29, s[68:71], s60 offen offset:1024 sc1
    v_cvt_pk_bf16_f32 v236, -v161, -v163
    v_cvt_pk_bf16_f32 v237, -v165, -v167
    v_cvt_pk_bf16_f32 v238, -v169, -v171
    v_cvt_pk_bf16_f32 v239, -v173, -v175
    buffer_store_dwordx4 v[236:239], v29, s[68:71], s60 offen offset:1536 sc1
    v_pk_fma_f32 v[176:177], v[80:81], v[46:47], v[176:177] op_sel:[0,0,0] op_sel_hi:[0,1,1]
    v_pk_fma_f32 v[178:179], v[82:83], v[46:47], v[178:179] op_sel:[0,0,0] op_sel_hi:[0,1,1]
    v_pk_fma_f32 v[180:181], v[84:85], v[46:47], v[180:181] op_sel:[0,0,0] op_sel_hi:[0,1,1]
    v_pk_fma_f32 v[182:183], v[86:87], v[46:47], v[182:183] op_sel:[0,0,0] op_sel_hi:[0,1,1]
    v_pk_fma_f32 v[184:185], v[88:89], v[46:47], v[184:185] op_sel:[0,0,0] op_sel_hi:[0,1,1]
    v_pk_fma_f32 v[186:187], v[90:91], v[46:47], v[186:187] op_sel:[0,0,0] op_sel_hi:[0,1,1]
    v_pk_fma_f32 v[188:189], v[92:93], v[46:47], v[188:189] op_sel:[0,0,0] op_sel_hi:[0,1,1]
    v_pk_fma_f32 v[190:191], v[94:95], v[46:47], v[190:191] op_sel:[0,0,0] op_sel_hi:[0,1,1]
    v_pk_fma_f32 v[176:177], v[80:81], v[44:45], v[176:177] op_sel:[1,0,0] op_sel_hi:[1,1,1]
    v_pk_fma_f32 v[178:179], v[82:83], v[44:45], v[178:179] op_sel:[1,0,0] op_sel_hi:[1,1,1]
    v_pk_fma_f32 v[180:181], v[84:85], v[44:45], v[180:181] op_sel:[1,0,0] op_sel_hi:[1,1,1]
    v_pk_fma_f32 v[182:183], v[86:87], v[44:45], v[182:183] op_sel:[1,0,0] op_sel_hi:[1,1,1]
    v_pk_fma_f32 v[184:185], v[88:89], v[44:45], v[184:185] op_sel:[1,0,0] op_sel_hi:[1,1,1]
    v_pk_fma_f32 v[186:187], v[90:91], v[44:45], v[186:187] op_sel:[1,0,0] op_sel_hi:[1,1,1]
    v_pk_fma_f32 v[188:189], v[92:93], v[44:45], v[188:189] op_sel:[1,0,0] op_sel_hi:[1,1,1]
    v_pk_fma_f32 v[190:191], v[94:95], v[44:45], v[190:191] op_sel:[1,0,0] op_sel_hi:[1,1,1]
    v_cvt_pk_bf16_f32 v240, -v176, -v178
    v_cvt_pk_bf16_f32 v241, -v180, -v182
    v_cvt_pk_bf16_f32 v242, -v184, -v186
    v_cvt_pk_bf16_f32 v243, -v188, -v190
    buffer_store_dwordx4 v[240:243], v30, s[68:71], s60 offen offset:1280 sc1
    v_cvt_pk_bf16_f32 v244, -v177, -v179
    v_cvt_pk_bf16_f32 v245, -v181, -v183
    v_cvt_pk_bf16_f32 v246, -v185, -v187
    v_cvt_pk_bf16_f32 v247, -v189, -v191
    buffer_store_dwordx4 v[244:247], v30, s[68:71], s60 offen offset:1792 sc1
    s_waitcnt vmcnt(8)
    v_lshlrev_b32 v64, 16, v102
    v_and_b32 v65, 0xffff0000, v102
    v_lshlrev_b32_e64 v66, 16, v103
    v_and_b32 v67, 0xffff0000, v103
    v_lshlrev_b32_e64 v68, 16, v110
    v_and_b32 v69, 0xffff0000, v110
    v_lshlrev_b32_e64 v70, 16, v111
    v_and_b32 v71, 0xffff0000, v111
    v_lshlrev_b32_e64 v72, 16, v98
    v_and_b32 v73, 0xffff0000, v98
    v_lshlrev_b32_e64 v74, 16, v99
    v_and_b32 v75, 0xffff0000, v99
    v_lshlrev_b32_e64 v76, 16, v200
    v_and_b32 v77, 0xffff0000, v200
    v_lshlrev_b32_e64 v78, 16, v201
    v_and_b32 v79, 0xffff0000, v201
    v_lshlrev_b32_e64 v80, 16, v202
    v_and_b32 v81, 0xffff0000, v202
    v_lshlrev_b32_e64 v82, 16, v203
    v_and_b32 v83, 0xffff0000, v203
    v_lshlrev_b32_e64 v84, 16, v204
    v_and_b32 v85, 0xffff0000, v204
    v_lshlrev_b32_e64 v86, 16, v205
    v_and_b32 v87, 0xffff0000, v205
    v_lshlrev_b32_e64 v88, 16, v206
    v_and_b32 v89, 0xffff0000, v206
    v_lshlrev_b32_e64 v90, 16, v207
    v_and_b32 v91, 0xffff0000, v207
    v_lshlrev_b32_e64 v92, 16, v124
    v_and_b32 v93, 0xffff0000, v124
    v_lshlrev_b32_e64 v94, 16, v125
    v_and_b32 v95, 0xffff0000, v125
    v_lshlrev_b32_e64 v20, 16, v126
    v_and_b32 v21, 0xffff0000, v126
    v_lshlrev_b32_e64 v22, 16, v127
    v_and_b32 v23, 0xffff0000, v127
    v_pk_mul_f32 v[76:77], v[76:77], v[64:65]
    v_pk_mul_f32 v[78:79], v[78:79], v[66:67]
    v_pk_mul_f32 v[80:81], v[80:81], v[68:69]
    v_pk_mul_f32 v[82:83], v[82:83], v[70:71]
    v_pk_mul_f32 v[84:85], v[84:85], v[72:73]
    v_pk_mul_f32 v[86:87], v[86:87], v[74:75]
    v_pk_mul_f32 v[88:89], v[88:89], v[64:65]
    v_pk_mul_f32 v[90:91], v[90:91], v[66:67]
    v_pk_mul_f32 v[92:93], v[92:93], v[68:69]
    v_pk_mul_f32 v[94:95], v[94:95], v[70:71]
    v_pk_mul_f32 v[20:21], v[20:21], v[72:73]
    v_pk_mul_f32 v[22:23], v[22:23], v[74:75]
    s_mov_b64 exec, 1
    s_waitcnt vmcnt(0)
    global_store_dword v6, v122, s[46:47] sc1
    s_mov_b64 exec, -1
    v_mov_b64 v[32:33], 0
    v_mov_b64 v[34:35], 0
    v_mov_b64 v[36:37], 0
    v_mov_b64 v[38:39], 0
    v_mov_b64 v[40:41], 0
    v_mov_b64 v[42:43], 0
    v_mov_b64 v[44:45], 0
    v_mov_b64 v[46:47], 0
    v_mov_b64 v[48:49], 0
    v_mov_b64 v[50:51], 0
    v_mov_b64 v[52:53], 0
    v_mov_b64 v[54:55], 0
    s_branch L_tail_done
.p2align 3
L_A:
    s_mul_i32 s60, s50, 72
    s_mul_i32 s4, s49, 6
    s_lshl_b32 s5, s49, 2
    s_sub_u32 s4, s4, 144
    s_sub_u32 s5, s5, 24
    s_cmp_ge_u32 s49, 24
    s_cselect_b32 s4, s4, s5
    s_add_u32 s60, s60, s4
    s_add_u32 s61, s60, s48
    s_and_b32 s5, s48, 1
    s_add_u32 s5, s5, 4
    s_cmp_ge_u32 s49, 24
    s_cselect_b32 s64, s5, s48
    s_add_u32 s65, s60, s64
    s_lshl_b32 s62, s61, 8
    v_lshl_add_u32 v26, v1, 2, s62
    s_lshl_b32 s62, s61, 1
    v_mov_b32_e64 v27, s62
    s_lshl_b32 s62, s65, 8
    s_and_b32 s4, s48, 2
    s_lshl_b32 s4, s4, 6
    s_add_u32 s62, s62, s4
    v_lshl_add_u32 v24, v1, 1, s62
    s_lshl_b32 s62, s65, 1
    v_mov_b32 v25, s62
    v_mov_b32 v60, 0
    v_mov_b32_e64 v61, 0
    s_waitcnt lgkmcnt(0)
    global_load_ushort v16, v24, s[10:11]
    global_load_ushort v17, v24, s[12:13]
    global_load_ushort v20, v25, s[18:19]
    global_load_dword v10, v26, s[10:11]
    global_load_dword v11, v26, s[12:13]
    global_load_ushort v14, v27, s[18:19]
    global_load_ushort v18, v24, s[14:15]
    global_load_ushort v19, v24, s[16:17]
    global_load_ushort v21, v25, s[20:21]
    global_load_dword v12, v26, s[14:15]
    global_load_dword v13, v26, s[16:17]
    global_load_ushort v15, v27, s[20:21]
    global_load_dword v22, v60, s[46:47]
    s_lshl_b32 s4, s48, 3
    s_add_u32 s4, s4, 149504
    v_mov_b32 v4, s4
    ds_write_b64 v4, v[60:61]
    s_cmp_ge_u32 s49, 24
    s_cbranch_scc1 L_nox
    s_cmp_ge_u32 s49, 12
    s_mov_b32 s4, 3393292320
    s_mov_b32 s5, 155585890
    s_cmov_b32 s4, 899438227
    s_cmov_b32 s5, 250833482
    s_cselect_b32 s52, 12, 0
    s_sub_u32 s52, s49, s52
    s_mul_i32 s52, s52, 5
    s_lshr_b64 s[4:5], s[4:5], s52
    s_and_b32 s52, s4, 7
    s_bfe_u32 s4, s4, 0x20003
    s_and_b32 s51, s4, 1
    s_lshl_b32 s56, s50, 2
    s_add_u32 s56, s56, s4
    s_mul_i32 s57, s52, 3
    s_lshr_b32 s57, s57, 1
    s_mul_i32 s4, s4, 0
    s_add_u32 s57, s57, s4
    s_mul_i32 s4, s50, 3
    s_add_u32 s57, s57, s4
    s_mul_hi_u32 s4, s57, 0x1C71C71D
    s_mul_i32 s4, s4, 9
    s_sub_u32 s57, s57, s4
    s_lshl_b32 s57, s57, 7
    s_lshl_b32 s4, s56, 6
    v_lshrrev_b32 v96, 3, v0
    v_add_u32 v97, s4, v96
    v_and_b32 v98, 7, v0
    s_mul_i32 s5, s52, 192
    v_lshl_add_u32 v99, v98, 3, s5
    v_mul_u32_u24 v100, 1152, v97
    v_add_u32_e64 v100, v100, v99
    v_add_u32 v101, 36864, v100
    global_load_dwordx2 v[28:29], v100, s[8:9] offset:0
    global_load_dwordx2 v[34:35], v101, s[8:9] offset:0
    global_load_dwordx2 v[44:45], v99, s[38:39] offset:0
    global_load_dwordx2 v[30:31], v100, s[8:9] offset:64
    global_load_dwordx2 v[36:37], v101, s[8:9] offset:64
    global_load_dwordx2 v[46:47], v99, s[38:39] offset:64
    global_load_dwordx2 v[32:33], v100, s[8:9] offset:128
    global_load_dwordx2 v[38:39], v101, s[8:9] offset:128
    global_load_dwordx2 v[48:49], v99, s[38:39] offset:128
    v_lshlrev_b32 v100, 1, v100
    v_lshlrev_b32 v101, 1, v101
L_nox:
    s_waitcnt lgkmcnt(0)
    s_barrier
    s_mov_b32 s76, s46
    s_mov_b32 s77, s47
    s_mov_b32 s78, 268435456
    s_mov_b32 s79, 0x20000
    s_mul_i32 s68, s48, 8704
    s_add_u32 s69, s68, 34816
    s_add_u32 s70, s69, 4608
    s_mul_i32 s66, s64, 8704
    s_add_u32 s66, s66, 34816
    s_mov_b32 m0, s68
    s_mov_b32 s74, 0xffff
    s_mov_b32 s75, 0xffff
    s_cmp_lt_u32 s48, 2
    s_cselect_b32 s63, s66, s69
    s_cselect_b32 s67, 0, 64
    v_mov_b64 v[62:63], 0
    s_nop 0
    v_lshl_add_u32 v8, v1, 4, s69
    v_lshl_add_u32 v9, v1, 4, s63
    ds_write_b128 v8, v[60:63] offset:4608
    ds_write_b128 v8, v[60:63] offset:5632
    ds_write_b128 v8, v[60:63] offset:6656
    ds_write_b128 v8, v[60:63] offset:7680
    ds_write_b128 v9, v[60:63] offset:4608
    ds_write_b128 v9, v[60:63] offset:5632
    ds_write_b128 v9, v[60:63] offset:6656
    ds_write_b128 v9, v[60:63] offset:7680
    v_mul_u32_u24 v59, 544, v2
    v_lshl_add_u32 v59, v3, 4, v59
    v_add_u32 v59, s68, v59
    v_and_b32 v58, 7, v2
    v_lshlrev_b32_e64 v58, 2, v58
    s_mov_b32 s62, 0x43222100
    v_lshrrev_b32 v58, v58, s62
    v_and_b32 v58, 15, v58
    v_lshrrev_b32 v57, 3, v2
    v_mad_u32_u24 v58, v57, 5, v58
    v_mul_u32_u24 v58, 544, v58
    v_lshl_add_u32 v58, v3, 4, v58
    v_add_u32 v58, s68, v58
    v_lshrrev_b32 v5, 1, v3
    v_lshlrev_b32_e64 v5, 8, v5
    v_lshl_add_u32 v5, v2, 4, v5
    v_and_b32_e64 v6, 1, v3
    v_lshl_add_u32 v5, v6, 3, v5
    v_sub_u32 v5, 568, v5
    v_lshrrev_b32 v6, 1, v2
    v_and_b32 v8, 1, v2
    v_lshlrev_b32_e64 v9, 6, v3
    v_lshl_add_u32 v9, v6, 2, v9
    v_lshlrev_b32 v23, 8, v8
    v_sub_u32 v23, v23, v9
    v_add_u32 v23, 2524, v23
    v_lshlrev_b32_e64 v9, 7, v3
    v_lshl_add_u32 v9, v6, 2, v9
    v_lshlrev_b32 v8, 1, v8
    v_sub_u32 v8, v8, v9
    v_add_u32 v8, 3292, v8
    v_cmp_gt_u32 vcc, 2, v3
    s_nop 1
    v_cndmask_b32 v6, v8, v23, vcc
    s_mul_i32 s71, s50, 14
    s_add_u32 s71, s71, s49
    s_lshl_b32 s71, s71, 5
    s_add_u32 s71, s71, s48
    s_lshl_b32 s71, s71, 2
    s_add_u32 s71, s71, 390912
    v_lshlrev_b32 v56, 3, v3
    v_sub_u32 v56, v56, v2
    v_add_u32 v56, 15, v56
    v_lshlrev_b32 v56, 1, v56
    v_and_b32 v57, 1, v2
    v_cmp_eq_u32 vcc, 0, v57
    v_mov_b32 v57, 1214
    v_lshlrev_b32 v24, 2, v3
    v_cndmask_b32 v57, 0, v57, vcc
    v_add_u32 v56, v56, v57
    v_sub_u32 v24, v24, v2
    v_add_u32 v24, 607, v24
    v_lshlrev_b32 v24, 2, v24
    v_lshlrev_b32 v25, 5, v2
    v_lshl_add_u32 v25, v3, 4, v25
    v_add_u32 v25, 32, v25
    v_and_b32 v26, 1, v3
    v_lshlrev_b32 v26, 9, v26
    v_lshrrev_b32 v27, 2, v2
    v_lshl_add_u32 v26, v27, 7, v26
    v_lshrrev_b32_e64 v27, 1, v3
    v_lshl_add_u32 v26, v27, 6, v26
    v_and_b32_e64 v27, 3, v2
    v_lshl_add_u32 v26, v27, 4, v26
    v_and_b32 v27, 3, v1
    v_lshlrev_b32 v27, 3, v27
    v_add_u32 v27, 149536, v27
    s_and_b32 s4, s48, 1
    s_lshl_b32 s4, s4, 3
    s_add_u32 s4, s4, 149508
    s_cmp_ge_u32 s49, 24
    s_cselect_b32 s4, s4, 149536
    v_mov_b32 v57, s4
    v_cmp_gt_u32 vcc, 32, v1
    s_nop 1
    v_cndmask_b32 v27, v57, v27, vcc
    v_add_u32 v61, s70, v5
    v_mov_b32 v62, s70
    v_add_u32_e64 v63, s70, v6
    s_and_b32 s4, s48, 1
    s_mul_i32 s4, s4, 3072
    s_add_u32 s4, s4, 100352
    v_lshl_add_u32 v40, v1, 4, s4
    v_mov_b32 v41, 1
    s_cmp_lt_u32 s49, 24
    s_cbranch_scc1 L_tab
    s_waitcnt vmcnt(10)
    v_lshlrev_b32_e64 v20, 16, v20
    v_mul_f32 v20, 0x3fb8aa3b, v20
    v_lshlrev_b32 v64, 16, v16
    v_exp_f32 v20, v20
    v_mul_f32 v64, 0x3fb8aa3b, v64
    v_exp_f32_e64 v64, v64
    v_cvt_pk_bf16_f32 v20, v20, v20
    v_lshlrev_b32_e64 v65, 16, v17
    v_cvt_pk_bf16_f32 v16, v64, v64
    v_and_b32 v20, 0xffff0000, v20
    v_lshlrev_b32 v64, 16, v16
    s_waitcnt vmcnt(4)
    v_pk_mul_f32 v[64:65], v[20:21], v[64:65] op_sel:[0,0] op_sel_hi:[0,1]
    v_mul_f32 v64, 0xbfb8aa3b, v64
    v_mul_f32_e64 v65, 0x3e22f983, v65
    v_mul_f32 v84, 0x41000000, v64
    v_mul_f32 v85, 0x41000000, v65
    v_mul_f32 v88, 1.0, v64
    v_mul_f32 v89, 1.0, v65
    v_mul_f32 v92, 0x43000000, v64
    v_mul_f32 v93, 0x43000000, v65
    v_exp_f32 v84, v84
    v_fract_f32 v85, v85
    v_exp_f32 v88, v88
    v_fract_f32 v89, v89
    v_exp_f32 v92, v92
    v_fract_f32 v93, v93
    v_cos_f32 v68, v85
    v_sin_f32 v69, v85
    v_cos_f32 v76, v89
    v_sin_f32 v77, v89
    v_cos_f32 v80, v93
    v_sin_f32 v81, v93
    v_mul_f32 v68, v68, v84
    v_mul_f32 v69, v69, v84
    v_mul_f32 v76, v76, v88
    v_mul_f32 v77, v77, v88
    v_mul_f32 v80, v80, v92
    v_mul_f32 v81, v81, v92
    v_pk_mul_f32 v[84:85], v[68:69], v[68:69] op_sel:[0,0] op_sel_hi:[0,1]
    v_pk_fma_f32 v[72:73], v[68:69], v[68:69], v[84:85] op_sel:[1,1,0] op_sel_hi:[1,0,1] neg_lo:[1,0,0]
    v_mov_b32 v238, 0x3f80
    v_cvt_pk_bf16_f32 v148, v68, -v69
    v_cvt_pk_bf16_f32 v150, v72, -v73
    v_pk_mul_f32 v[84:85], v[68:69], v[72:73] op_sel:[0,0] op_sel_hi:[0,1]
    v_pk_mul_f32 v[88:89], v[72:73], v[72:73] op_sel:[0,0] op_sel_hi:[0,1]
    v_pk_fma_f32 v[140:141], v[68:69], v[72:73], v[84:85] op_sel:[1,1,0] op_sel_hi:[1,0,1] neg_lo:[1,0,0]
    v_pk_fma_f32 v[144:145], v[72:73], v[72:73], v[88:89] op_sel:[1,1,0] op_sel_hi:[1,0,1] neg_lo:[1,0,0]
    v_cvt_pk_bf16_f32 v152, v140, -v141
    ds_write_addtid_b32 v238 offset:0
    ds_write_addtid_b32 v148 offset:544
    ds_write_addtid_b32 v150 offset:1088
    ds_write_addtid_b32 v152 offset:1632
    v_cvt_pk_bf16_f32 v154, v144, -v145
    v_pk_mul_f32 v[84:85], v[140:141], v[72:73] op_sel:[0,0] op_sel_hi:[0,1]
    v_pk_mul_f32 v[88:89], v[144:145], v[72:73] op_sel:[0,0] op_sel_hi:[0,1]
    v_pk_fma_f32 v[140:141], v[140:141], v[72:73], v[84:85] op_sel:[1,1,0] op_sel_hi:[1,0,1] neg_lo:[1,0,0]
    v_pk_fma_f32 v[144:145], v[144:145], v[72:73], v[88:89] op_sel:[1,1,0] op_sel_hi:[1,0,1] neg_lo:[1,0,0]
    v_cvt_pk_bf16_f32 v232, v140, -v141
    v_cvt_pk_bf16_f32 v234, v144, -v145
    v_pk_mul_f32 v[84:85], v[140:141], v[72:73] op_sel:[0,0] op_sel_hi:[0,1]
    v_pk_mul_f32 v[88:89], v[144:145], v[72:73] op_sel:[0,0] op_sel_hi:[0,1]
    v_pk_fma_f32 v[140:141], v[140:141], v[72:73], v[84:85] op_sel:[1,1,0] op_sel_hi:[1,0,1] neg_lo:[1,0,0]
    v_pk_fma_f32 v[144:145], v[144:145], v[72:73], v[88:89] op_sel:[1,1,0] op_sel_hi:[1,0,1] neg_lo:[1,0,0]
    v_cvt_pk_bf16_f32 v236, v140, -v141
    ds_write_addtid_b32 v154 offset:2176
    ds_write_addtid_b32 v232 offset:2720
    ds_write_addtid_b32 v234 offset:3264
    ds_write_addtid_b32 v236 offset:3808
    v_cvt_pk_bf16_f32 v238, v144, -v145
    v_pk_mul_f32 v[84:85], v[140:141], v[72:73] op_sel:[0,0] op_sel_hi:[0,1]
    v_pk_mul_f32 v[88:89], v[144:145], v[72:73] op_sel:[0,0] op_sel_hi:[0,1]
    v_pk_fma_f32 v[140:141], v[140:141], v[72:73], v[84:85] op_sel:[1,1,0] op_sel_hi:[1,0,1] neg_lo:[1,0,0]
    v_pk_fma_f32 v[144:145], v[144:145], v[72:73], v[88:89] op_sel:[1,1,0] op_sel_hi:[1,0,1] neg_lo:[1,0,0]
    v_cvt_pk_bf16_f32 v148, v140, -v141
    v_cvt_pk_bf16_f32 v150, v144, -v145
    v_pk_mul_f32 v[84:85], v[140:141], v[72:73] op_sel:[0,0] op_sel_hi:[0,1]
    v_pk_mul_f32 v[88:89], v[144:145], v[72:73] op_sel:[0,0] op_sel_hi:[0,1]
    v_pk_fma_f32 v[140:141], v[140:141], v[72:73], v[84:85] op_sel:[1,1,0] op_sel_hi:[1,0,1] neg_lo:[1,0,0]
    v_pk_fma_f32 v[144:145], v[144:145], v[72:73], v[88:89] op_sel:[1,1,0] op_sel_hi:[1,0,1] neg_lo:[1,0,0]
    v_cvt_pk_bf16_f32 v152, v140, -v141
    ds_write_addtid_b32 v238 offset:4352
    ds_write_addtid_b32 v148 offset:4896
    ds_write_addtid_b32 v150 offset:5440
    ds_write_addtid_b32 v152 offset:5984
    v_cvt_pk_bf16_f32 v154, v144, -v145
    v_pk_mul_f32 v[84:85], v[140:141], v[72:73] op_sel:[0,0] op_sel_hi:[0,1]
    v_pk_mul_f32 v[88:89], v[144:145], v[72:73] op_sel:[0,0] op_sel_hi:[0,1]
    v_pk_fma_f32 v[140:141], v[140:141], v[72:73], v[84:85] op_sel:[1,1,0] op_sel_hi:[1,0,1] neg_lo:[1,0,0]
    v_pk_fma_f32 v[144:145], v[144:145], v[72:73], v[88:89] op_sel:[1,1,0] op_sel_hi:[1,0,1] neg_lo:[1,0,0]
    v_cvt_pk_bf16_f32 v232, v140, -v141
    v_cvt_pk_bf16_f32 v234, v144, -v145
    v_pk_mul_f32 v[84:85], v[140:141], v[72:73] op_sel:[0,0] op_sel_hi:[0,1]
    v_pk_fma_f32 v[140:141], v[140:141], v[72:73], v[84:85] op_sel:[1,1,0] op_sel_hi:[1,0,1] neg_lo:[1,0,0]
    v_cvt_pk_bf16_f32 v236, v140, -v141
    ds_write_addtid_b32 v154 offset:6528
    ds_write_addtid_b32 v232 offset:7072
    ds_write_addtid_b32 v234 offset:7616
    ds_write_addtid_b32 v236 offset:8160
    ds_read_b128 v[156:159], v59 offset:0
    ds_read_b128 v[160:163], v59 offset:64
    ds_read_b128 v[164:167], v59 offset:128
    ds_read_b128 v[168:171], v59 offset:192
    v_add_f32 v20, v20, v20
    v_lshlrev_b32 v104, 16, v18
    v_lshlrev_b32_e64 v105, 16, v19
    v_pk_mul_f32 v[104:105], v[20:21], v[104:105] op_sel:[0,0] op_sel_hi:[0,1]
    v_pk_mul_f32 v[84:85], v[76:77], v[76:77] op_sel:[0,0] op_sel_hi:[0,1]
    v_pk_mul_f32 v[88:89], v[104:105], v[76:77] op_sel:[0,0] op_sel_hi:[0,1]
    v_pk_mul_f32 v[92:93], v[104:105], v[68:69] op_sel:[0,0] op_sel_hi:[0,1]
    v_pk_fma_f32 v[140:141], v[76:77], v[76:77], v[84:85] op_sel:[1,1,0] op_sel_hi:[1,0,1] neg_lo:[1,0,0]
    v_pk_fma_f32 v[108:109], v[104:105], v[76:77], v[88:89] op_sel:[1,1,0] op_sel_hi:[1,0,1] neg_lo:[1,0,0]
    v_pk_fma_f32 v[136:137], v[104:105], v[68:69], v[92:93] op_sel:[1,1,0] op_sel_hi:[1,0,1] neg_lo:[1,0,0]
    v_cvt_pk_bf16_f32 v238, v104, v105
    v_cvt_pk_bf16_f32 v148, v108, v109
    v_pk_mul_f32 v[84:85], v[104:105], v[140:141] op_sel:[0,0] op_sel_hi:[0,1]
    v_pk_mul_f32 v[88:89], v[108:109], v[140:141] op_sel:[0,0] op_sel_hi:[0,1]
    v_pk_fma_f32 v[112:113], v[104:105], v[140:141], v[84:85] op_sel:[1,1,0] op_sel_hi:[1,0,1] neg_lo:[1,0,0]
    v_pk_fma_f32 v[116:117], v[108:109], v[140:141], v[88:89] op_sel:[1,1,0] op_sel_hi:[1,0,1] neg_lo:[1,0,0]
    v_cvt_pk_bf16_f32 v150, v112, v113
    v_cvt_pk_bf16_f32 v152, v116, v117
    ds_write_addtid_b32 v238 offset:0
    ds_write_addtid_b32 v148 offset:544
    ds_write_addtid_b32 v150 offset:1088
    ds_write_addtid_b32 v152 offset:1632
    v_pk_mul_f32 v[84:85], v[112:113], v[140:141] op_sel:[0,0] op_sel_hi:[0,1]
    v_pk_mul_f32 v[88:89], v[116:117], v[140:141] op_sel:[0,0] op_sel_hi:[0,1]
    v_pk_fma_f32 v[120:121], v[112:113], v[140:141], v[84:85] op_sel:[1,1,0] op_sel_hi:[1,0,1] neg_lo:[1,0,0]
    v_pk_fma_f32 v[124:125], v[116:117], v[140:141], v[88:89] op_sel:[1,1,0] op_sel_hi:[1,0,1] neg_lo:[1,0,0]
    v_cvt_pk_bf16_f32 v154, v120, v121
    v_cvt_pk_bf16_f32 v232, v124, v125
    v_pk_mul_f32 v[84:85], v[120:121], v[140:141] op_sel:[0,0] op_sel_hi:[0,1]
    v_pk_mul_f32 v[88:89], v[124:125], v[140:141] op_sel:[0,0] op_sel_hi:[0,1]
    v_pk_fma_f32 v[128:129], v[120:121], v[140:141], v[84:85] op_sel:[1,1,0] op_sel_hi:[1,0,1] neg_lo:[1,0,0]
    v_pk_fma_f32 v[132:133], v[124:125], v[140:141], v[88:89] op_sel:[1,1,0] op_sel_hi:[1,0,1] neg_lo:[1,0,0]
    v_cvt_pk_bf16_f32 v234, v128, v129
    v_cvt_pk_bf16_f32 v236, v132, v133
    ds_write_addtid_b32 v154 offset:2176
    ds_write_addtid_b32 v232 offset:2720
    ds_write_addtid_b32 v234 offset:3264
    ds_write_addtid_b32 v236 offset:3808
    v_pk_mul_f32 v[84:85], v[104:105], v[80:81] op_sel:[0,0] op_sel_hi:[0,1]
    v_pk_mul_f32 v[88:89], v[108:109], v[80:81] op_sel:[0,0] op_sel_hi:[0,1]
    v_pk_mul_f32 v[92:93], v[112:113], v[80:81] op_sel:[0,0] op_sel_hi:[0,1]
    v_pk_fma_f32 v[104:105], v[104:105], v[80:81], v[84:85] op_sel:[1,1,0] op_sel_hi:[1,0,1] neg_lo:[1,0,0]
    v_pk_fma_f32 v[108:109], v[108:109], v[80:81], v[88:89] op_sel:[1,1,0] op_sel_hi:[1,0,1] neg_lo:[1,0,0]
    v_pk_fma_f32 v[112:113], v[112:113], v[80:81], v[92:93] op_sel:[1,1,0] op_sel_hi:[1,0,1] neg_lo:[1,0,0]
    v_cvt_pk_bf16_f32 v238, v104, v105
    v_cvt_pk_bf16_f32 v148, v108, v109
    v_cvt_pk_bf16_f32 v150, v112, v113
    v_pk_mul_f32 v[84:85], v[116:117], v[80:81] op_sel:[0,0] op_sel_hi:[0,1]
    v_pk_mul_f32 v[88:89], v[120:121], v[80:81] op_sel:[0,0] op_sel_hi:[0,1]
    v_pk_mul_f32 v[92:93], v[124:125], v[80:81] op_sel:[0,0] op_sel_hi:[0,1]
    v_pk_fma_f32 v[116:117], v[116:117], v[80:81], v[84:85] op_sel:[1,1,0] op_sel_hi:[1,0,1] neg_lo:[1,0,0]
    v_pk_fma_f32 v[120:121], v[120:121], v[80:81], v[88:89] op_sel:[1,1,0] op_sel_hi:[1,0,1] neg_lo:[1,0,0]
    v_pk_fma_f32 v[124:125], v[124:125], v[80:81], v[92:93] op_sel:[1,1,0] op_sel_hi:[1,0,1] neg_lo:[1,0,0]
    v_cvt_pk_bf16_f32 v152, v116, v117
    ds_write_addtid_b32 v238 offset:4352
    ds_write_addtid_b32 v148 offset:4896
    ds_write_addtid_b32 v150 offset:5440
    ds_write_addtid_b32 v152 offset:5984
    v_cvt_pk_bf16_f32 v154, v120, v121
    v_cvt_pk_bf16_f32 v232, v124, v125
    v_pk_mul_f32 v[84:85], v[128:129], v[80:81] op_sel:[0,0] op_sel_hi:[0,1]
    v_pk_mul_f32 v[88:89], v[132:133], v[80:81] op_sel:[0,0] op_sel_hi:[0,1]
    v_pk_mul_f32 v[92:93], v[136:137], v[80:81] op_sel:[0,0] op_sel_hi:[0,1]
    v_pk_fma_f32 v[128:129], v[128:129], v[80:81], v[84:85] op_sel:[1,1,0] op_sel_hi:[1,0,1] neg_lo:[1,0,0]
    v_pk_fma_f32 v[132:133], v[132:133], v[80:81], v[88:89] op_sel:[1,1,0] op_sel_hi:[1,0,1] neg_lo:[1,0,0]
    v_pk_fma_f32 v[136:137], v[136:137], v[80:81], v[92:93] op_sel:[1,1,0] op_sel_hi:[1,0,1] neg_lo:[1,0,0]
    v_cvt_pk_bf16_f32 v234, v128, v129
    v_cvt_pk_bf16_f32 v236, v132, v133
    ds_write_addtid_b32 v154 offset:6528
    ds_write_addtid_b32 v232 offset:7072
    ds_write_addtid_b32 v234 offset:7616
    ds_write_addtid_b32 v236 offset:8160
    v_lshlrev_b32 v21, 16, v21
    v_cmp_eq_u32 vcc, s67, v1
    v_mov_b32 v29, 0
    v_mov_b32 v30, 0
    v_cndmask_b32 v28, 0, v21, vcc
    v_mov_b32 v31, 0
    ds_read_b128 v[188:191], v59 offset:0
    ds_read_b128 v[192:195], v59 offset:64
    ds_read_b128 v[196:199], v59 offset:128
    ds_read_b128 v[200:203], v59 offset:192
    v_pk_mul_f32 v[84:85], v[104:105], v[80:81] op_sel:[0,0] op_sel_hi:[0,1]
    v_pk_mul_f32 v[88:89], v[112:113], v[80:81] op_sel:[0,0] op_sel_hi:[0,1]
    v_pk_mul_f32 v[92:93], v[120:121], v[80:81] op_sel:[0,0] op_sel_hi:[0,1]
    v_pk_mul_f32 v[96:97], v[128:129], v[80:81] op_sel:[0,0] op_sel_hi:[0,1]
    v_pk_mul_f32 v[100:101], v[136:137], v[80:81] op_sel:[0,0] op_sel_hi:[0,1]
    v_pk_fma_f32 v[104:105], v[104:105], v[80:81], v[84:85] op_sel:[1,1,0] op_sel_hi:[1,0,1] neg_lo:[1,0,0]
    v_pk_fma_f32 v[112:113], v[112:113], v[80:81], v[88:89] op_sel:[1,1,0] op_sel_hi:[1,0,1] neg_lo:[1,0,0]
    v_pk_fma_f32 v[120:121], v[120:121], v[80:81], v[92:93] op_sel:[1,1,0] op_sel_hi:[1,0,1] neg_lo:[1,0,0]
    v_pk_fma_f32 v[128:129], v[128:129], v[80:81], v[96:97] op_sel:[1,1,0] op_sel_hi:[1,0,1] neg_lo:[1,0,0]
    v_pk_fma_f32 v[136:137], v[136:137], v[80:81], v[100:101] op_sel:[1,1,0] op_sel_hi:[1,0,1] neg_lo:[1,0,0]
    s_waitcnt lgkmcnt(0)
    v_mfma_f32_16x16x32_bf16 v[28:31], v[188:191], v[156:159], v[28:31]
    v_cvt_pk_bf16_f32 v238, v104, v105
    v_cvt_pk_bf16_f32 v148, v112, v113
    v_cvt_pk_bf16_f32 v150, v120, v121
    v_mfma_f32_16x16x32_bf16 v[28:31], v[192:195], v[160:163], v[28:31]
    v_cvt_pk_bf16_f32 v152, v128, v129
    ds_write_addtid_b32 v238 offset:0
    v_mfma_f32_16x16x32_bf16 v[28:31], v[196:199], v[164:167], v[28:31]
    ds_write_addtid_b32 v148 offset:544
    ds_write_addtid_b32 v150 offset:1088
    ds_write_addtid_b32 v152 offset:1632
    v_mfma_f32_16x16x32_bf16 v[28:31], v[200:203], v[168:171], v[28:31]
    s_nop 0
    v_cvt_pk_bf16_f32 v154, v136, v137
    ds_write_addtid_b32 v154 offset:2176
    v_pk_mul_f32 v[84:85], v[104:105], v[80:81] op_sel:[0,0] op_sel_hi:[0,1]
    v_pk_mul_f32 v[88:89], v[112:113], v[80:81] op_sel:[0,0] op_sel_hi:[0,1]
    v_pk_mul_f32 v[92:93], v[120:121], v[80:81] op_sel:[0,0] op_sel_hi:[0,1]
    v_pk_mul_f32 v[96:97], v[128:129], v[80:81] op_sel:[0,0] op_sel_hi:[0,1]
    v_pk_mul_f32 v[100:101], v[136:137], v[80:81] op_sel:[0,0] op_sel_hi:[0,1]
    v_pk_fma_f32 v[104:105], v[104:105], v[80:81], v[84:85] op_sel:[1,1,0] op_sel_hi:[1,0,1] neg_lo:[1,0,0]
    v_pk_fma_f32 v[112:113], v[112:113], v[80:81], v[88:89] op_sel:[1,1,0] op_sel_hi:[1,0,1] neg_lo:[1,0,0]
    v_pk_fma_f32 v[120:121], v[120:121], v[80:81], v[92:93] op_sel:[1,1,0] op_sel_hi:[1,0,1] neg_lo:[1,0,0]
    v_pk_fma_f32 v[128:129], v[128:129], v[80:81], v[96:97] op_sel:[1,1,0] op_sel_hi:[1,0,1] neg_lo:[1,0,0]
    v_pk_fma_f32 v[136:137], v[136:137], v[80:81], v[100:101] op_sel:[1,1,0] op_sel_hi:[1,0,1] neg_lo:[1,0,0]
    v_cvt_pk_bf16_f32 v232, v104, v105
    v_cvt_pk_bf16_f32 v234, v112, v113
    v_cvt_pk_bf16_f32 v236, v120, v121
    v_cvt_pk_bf16_f32 v238, v128, v129
    ds_write_addtid_b32 v232 offset:2720
    ds_write_addtid_b32 v234 offset:3264
    ds_write_addtid_b32 v236 offset:3808
    ds_write_addtid_b32 v238 offset:4352
    v_cvt_pk_bf16_f32 v148, v136, v137
    ds_write_addtid_b32 v148 offset:4896
    ds_read_b128 v[188:191], v58 offset:0
    ds_read_b128 v[192:195], v58 offset:64
    ds_read_b128 v[196:199], v58 offset:128
    ds_read_b128 v[200:203], v58 offset:192
    v_pk_mul_f32 v[84:85], v[80:81], v[80:81] op_sel:[0,0] op_sel_hi:[0,1]
    v_pk_mul_f32 v[88:89], v[120:121], v[80:81] op_sel:[0,0] op_sel_hi:[0,1]
    v_pk_mul_f32 v[92:93], v[136:137], v[80:81] op_sel:[0,0] op_sel_hi:[0,1]
    v_pk_fma_f32 v[76:77], v[80:81], v[80:81], v[84:85] op_sel:[1,1,0] op_sel_hi:[1,0,1] neg_lo:[1,0,0]
    v_pk_fma_f32 v[120:121], v[120:121], v[80:81], v[88:89] op_sel:[1,1,0] op_sel_hi:[1,0,1] neg_lo:[1,0,0]
    v_pk_fma_f32 v[136:137], v[136:137], v[80:81], v[92:93] op_sel:[1,1,0] op_sel_hi:[1,0,1] neg_lo:[1,0,0]
    v_pk_mul_f32 v[84:85], v[120:121], v[80:81] op_sel:[0,0] op_sel_hi:[0,1]
    v_pk_mul_f32 v[88:89], v[136:137], v[80:81] op_sel:[0,0] op_sel_hi:[0,1]
    v_pk_fma_f32 v[116:117], v[120:121], v[80:81], v[84:85] op_sel:[1,1,0] op_sel_hi:[1,0,1] neg_lo:[1,0,0]
    v_pk_fma_f32 v[132:133], v[136:137], v[80:81], v[88:89] op_sel:[1,1,0] op_sel_hi:[1,0,1] neg_lo:[1,0,0]
    s_waitcnt lgkmcnt(0)
    v_mfma_f32_16x16x32_bf16 v[32:35], v[188:191], v[156:159], 0
    v_cvt_pk_bf16_f32 v150, v120, v121
    v_cvt_pk_bf16_f32 v152, v136, v137
    v_mfma_f32_16x16x32_bf16 v[32:35], v[192:195], v[160:163], v[32:35]
    v_cvt_pk_bf16_f32 v154, v116, v117
    v_cvt_pk_bf16_f32 v232, v132, v133
    v_mfma_f32_16x16x32_bf16 v[32:35], v[196:199], v[164:167], v[32:35]
    ds_write_addtid_b32 v150 offset:0
    ds_write_addtid_b32 v152 offset:544
    v_mfma_f32_16x16x32_bf16 v[32:35], v[200:203], v[168:171], v[32:35]
    s_nop 0
    ds_write_addtid_b32 v154 offset:1088
    ds_write_addtid_b32 v232 offset:1632
    v_pk_mul_f32 v[84:85], v[120:121], v[76:77] op_sel:[0,0] op_sel_hi:[0,1]
    v_pk_mul_f32 v[88:89], v[136:137], v[76:77] op_sel:[0,0] op_sel_hi:[0,1]
    v_pk_mul_f32 v[92:93], v[116:117], v[76:77] op_sel:[0,0] op_sel_hi:[0,1]
    v_pk_mul_f32 v[96:97], v[132:133], v[76:77] op_sel:[0,0] op_sel_hi:[0,1]
    v_pk_fma_f32 v[120:121], v[120:121], v[76:77], v[84:85] op_sel:[1,1,0] op_sel_hi:[1,0,1] neg_lo:[1,0,0]
    v_pk_fma_f32 v[136:137], v[136:137], v[76:77], v[88:89] op_sel:[1,1,0] op_sel_hi:[1,0,1] neg_lo:[1,0,0]
    v_pk_fma_f32 v[116:117], v[116:117], v[76:77], v[92:93] op_sel:[1,1,0] op_sel_hi:[1,0,1] neg_lo:[1,0,0]
    v_pk_fma_f32 v[132:133], v[132:133], v[76:77], v[96:97] op_sel:[1,1,0] op_sel_hi:[1,0,1] neg_lo:[1,0,0]
    v_cvt_pk_bf16_f32 v234, v120, v121
    v_cvt_pk_bf16_f32 v236, v136, v137
    v_cvt_pk_bf16_f32 v238, v116, v117
    v_cvt_pk_bf16_f32 v148, v132, v133
    ds_write_addtid_b32 v234 offset:2176
    ds_write_addtid_b32 v236 offset:2720
    ds_write_addtid_b32 v238 offset:3264
    ds_write_addtid_b32 v148 offset:3808
    v_pk_mul_f32 v[84:85], v[136:137], v[76:77] op_sel:[0,0] op_sel_hi:[0,1]
    v_pk_mul_f32 v[88:89], v[132:133], v[76:77] op_sel:[0,0] op_sel_hi:[0,1]
    v_pk_fma_f32 v[136:137], v[136:137], v[76:77], v[84:85] op_sel:[1,1,0] op_sel_hi:[1,0,1] neg_lo:[1,0,0]
    v_pk_fma_f32 v[132:133], v[132:133], v[76:77], v[88:89] op_sel:[1,1,0] op_sel_hi:[1,0,1] neg_lo:[1,0,0]
    v_cvt_pk_bf16_f32 v150, v136, v137
    v_cvt_pk_bf16_f32 v152, v132, v133
    v_pk_mul_f32 v[84:85], v[136:137], v[76:77] op_sel:[0,0] op_sel_hi:[0,1]
    v_pk_mul_f32 v[88:89], v[132:133], v[76:77] op_sel:[0,0] op_sel_hi:[0,1]
    v_pk_fma_f32 v[136:137], v[136:137], v[76:77], v[84:85] op_sel:[1,1,0] op_sel_hi:[1,0,1] neg_lo:[1,0,0]
    v_pk_fma_f32 v[132:133], v[132:133], v[76:77], v[88:89] op_sel:[1,1,0] op_sel_hi:[1,0,1] neg_lo:[1,0,0]
    v_cvt_pk_bf16_f32 v154, v136, v137
    v_cvt_pk_bf16_f32 v232, v132, v133
    ds_write_addtid_b32 v150 offset:4352
    ds_write_addtid_b32 v152 offset:4896
    ds_write_addtid_b32 v154 offset:5440
    ds_write_addtid_b32 v232 offset:5984
    v_pk_mul_f32 v[84:85], v[136:137], v[76:77] op_sel:[0,0] op_sel_hi:[0,1]
    v_pk_mul_f32 v[88:89], v[132:133], v[76:77] op_sel:[0,0] op_sel_hi:[0,1]
    v_pk_fma_f32 v[136:137], v[136:137], v[76:77], v[84:85] op_sel:[1,1,0] op_sel_hi:[1,0,1] neg_lo:[1,0,0]
    v_pk_fma_f32 v[132:133], v[132:133], v[76:77], v[88:89] op_sel:[1,1,0] op_sel_hi:[1,0,1] neg_lo:[1,0,0]
    v_cvt_pk_bf16_f32 v234, v136, v137
    v_cvt_pk_bf16_f32 v236, v132, v133
    v_pk_mul_f32 v[84:85], v[136:137], v[76:77] op_sel:[0,0] op_sel_hi:[0,1]
    v_pk_mul_f32 v[88:89], v[132:133], v[76:77] op_sel:[0,0] op_sel_hi:[0,1]
    v_pk_fma_f32 v[136:137], v[136:137], v[76:77], v[84:85] op_sel:[1,1,0] op_sel_hi:[1,0,1] neg_lo:[1,0,0]
    v_pk_fma_f32 v[132:133], v[132:133], v[76:77], v[88:89] op_sel:[1,1,0] op_sel_hi:[1,0,1] neg_lo:[1,0,0]
    v_cvt_pk_bf16_f32 v238, v136, v137
    v_cvt_pk_bf16_f32 v148, v132, v133
    ds_write_addtid_b32 v234 offset:6528
    ds_write_addtid_b32 v236 offset:7072
    ds_write_addtid_b32 v238 offset:7616
    ds_write_addtid_b32 v148 offset:8160
    ds_read_b128 v[188:191], v59 offset:0
    ds_read_b128 v[192:195], v59 offset:64
    ds_read_b128 v[196:199], v59 offset:128
    ds_read_b128 v[200:203], v59 offset:192
    s_waitcnt lgkmcnt(3)
    v_mfma_f32_16x16x32_bf16 v[36:39], v[188:191], v[156:159], 0
    s_waitcnt lgkmcnt(2)
    v_mfma_f32_16x16x32_bf16 v[36:39], v[192:195], v[160:163], v[36:39]
    s_waitcnt lgkmcnt(1)
    v_mfma_f32_16x16x32_bf16 v[36:39], v[196:199], v[164:167], v[36:39]
    s_waitcnt lgkmcnt(0)
    v_mfma_f32_16x16x32_bf16 v[36:39], v[200:203], v[168:171], v[36:39]
    s_cmp_lt_u32 s48, 2
    s_cbranch_scc1 L_tab
    ds_write_b128 v40, v[28:31] offset:0
    ds_write_b128 v40, v[32:35] offset:1024
    s_nop 3
    ds_write_b128 v40, v[36:39] offset:2048
    ds_write_b32 v4, v41 offset:4
.p2align 3
L_tab:
    s_waitcnt vmcnt(7)
    v_lshlrev_b32 v14, 16, v14
    v_mul_f32 v14, 0x3fb8aa3b, v14
    v_lshlrev_b32_e64 v64, 16, v10
    v_and_b32 v66, 0xffff0000, v10
    v_exp_f32_e64 v14, v14
    v_mul_f32 v64, 0x3fb8aa3b, v64
    v_mul_f32 v66, 0x3fb8aa3b, v66
    v_exp_f32 v64, v64
    v_exp_f32 v66, v66
    v_cvt_pk_bf16_f32 v14, v14, v14
    v_lshlrev_b32_e64 v65, 16, v11
    v_and_b32 v67, 0xffff0000, v11
    v_cvt_pk_bf16_f32 v10, v64, v66
    v_and_b32 v14, 0xffff0000, v14
    v_lshlrev_b32_e64 v64, 16, v10
    v_and_b32 v66, 0xffff0000, v10
    s_waitcnt vmcnt(1)
    v_pk_mul_f32 v[64:65], v[14:15], v[64:65] op_sel:[0,0] op_sel_hi:[0,1]
    v_pk_mul_f32 v[66:67], v[14:15], v[66:67] op_sel:[0,0] op_sel_hi:[0,1]
    v_mul_f32 v64, 0xbfb8aa3b, v64
    v_mul_f32 v65, 0x3e22f983, v65
    v_mul_f32 v66, 0xbfb8aa3b, v66
    v_mul_f32_e64 v67, 0x3e22f983, v67
    v_mul_f32 v84, 0x41000000, v64
    v_mul_f32 v85, 0x41000000, v65
    v_mul_f32 v86, 0x41000000, v66
    v_mul_f32 v87, 0x41000000, v67
    v_mul_f32 v88, 1.0, v64
    v_mul_f32 v89, 1.0, v65
    v_mul_f32 v90, 1.0, v66
    v_mul_f32 v91, 1.0, v67
    v_mul_f32 v92, 0x43000000, v64
    v_mul_f32 v93, 0x43000000, v65
    v_mul_f32 v94, 0x43000000, v66
    v_mul_f32 v95, 0x43000000, v67
    v_exp_f32 v84, v84
    v_fract_f32 v85, v85
    v_exp_f32 v86, v86
    v_fract_f32 v87, v87
    v_exp_f32 v88, v88
    v_fract_f32 v89, v89
    v_exp_f32 v90, v90
    v_fract_f32 v91, v91
    v_exp_f32 v92, v92
    v_fract_f32 v93, v93
    v_exp_f32 v94, v94
    v_fract_f32 v95, v95
    v_cos_f32 v68, v85
    v_sin_f32 v69, v85
    v_cos_f32 v70, v87
    v_sin_f32 v71, v87
    v_cos_f32 v76, v89
    v_sin_f32 v77, v89
    v_cos_f32 v78, v91
    v_sin_f32 v79, v91
    v_cos_f32 v80, v93
    v_sin_f32 v81, v93
    v_cos_f32 v82, v95
    v_sin_f32 v83, v95
    v_mul_f32 v68, v68, v84
    v_mul_f32 v69, v69, v84
    v_mul_f32 v70, v70, v86
    v_mul_f32 v71, v71, v86
    v_mul_f32 v76, v76, v88
    v_mul_f32 v77, v77, v88
    v_mul_f32 v78, v78, v90
    v_mul_f32 v79, v79, v90
    v_mul_f32 v80, v80, v92
    v_mul_f32 v81, v81, v92
    v_mul_f32 v82, v82, v94
    v_mul_f32 v83, v83, v94
    v_pk_mul_f32 v[84:85], v[68:69], v[68:69] op_sel:[0,0] op_sel_hi:[0,1]
    v_pk_mul_f32 v[86:87], v[70:71], v[70:71] op_sel:[0,0] op_sel_hi:[0,1]
    v_pk_fma_f32 v[72:73], v[68:69], v[68:69], v[84:85] op_sel:[1,1,0] op_sel_hi:[1,0,1] neg_lo:[1,0,0]
    v_pk_fma_f32 v[74:75], v[70:71], v[70:71], v[86:87] op_sel:[1,1,0] op_sel_hi:[1,0,1] neg_lo:[1,0,0]
    v_mov_b32 v238, 0x3f80
    v_cvt_pk_bf16_f32 v148, v68, -v69
    v_cvt_pk_bf16_f32 v149, v70, -v71
    v_cvt_pk_bf16_f32 v150, v72, -v73
    v_cvt_pk_bf16_f32 v151, v74, -v75
    v_pk_mul_f32 v[84:85], v[68:69], v[72:73] op_sel:[0,0] op_sel_hi:[0,1]
    v_pk_mul_f32 v[86:87], v[70:71], v[74:75] op_sel:[0,0] op_sel_hi:[0,1]
    v_pk_mul_f32 v[88:89], v[72:73], v[72:73] op_sel:[0,0] op_sel_hi:[0,1]
    v_pk_mul_f32 v[90:91], v[74:75], v[74:75] op_sel:[0,0] op_sel_hi:[0,1]
    v_pk_fma_f32 v[140:141], v[68:69], v[72:73], v[84:85] op_sel:[1,1,0] op_sel_hi:[1,0,1] neg_lo:[1,0,0]
    v_pk_fma_f32 v[142:143], v[70:71], v[74:75], v[86:87] op_sel:[1,1,0] op_sel_hi:[1,0,1] neg_lo:[1,0,0]
    v_pk_fma_f32 v[144:145], v[72:73], v[72:73], v[88:89] op_sel:[1,1,0] op_sel_hi:[1,0,1] neg_lo:[1,0,0]
    v_pk_fma_f32 v[146:147], v[74:75], v[74:75], v[90:91] op_sel:[1,1,0] op_sel_hi:[1,0,1] neg_lo:[1,0,0]
    v_cvt_pk_bf16_f32 v152, v140, -v141
    v_cvt_pk_bf16_f32 v153, v142, -v143
    ds_write_addtid_b32 v238 offset:0
    ds_write_addtid_b32 v238 offset:256
    ds_write_addtid_b32 v148 offset:544
    ds_write_addtid_b32 v149 offset:800
    ds_write_addtid_b32 v150 offset:1088
    ds_write_addtid_b32 v151 offset:1344
    ds_write_addtid_b32 v152 offset:1632
    ds_write_addtid_b32 v153 offset:1888
    v_cvt_pk_bf16_f32 v154, v144, -v145
    v_cvt_pk_bf16_f32 v155, v146, -v147
    v_pk_mul_f32 v[84:85], v[140:141], v[72:73] op_sel:[0,0] op_sel_hi:[0,1]
    v_pk_mul_f32 v[86:87], v[142:143], v[74:75] op_sel:[0,0] op_sel_hi:[0,1]
    v_pk_mul_f32 v[88:89], v[144:145], v[72:73] op_sel:[0,0] op_sel_hi:[0,1]
    v_pk_mul_f32 v[90:91], v[146:147], v[74:75] op_sel:[0,0] op_sel_hi:[0,1]
    v_pk_fma_f32 v[140:141], v[140:141], v[72:73], v[84:85] op_sel:[1,1,0] op_sel_hi:[1,0,1] neg_lo:[1,0,0]
    v_pk_fma_f32 v[142:143], v[142:143], v[74:75], v[86:87] op_sel:[1,1,0] op_sel_hi:[1,0,1] neg_lo:[1,0,0]
    v_pk_fma_f32 v[144:145], v[144:145], v[72:73], v[88:89] op_sel:[1,1,0] op_sel_hi:[1,0,1] neg_lo:[1,0,0]
    v_pk_fma_f32 v[146:147], v[146:147], v[74:75], v[90:91] op_sel:[1,1,0] op_sel_hi:[1,0,1] neg_lo:[1,0,0]
    v_cvt_pk_bf16_f32 v232, v140, -v141
    v_cvt_pk_bf16_f32 v233, v142, -v143
    v_cvt_pk_bf16_f32 v234, v144, -v145
    v_cvt_pk_bf16_f32 v235, v146, -v147
    v_pk_mul_f32 v[84:85], v[140:141], v[72:73] op_sel:[0,0] op_sel_hi:[0,1]
    v_pk_mul_f32 v[86:87], v[142:143], v[74:75] op_sel:[0,0] op_sel_hi:[0,1]
    v_pk_mul_f32 v[88:89], v[144:145], v[72:73] op_sel:[0,0] op_sel_hi:[0,1]
    v_pk_mul_f32 v[90:91], v[146:147], v[74:75] op_sel:[0,0] op_sel_hi:[0,1]
    v_pk_fma_f32 v[140:141], v[140:141], v[72:73], v[84:85] op_sel:[1,1,0] op_sel_hi:[1,0,1] neg_lo:[1,0,0]
    v_pk_fma_f32 v[142:143], v[142:143], v[74:75], v[86:87] op_sel:[1,1,0] op_sel_hi:[1,0,1] neg_lo:[1,0,0]
    v_pk_fma_f32 v[144:145], v[144:145], v[72:73], v[88:89] op_sel:[1,1,0] op_sel_hi:[1,0,1] neg_lo:[1,0,0]
    v_pk_fma_f32 v[146:147], v[146:147], v[74:75], v[90:91] op_sel:[1,1,0] op_sel_hi:[1,0,1] neg_lo:[1,0,0]
    v_cvt_pk_bf16_f32 v236, v140, -v141
    v_cvt_pk_bf16_f32 v237, v142, -v143
    ds_write_addtid_b32 v154 offset:2176
    ds_write_addtid_b32 v155 offset:2432
    ds_write_addtid_b32 v232 offset:2720
    ds_write_addtid_b32 v233 offset:2976
    ds_write_addtid_b32 v234 offset:3264
    ds_write_addtid_b32 v235 offset:3520
    ds_write_addtid_b32 v236 offset:3808
    ds_write_addtid_b32 v237 offset:4064
    v_cvt_pk_bf16_f32 v238, v144, -v145
    v_cvt_pk_bf16_f32 v239, v146, -v147
    v_pk_mul_f32 v[84:85], v[140:141], v[72:73] op_sel:[0,0] op_sel_hi:[0,1]
    v_pk_mul_f32 v[86:87], v[142:143], v[74:75] op_sel:[0,0] op_sel_hi:[0,1]
    v_pk_mul_f32 v[88:89], v[144:145], v[72:73] op_sel:[0,0] op_sel_hi:[0,1]
    v_pk_mul_f32 v[90:91], v[146:147], v[74:75] op_sel:[0,0] op_sel_hi:[0,1]
    v_pk_fma_f32 v[140:141], v[140:141], v[72:73], v[84:85] op_sel:[1,1,0] op_sel_hi:[1,0,1] neg_lo:[1,0,0]
    v_pk_fma_f32 v[142:143], v[142:143], v[74:75], v[86:87] op_sel:[1,1,0] op_sel_hi:[1,0,1] neg_lo:[1,0,0]
    v_pk_fma_f32 v[144:145], v[144:145], v[72:73], v[88:89] op_sel:[1,1,0] op_sel_hi:[1,0,1] neg_lo:[1,0,0]
    v_pk_fma_f32 v[146:147], v[146:147], v[74:75], v[90:91] op_sel:[1,1,0] op_sel_hi:[1,0,1] neg_lo:[1,0,0]
    v_cvt_pk_bf16_f32 v148, v140, -v141
    v_cvt_pk_bf16_f32 v149, v142, -v143
    v_cvt_pk_bf16_f32 v150, v144, -v145
    v_cvt_pk_bf16_f32 v151, v146, -v147
    v_pk_mul_f32 v[84:85], v[140:141], v[72:73] op_sel:[0,0] op_sel_hi:[0,1]
    v_pk_mul_f32 v[86:87], v[142:143], v[74:75] op_sel:[0,0] op_sel_hi:[0,1]
    v_pk_mul_f32 v[88:89], v[144:145], v[72:73] op_sel:[0,0] op_sel_hi:[0,1]
    v_pk_mul_f32 v[90:91], v[146:147], v[74:75] op_sel:[0,0] op_sel_hi:[0,1]
    v_pk_fma_f32 v[140:141], v[140:141], v[72:73], v[84:85] op_sel:[1,1,0] op_sel_hi:[1,0,1] neg_lo:[1,0,0]
    v_pk_fma_f32 v[142:143], v[142:143], v[74:75], v[86:87] op_sel:[1,1,0] op_sel_hi:[1,0,1] neg_lo:[1,0,0]
    v_pk_fma_f32 v[144:145], v[144:145], v[72:73], v[88:89] op_sel:[1,1,0] op_sel_hi:[1,0,1] neg_lo:[1,0,0]
    v_pk_fma_f32 v[146:147], v[146:147], v[74:75], v[90:91] op_sel:[1,1,0] op_sel_hi:[1,0,1] neg_lo:[1,0,0]
    v_cvt_pk_bf16_f32 v152, v140, -v141
    v_cvt_pk_bf16_f32 v153, v142, -v143
    ds_write_addtid_b32 v238 offset:4352
    ds_write_addtid_b32 v239 offset:4608
    ds_write_addtid_b32 v148 offset:4896
    ds_write_addtid_b32 v149 offset:5152
    ds_write_addtid_b32 v150 offset:5440
    ds_write_addtid_b32 v151 offset:5696
    ds_write_addtid_b32 v152 offset:5984
    ds_write_addtid_b32 v153 offset:6240
    v_cvt_pk_bf16_f32 v154, v144, -v145
    v_cvt_pk_bf16_f32 v155, v146, -v147
    v_pk_mul_f32 v[84:85], v[140:141], v[72:73] op_sel:[0,0] op_sel_hi:[0,1]
    v_pk_mul_f32 v[86:87], v[142:143], v[74:75] op_sel:[0,0] op_sel_hi:[0,1]
    v_pk_mul_f32 v[88:89], v[144:145], v[72:73] op_sel:[0,0] op_sel_hi:[0,1]
    v_pk_mul_f32 v[90:91], v[146:147], v[74:75] op_sel:[0,0] op_sel_hi:[0,1]
    v_pk_fma_f32 v[140:141], v[140:141], v[72:73], v[84:85] op_sel:[1,1,0] op_sel_hi:[1,0,1] neg_lo:[1,0,0]
    v_pk_fma_f32 v[142:143], v[142:143], v[74:75], v[86:87] op_sel:[1,1,0] op_sel_hi:[1,0,1] neg_lo:[1,0,0]
    v_pk_fma_f32 v[144:145], v[144:145], v[72:73], v[88:89] op_sel:[1,1,0] op_sel_hi:[1,0,1] neg_lo:[1,0,0]
    v_pk_fma_f32 v[146:147], v[146:147], v[74:75], v[90:91] op_sel:[1,1,0] op_sel_hi:[1,0,1] neg_lo:[1,0,0]
    v_cvt_pk_bf16_f32 v232, v140, -v141
    v_cvt_pk_bf16_f32 v233, v142, -v143
    v_cvt_pk_bf16_f32 v234, v144, -v145
    v_cvt_pk_bf16_f32 v235, v146, -v147
    v_pk_mul_f32 v[84:85], v[140:141], v[72:73] op_sel:[0,0] op_sel_hi:[0,1]
    v_pk_mul_f32 v[86:87], v[142:143], v[74:75] op_sel:[0,0] op_sel_hi:[0,1]
    v_pk_fma_f32 v[140:141], v[140:141], v[72:73], v[84:85] op_sel:[1,1,0] op_sel_hi:[1,0,1] neg_lo:[1,0,0]
    v_pk_fma_f32 v[142:143], v[142:143], v[74:75], v[86:87] op_sel:[1,1,0] op_sel_hi:[1,0,1] neg_lo:[1,0,0]
    v_cvt_pk_bf16_f32 v236, v140, -v141
    v_cvt_pk_bf16_f32 v237, v142, -v143
    ds_write_addtid_b32 v154 offset:6528
    ds_write_addtid_b32 v155 offset:6784
    ds_write_addtid_b32 v232 offset:7072
    ds_write_addtid_b32 v233 offset:7328
    ds_write_addtid_b32 v234 offset:7616
    ds_write_addtid_b32 v235 offset:7872
    ds_write_addtid_b32 v236 offset:8160
    ds_write_addtid_b32 v237 offset:8416
    ds_read_b128 v[156:159], v59 offset:0
    ds_read_b128 v[160:163], v59 offset:64
    ds_read_b128 v[164:167], v59 offset:128
    ds_read_b128 v[168:171], v59 offset:192
    ds_read_b128 v[172:175], v59 offset:256
    ds_read_b128 v[176:179], v59 offset:320
    ds_read_b128 v[180:183], v59 offset:384
    ds_read_b128 v[184:187], v59 offset:448
    v_add_f32 v14, v14, v14
    v_lshlrev_b32 v104, 16, v12
    v_lshlrev_b32_e64 v105, 16, v13
    v_and_b32 v106, 0xffff0000, v12
    v_and_b32 v107, 0xffff0000, v13
    v_pk_mul_f32 v[104:105], v[14:15], v[104:105] op_sel:[0,0] op_sel_hi:[0,1]
    v_pk_mul_f32 v[106:107], v[14:15], v[106:107] op_sel:[0,0] op_sel_hi:[0,1]
    v_pk_mul_f32 v[84:85], v[76:77], v[76:77] op_sel:[0,0] op_sel_hi:[0,1]
    v_pk_mul_f32 v[86:87], v[78:79], v[78:79] op_sel:[0,0] op_sel_hi:[0,1]
    v_pk_mul_f32 v[88:89], v[104:105], v[76:77] op_sel:[0,0] op_sel_hi:[0,1]
    v_pk_mul_f32 v[90:91], v[106:107], v[78:79] op_sel:[0,0] op_sel_hi:[0,1]
    v_pk_mul_f32 v[92:93], v[104:105], v[68:69] op_sel:[0,0] op_sel_hi:[0,1]
    v_pk_mul_f32 v[94:95], v[106:107], v[70:71] op_sel:[0,0] op_sel_hi:[0,1]
    v_pk_fma_f32 v[140:141], v[76:77], v[76:77], v[84:85] op_sel:[1,1,0] op_sel_hi:[1,0,1] neg_lo:[1,0,0]
    v_pk_fma_f32 v[142:143], v[78:79], v[78:79], v[86:87] op_sel:[1,1,0] op_sel_hi:[1,0,1] neg_lo:[1,0,0]
    v_pk_fma_f32 v[108:109], v[104:105], v[76:77], v[88:89] op_sel:[1,1,0] op_sel_hi:[1,0,1] neg_lo:[1,0,0]
    v_pk_fma_f32 v[110:111], v[106:107], v[78:79], v[90:91] op_sel:[1,1,0] op_sel_hi:[1,0,1] neg_lo:[1,0,0]
    v_pk_fma_f32 v[136:137], v[104:105], v[68:69], v[92:93] op_sel:[1,1,0] op_sel_hi:[1,0,1] neg_lo:[1,0,0]
    v_pk_fma_f32 v[138:139], v[106:107], v[70:71], v[94:95] op_sel:[1,1,0] op_sel_hi:[1,0,1] neg_lo:[1,0,0]
    v_cvt_pk_bf16_f32 v238, v104, v105
    v_cvt_pk_bf16_f32 v239, v106, v107
    v_cvt_pk_bf16_f32 v148, v108, v109
    v_cvt_pk_bf16_f32 v149, v110, v111
    v_pk_mul_f32 v[84:85], v[104:105], v[140:141] op_sel:[0,0] op_sel_hi:[0,1]
    v_pk_mul_f32 v[86:87], v[106:107], v[142:143] op_sel:[0,0] op_sel_hi:[0,1]
    v_pk_mul_f32 v[88:89], v[108:109], v[140:141] op_sel:[0,0] op_sel_hi:[0,1]
    v_pk_mul_f32 v[90:91], v[110:111], v[142:143] op_sel:[0,0] op_sel_hi:[0,1]
    v_pk_fma_f32 v[112:113], v[104:105], v[140:141], v[84:85] op_sel:[1,1,0] op_sel_hi:[1,0,1] neg_lo:[1,0,0]
    v_pk_fma_f32 v[114:115], v[106:107], v[142:143], v[86:87] op_sel:[1,1,0] op_sel_hi:[1,0,1] neg_lo:[1,0,0]
    v_pk_fma_f32 v[116:117], v[108:109], v[140:141], v[88:89] op_sel:[1,1,0] op_sel_hi:[1,0,1] neg_lo:[1,0,0]
    v_pk_fma_f32 v[118:119], v[110:111], v[142:143], v[90:91] op_sel:[1,1,0] op_sel_hi:[1,0,1] neg_lo:[1,0,0]
    v_cvt_pk_bf16_f32 v150, v112, v113
    v_cvt_pk_bf16_f32 v151, v114, v115
    v_cvt_pk_bf16_f32 v152, v116, v117
    v_cvt_pk_bf16_f32 v153, v118, v119
    ds_write_addtid_b32 v238 offset:0
    ds_write_addtid_b32 v239 offset:256
    ds_write_addtid_b32 v148 offset:544
    ds_write_addtid_b32 v149 offset:800
    ds_write_addtid_b32 v150 offset:1088
    ds_write_addtid_b32 v151 offset:1344
    ds_write_addtid_b32 v152 offset:1632
    ds_write_addtid_b32 v153 offset:1888
    v_pk_mul_f32 v[84:85], v[112:113], v[140:141] op_sel:[0,0] op_sel_hi:[0,1]
    v_pk_mul_f32 v[86:87], v[114:115], v[142:143] op_sel:[0,0] op_sel_hi:[0,1]
    v_pk_mul_f32 v[88:89], v[116:117], v[140:141] op_sel:[0,0] op_sel_hi:[0,1]
    v_pk_mul_f32 v[90:91], v[118:119], v[142:143] op_sel:[0,0] op_sel_hi:[0,1]
    v_pk_fma_f32 v[120:121], v[112:113], v[140:141], v[84:85] op_sel:[1,1,0] op_sel_hi:[1,0,1] neg_lo:[1,0,0]
    v_pk_fma_f32 v[122:123], v[114:115], v[142:143], v[86:87] op_sel:[1,1,0] op_sel_hi:[1,0,1] neg_lo:[1,0,0]
    v_pk_fma_f32 v[124:125], v[116:117], v[140:141], v[88:89] op_sel:[1,1,0] op_sel_hi:[1,0,1] neg_lo:[1,0,0]
    v_pk_fma_f32 v[126:127], v[118:119], v[142:143], v[90:91] op_sel:[1,1,0] op_sel_hi:[1,0,1] neg_lo:[1,0,0]
    v_cvt_pk_bf16_f32 v154, v120, v121
    v_cvt_pk_bf16_f32 v155, v122, v123
    v_cvt_pk_bf16_f32 v232, v124, v125
    v_cvt_pk_bf16_f32 v233, v126, v127
    v_pk_mul_f32 v[84:85], v[120:121], v[140:141] op_sel:[0,0] op_sel_hi:[0,1]
    v_pk_mul_f32 v[86:87], v[122:123], v[142:143] op_sel:[0,0] op_sel_hi:[0,1]
    v_pk_mul_f32 v[88:89], v[124:125], v[140:141] op_sel:[0,0] op_sel_hi:[0,1]
    v_pk_mul_f32 v[90:91], v[126:127], v[142:143] op_sel:[0,0] op_sel_hi:[0,1]
    v_pk_fma_f32 v[128:129], v[120:121], v[140:141], v[84:85] op_sel:[1,1,0] op_sel_hi:[1,0,1] neg_lo:[1,0,0]
    v_pk_fma_f32 v[130:131], v[122:123], v[142:143], v[86:87] op_sel:[1,1,0] op_sel_hi:[1,0,1] neg_lo:[1,0,0]
    v_pk_fma_f32 v[132:133], v[124:125], v[140:141], v[88:89] op_sel:[1,1,0] op_sel_hi:[1,0,1] neg_lo:[1,0,0]
    v_pk_fma_f32 v[134:135], v[126:127], v[142:143], v[90:91] op_sel:[1,1,0] op_sel_hi:[1,0,1] neg_lo:[1,0,0]
    v_cvt_pk_bf16_f32 v234, v128, v129
    v_cvt_pk_bf16_f32 v235, v130, v131
    v_cvt_pk_bf16_f32 v236, v132, v133
    v_cvt_pk_bf16_f32 v237, v134, v135
    ds_write_addtid_b32 v154 offset:2176
    ds_write_addtid_b32 v155 offset:2432
    ds_write_addtid_b32 v232 offset:2720
    ds_write_addtid_b32 v233 offset:2976
    ds_write_addtid_b32 v234 offset:3264
    ds_write_addtid_b32 v235 offset:3520
    ds_write_addtid_b32 v236 offset:3808
    ds_write_addtid_b32 v237 offset:4064
    v_pk_mul_f32 v[84:85], v[104:105], v[80:81] op_sel:[0,0] op_sel_hi:[0,1]
    v_pk_mul_f32 v[86:87], v[106:107], v[82:83] op_sel:[0,0] op_sel_hi:[0,1]
    v_pk_mul_f32 v[88:89], v[108:109], v[80:81] op_sel:[0,0] op_sel_hi:[0,1]
    v_pk_mul_f32 v[90:91], v[110:111], v[82:83] op_sel:[0,0] op_sel_hi:[0,1]
    v_pk_mul_f32 v[92:93], v[112:113], v[80:81] op_sel:[0,0] op_sel_hi:[0,1]
    v_pk_mul_f32 v[94:95], v[114:115], v[82:83] op_sel:[0,0] op_sel_hi:[0,1]
    v_pk_fma_f32 v[104:105], v[104:105], v[80:81], v[84:85] op_sel:[1,1,0] op_sel_hi:[1,0,1] neg_lo:[1,0,0]
    v_pk_fma_f32 v[106:107], v[106:107], v[82:83], v[86:87] op_sel:[1,1,0] op_sel_hi:[1,0,1] neg_lo:[1,0,0]
    v_pk_fma_f32 v[108:109], v[108:109], v[80:81], v[88:89] op_sel:[1,1,0] op_sel_hi:[1,0,1] neg_lo:[1,0,0]
    v_pk_fma_f32 v[110:111], v[110:111], v[82:83], v[90:91] op_sel:[1,1,0] op_sel_hi:[1,0,1] neg_lo:[1,0,0]
    v_pk_fma_f32 v[112:113], v[112:113], v[80:81], v[92:93] op_sel:[1,1,0] op_sel_hi:[1,0,1] neg_lo:[1,0,0]
    v_pk_fma_f32 v[114:115], v[114:115], v[82:83], v[94:95] op_sel:[1,1,0] op_sel_hi:[1,0,1] neg_lo:[1,0,0]
    v_cvt_pk_bf16_f32 v238, v104, v105
    v_cvt_pk_bf16_f32 v239, v106, v107
    v_cvt_pk_bf16_f32 v148, v108, v109
    v_cvt_pk_bf16_f32 v149, v110, v111
    v_cvt_pk_bf16_f32 v150, v112, v113
    v_cvt_pk_bf16_f32 v151, v114, v115
    v_pk_mul_f32 v[84:85], v[116:117], v[80:81] op_sel:[0,0] op_sel_hi:[0,1]
    v_pk_mul_f32 v[86:87], v[118:119], v[82:83] op_sel:[0,0] op_sel_hi:[0,1]
    v_pk_mul_f32 v[88:89], v[120:121], v[80:81] op_sel:[0,0] op_sel_hi:[0,1]
    v_pk_mul_f32 v[90:91], v[122:123], v[82:83] op_sel:[0,0] op_sel_hi:[0,1]
    v_pk_mul_f32 v[92:93], v[124:125], v[80:81] op_sel:[0,0] op_sel_hi:[0,1]
    v_pk_mul_f32 v[94:95], v[126:127], v[82:83] op_sel:[0,0] op_sel_hi:[0,1]
    v_pk_fma_f32 v[116:117], v[116:117], v[80:81], v[84:85] op_sel:[1,1,0] op_sel_hi:[1,0,1] neg_lo:[1,0,0]
    v_pk_fma_f32 v[118:119], v[118:119], v[82:83], v[86:87] op_sel:[1,1,0] op_sel_hi:[1,0,1] neg_lo:[1,0,0]
    v_pk_fma_f32 v[120:121], v[120:121], v[80:81], v[88:89] op_sel:[1,1,0] op_sel_hi:[1,0,1] neg_lo:[1,0,0]
    v_pk_fma_f32 v[122:123], v[122:123], v[82:83], v[90:91] op_sel:[1,1,0] op_sel_hi:[1,0,1] neg_lo:[1,0,0]
    v_pk_fma_f32 v[124:125], v[124:125], v[80:81], v[92:93] op_sel:[1,1,0] op_sel_hi:[1,0,1] neg_lo:[1,0,0]
    v_pk_fma_f32 v[126:127], v[126:127], v[82:83], v[94:95] op_sel:[1,1,0] op_sel_hi:[1,0,1] neg_lo:[1,0,0]
    v_cvt_pk_bf16_f32 v152, v116, v117
    v_cvt_pk_bf16_f32 v153, v118, v119
    ds_write_addtid_b32 v238 offset:4352
    ds_write_addtid_b32 v239 offset:4608
    ds_write_addtid_b32 v148 offset:4896
    ds_write_addtid_b32 v149 offset:5152
    ds_write_addtid_b32 v150 offset:5440
    ds_write_addtid_b32 v151 offset:5696
    ds_write_addtid_b32 v152 offset:5984
    ds_write_addtid_b32 v153 offset:6240
    v_cvt_pk_bf16_f32 v154, v120, v121
    v_cvt_pk_bf16_f32 v155, v122, v123
    v_cvt_pk_bf16_f32 v232, v124, v125
    v_cvt_pk_bf16_f32 v233, v126, v127
    v_pk_mul_f32 v[84:85], v[128:129], v[80:81] op_sel:[0,0] op_sel_hi:[0,1]
    v_pk_mul_f32 v[86:87], v[130:131], v[82:83] op_sel:[0,0] op_sel_hi:[0,1]
    v_pk_mul_f32 v[88:89], v[132:133], v[80:81] op_sel:[0,0] op_sel_hi:[0,1]
    v_pk_mul_f32 v[90:91], v[134:135], v[82:83] op_sel:[0,0] op_sel_hi:[0,1]
    v_pk_mul_f32 v[92:93], v[136:137], v[80:81] op_sel:[0,0] op_sel_hi:[0,1]
    v_pk_mul_f32 v[94:95], v[138:139], v[82:83] op_sel:[0,0] op_sel_hi:[0,1]
    v_pk_fma_f32 v[128:129], v[128:129], v[80:81], v[84:85] op_sel:[1,1,0] op_sel_hi:[1,0,1] neg_lo:[1,0,0]
    v_pk_fma_f32 v[130:131], v[130:131], v[82:83], v[86:87] op_sel:[1,1,0] op_sel_hi:[1,0,1] neg_lo:[1,0,0]
    v_pk_fma_f32 v[132:133], v[132:133], v[80:81], v[88:89] op_sel:[1,1,0] op_sel_hi:[1,0,1] neg_lo:[1,0,0]
    v_pk_fma_f32 v[134:135], v[134:135], v[82:83], v[90:91] op_sel:[1,1,0] op_sel_hi:[1,0,1] neg_lo:[1,0,0]
    v_pk_fma_f32 v[136:137], v[136:137], v[80:81], v[92:93] op_sel:[1,1,0] op_sel_hi:[1,0,1] neg_lo:[1,0,0]
    v_pk_fma_f32 v[138:139], v[138:139], v[82:83], v[94:95] op_sel:[1,1,0] op_sel_hi:[1,0,1] neg_lo:[1,0,0]
    v_cvt_pk_bf16_f32 v234, v128, v129
    v_cvt_pk_bf16_f32 v235, v130, v131
    v_cvt_pk_bf16_f32 v236, v132, v133
    v_cvt_pk_bf16_f32 v237, v134, v135
    ds_write_addtid_b32 v154 offset:6528
    ds_write_addtid_b32 v155 offset:6784
    ds_write_addtid_b32 v232 offset:7072
    ds_write_addtid_b32 v233 offset:7328
    ds_write_addtid_b32 v234 offset:7616
    ds_write_addtid_b32 v235 offset:7872
    ds_write_addtid_b32 v236 offset:8160
    ds_write_addtid_b32 v237 offset:8416
    v_lshlrev_b32 v15, 16, v15
    v_cmp_eq_u32 vcc, 0, v1
    v_mov_b32 v221, 0
    v_mov_b32 v222, 0
    v_cndmask_b32 v220, 0, v15, vcc
    v_mov_b32 v223, 0
    ds_read_b128 v[188:191], v59 offset:0
    ds_read_b128 v[192:195], v59 offset:64
    ds_read_b128 v[196:199], v59 offset:128
    ds_read_b128 v[200:203], v59 offset:192
    ds_read_b128 v[204:207], v59 offset:256
    ds_read_b128 v[208:211], v59 offset:320
    ds_read_b128 v[212:215], v59 offset:384
    ds_read_b128 v[216:219], v59 offset:448
    v_pk_mul_f32 v[84:85], v[104:105], v[80:81] op_sel:[0,0] op_sel_hi:[0,1]
    v_pk_mul_f32 v[86:87], v[106:107], v[82:83] op_sel:[0,0] op_sel_hi:[0,1]
    v_pk_mul_f32 v[88:89], v[112:113], v[80:81] op_sel:[0,0] op_sel_hi:[0,1]
    v_pk_mul_f32 v[90:91], v[114:115], v[82:83] op_sel:[0,0] op_sel_hi:[0,1]
    v_pk_mul_f32 v[92:93], v[120:121], v[80:81] op_sel:[0,0] op_sel_hi:[0,1]
    v_pk_mul_f32 v[94:95], v[122:123], v[82:83] op_sel:[0,0] op_sel_hi:[0,1]
    v_pk_mul_f32 v[96:97], v[128:129], v[80:81] op_sel:[0,0] op_sel_hi:[0,1]
    v_pk_mul_f32 v[98:99], v[130:131], v[82:83] op_sel:[0,0] op_sel_hi:[0,1]
    v_pk_mul_f32 v[100:101], v[136:137], v[80:81] op_sel:[0,0] op_sel_hi:[0,1]
    v_pk_mul_f32 v[102:103], v[138:139], v[82:83] op_sel:[0,0] op_sel_hi:[0,1]
    v_pk_fma_f32 v[104:105], v[104:105], v[80:81], v[84:85] op_sel:[1,1,0] op_sel_hi:[1,0,1] neg_lo:[1,0,0]
    v_pk_fma_f32 v[106:107], v[106:107], v[82:83], v[86:87] op_sel:[1,1,0] op_sel_hi:[1,0,1] neg_lo:[1,0,0]
    v_pk_fma_f32 v[112:113], v[112:113], v[80:81], v[88:89] op_sel:[1,1,0] op_sel_hi:[1,0,1] neg_lo:[1,0,0]
    v_pk_fma_f32 v[114:115], v[114:115], v[82:83], v[90:91] op_sel:[1,1,0] op_sel_hi:[1,0,1] neg_lo:[1,0,0]
    v_pk_fma_f32 v[120:121], v[120:121], v[80:81], v[92:93] op_sel:[1,1,0] op_sel_hi:[1,0,1] neg_lo:[1,0,0]
    v_pk_fma_f32 v[122:123], v[122:123], v[82:83], v[94:95] op_sel:[1,1,0] op_sel_hi:[1,0,1] neg_lo:[1,0,0]
    v_pk_fma_f32 v[128:129], v[128:129], v[80:81], v[96:97] op_sel:[1,1,0] op_sel_hi:[1,0,1] neg_lo:[1,0,0]
    v_pk_fma_f32 v[130:131], v[130:131], v[82:83], v[98:99] op_sel:[1,1,0] op_sel_hi:[1,0,1] neg_lo:[1,0,0]
    v_pk_fma_f32 v[136:137], v[136:137], v[80:81], v[100:101] op_sel:[1,1,0] op_sel_hi:[1,0,1] neg_lo:[1,0,0]
    v_pk_fma_f32 v[138:139], v[138:139], v[82:83], v[102:103] op_sel:[1,1,0] op_sel_hi:[1,0,1] neg_lo:[1,0,0]
    s_waitcnt lgkmcnt(0)
    v_mfma_f32_16x16x32_bf16 v[220:223], v[188:191], v[156:159], v[220:223]
    v_cvt_pk_bf16_f32 v238, v104, v105
    v_cvt_pk_bf16_f32 v239, v106, v107
    v_cvt_pk_bf16_f32 v148, v112, v113
    v_mfma_f32_16x16x32_bf16 v[220:223], v[192:195], v[160:163], v[220:223]
    v_cvt_pk_bf16_f32 v149, v114, v115
    v_cvt_pk_bf16_f32 v150, v120, v121
    v_mfma_f32_16x16x32_bf16 v[220:223], v[196:199], v[164:167], v[220:223]
    v_cvt_pk_bf16_f32 v151, v122, v123
    v_cvt_pk_bf16_f32 v152, v128, v129
    v_cvt_pk_bf16_f32 v153, v130, v131
    v_mfma_f32_16x16x32_bf16 v[220:223], v[200:203], v[168:171], v[220:223]
    ds_write_addtid_b32 v238 offset:0
    ds_write_addtid_b32 v239 offset:256
    v_mfma_f32_16x16x32_bf16 v[220:223], v[204:207], v[172:175], v[220:223]
    ds_write_addtid_b32 v148 offset:544
    ds_write_addtid_b32 v149 offset:800
    ds_write_addtid_b32 v150 offset:1088
    v_mfma_f32_16x16x32_bf16 v[220:223], v[208:211], v[176:179], v[220:223]
    ds_write_addtid_b32 v151 offset:1344
    ds_write_addtid_b32 v152 offset:1632
    v_mfma_f32_16x16x32_bf16 v[220:223], v[212:215], v[180:183], v[220:223]
    ds_write_addtid_b32 v153 offset:1888
    v_cvt_pk_bf16_f32 v154, v136, v137
    v_cvt_pk_bf16_f32 v155, v138, v139
    v_mfma_f32_16x16x32_bf16 v[220:223], v[216:219], v[184:187], v[220:223]
    s_nop 0
    ds_write_addtid_b32 v154 offset:2176
    ds_write_addtid_b32 v155 offset:2432
    v_pk_mul_f32 v[84:85], v[104:105], v[80:81] op_sel:[0,0] op_sel_hi:[0,1]
    v_pk_mul_f32 v[86:87], v[106:107], v[82:83] op_sel:[0,0] op_sel_hi:[0,1]
    v_pk_mul_f32 v[88:89], v[112:113], v[80:81] op_sel:[0,0] op_sel_hi:[0,1]
    v_pk_mul_f32 v[90:91], v[114:115], v[82:83] op_sel:[0,0] op_sel_hi:[0,1]
    v_pk_mul_f32 v[92:93], v[120:121], v[80:81] op_sel:[0,0] op_sel_hi:[0,1]
    v_pk_mul_f32 v[94:95], v[122:123], v[82:83] op_sel:[0,0] op_sel_hi:[0,1]
    v_pk_mul_f32 v[96:97], v[128:129], v[80:81] op_sel:[0,0] op_sel_hi:[0,1]
    v_pk_mul_f32 v[98:99], v[130:131], v[82:83] op_sel:[0,0] op_sel_hi:[0,1]
    v_pk_mul_f32 v[100:101], v[136:137], v[80:81] op_sel:[0,0] op_sel_hi:[0,1]
    v_pk_mul_f32 v[102:103], v[138:139], v[82:83] op_sel:[0,0] op_sel_hi:[0,1]
    v_pk_fma_f32 v[104:105], v[104:105], v[80:81], v[84:85] op_sel:[1,1,0] op_sel_hi:[1,0,1] neg_lo:[1,0,0]
    v_pk_fma_f32 v[106:107], v[106:107], v[82:83], v[86:87] op_sel:[1,1,0] op_sel_hi:[1,0,1] neg_lo:[1,0,0]
    v_pk_fma_f32 v[112:113], v[112:113], v[80:81], v[88:89] op_sel:[1,1,0] op_sel_hi:[1,0,1] neg_lo:[1,0,0]
    v_pk_fma_f32 v[114:115], v[114:115], v[82:83], v[90:91] op_sel:[1,1,0] op_sel_hi:[1,0,1] neg_lo:[1,0,0]
    v_pk_fma_f32 v[120:121], v[120:121], v[80:81], v[92:93] op_sel:[1,1,0] op_sel_hi:[1,0,1] neg_lo:[1,0,0]
    v_pk_fma_f32 v[122:123], v[122:123], v[82:83], v[94:95] op_sel:[1,1,0] op_sel_hi:[1,0,1] neg_lo:[1,0,0]
    v_pk_fma_f32 v[128:129], v[128:129], v[80:81], v[96:97] op_sel:[1,1,0] op_sel_hi:[1,0,1] neg_lo:[1,0,0]
    v_pk_fma_f32 v[130:131], v[130:131], v[82:83], v[98:99] op_sel:[1,1,0] op_sel_hi:[1,0,1] neg_lo:[1,0,0]
    v_pk_fma_f32 v[136:137], v[136:137], v[80:81], v[100:101] op_sel:[1,1,0] op_sel_hi:[1,0,1] neg_lo:[1,0,0]
    v_pk_fma_f32 v[138:139], v[138:139], v[82:83], v[102:103] op_sel:[1,1,0] op_sel_hi:[1,0,1] neg_lo:[1,0,0]
    v_cvt_pk_bf16_f32 v232, v104, v105
    v_cvt_pk_bf16_f32 v233, v106, v107
    v_cvt_pk_bf16_f32 v234, v112, v113
    v_cvt_pk_bf16_f32 v235, v114, v115
    v_cvt_pk_bf16_f32 v236, v120, v121
    v_cvt_pk_bf16_f32 v237, v122, v123
    v_cvt_pk_bf16_f32 v238, v128, v129
    v_cvt_pk_bf16_f32 v239, v130, v131
    ds_write_addtid_b32 v232 offset:2720
    ds_write_addtid_b32 v233 offset:2976
    ds_write_addtid_b32 v234 offset:3264
    ds_write_addtid_b32 v235 offset:3520
    ds_write_addtid_b32 v236 offset:3808
    ds_write_addtid_b32 v237 offset:4064
    ds_write_addtid_b32 v238 offset:4352
    ds_write_addtid_b32 v239 offset:4608
    v_cvt_pk_bf16_f32 v148, v136, v137
    v_cvt_pk_bf16_f32 v149, v138, v139
    ds_write_addtid_b32 v148 offset:4896
    ds_write_addtid_b32 v149 offset:5152
    ds_read_b128 v[188:191], v58 offset:0
    ds_read_b128 v[192:195], v58 offset:64
    ds_read_b128 v[196:199], v58 offset:128
    ds_read_b128 v[200:203], v58 offset:192
    ds_read_b128 v[204:207], v58 offset:256
    ds_read_b128 v[208:211], v58 offset:320
    ds_read_b128 v[212:215], v58 offset:384
    ds_read_b128 v[216:219], v58 offset:448
    v_pk_mul_f32 v[84:85], v[80:81], v[80:81] op_sel:[0,0] op_sel_hi:[0,1]
    v_pk_mul_f32 v[86:87], v[82:83], v[82:83] op_sel:[0,0] op_sel_hi:[0,1]
    v_pk_mul_f32 v[88:89], v[120:121], v[80:81] op_sel:[0,0] op_sel_hi:[0,1]
    v_pk_mul_f32 v[90:91], v[122:123], v[82:83] op_sel:[0,0] op_sel_hi:[0,1]
    v_pk_mul_f32 v[92:93], v[136:137], v[80:81] op_sel:[0,0] op_sel_hi:[0,1]
    v_pk_mul_f32 v[94:95], v[138:139], v[82:83] op_sel:[0,0] op_sel_hi:[0,1]
    v_pk_fma_f32 v[76:77], v[80:81], v[80:81], v[84:85] op_sel:[1,1,0] op_sel_hi:[1,0,1] neg_lo:[1,0,0]
    v_pk_fma_f32 v[78:79], v[82:83], v[82:83], v[86:87] op_sel:[1,1,0] op_sel_hi:[1,0,1] neg_lo:[1,0,0]
    v_pk_fma_f32 v[120:121], v[120:121], v[80:81], v[88:89] op_sel:[1,1,0] op_sel_hi:[1,0,1] neg_lo:[1,0,0]
    v_pk_fma_f32 v[122:123], v[122:123], v[82:83], v[90:91] op_sel:[1,1,0] op_sel_hi:[1,0,1] neg_lo:[1,0,0]
    v_pk_fma_f32 v[136:137], v[136:137], v[80:81], v[92:93] op_sel:[1,1,0] op_sel_hi:[1,0,1] neg_lo:[1,0,0]
    v_pk_fma_f32 v[138:139], v[138:139], v[82:83], v[94:95] op_sel:[1,1,0] op_sel_hi:[1,0,1] neg_lo:[1,0,0]
    v_pk_mul_f32 v[84:85], v[120:121], v[80:81] op_sel:[0,0] op_sel_hi:[0,1]
    v_pk_mul_f32 v[86:87], v[122:123], v[82:83] op_sel:[0,0] op_sel_hi:[0,1]
    v_pk_mul_f32 v[88:89], v[136:137], v[80:81] op_sel:[0,0] op_sel_hi:[0,1]
    v_pk_mul_f32 v[90:91], v[138:139], v[82:83] op_sel:[0,0] op_sel_hi:[0,1]
    v_pk_fma_f32 v[116:117], v[120:121], v[80:81], v[84:85] op_sel:[1,1,0] op_sel_hi:[1,0,1] neg_lo:[1,0,0]
    v_pk_fma_f32 v[118:119], v[122:123], v[82:83], v[86:87] op_sel:[1,1,0] op_sel_hi:[1,0,1] neg_lo:[1,0,0]
    v_pk_fma_f32 v[132:133], v[136:137], v[80:81], v[88:89] op_sel:[1,1,0] op_sel_hi:[1,0,1] neg_lo:[1,0,0]
    v_pk_fma_f32 v[134:135], v[138:139], v[82:83], v[90:91] op_sel:[1,1,0] op_sel_hi:[1,0,1] neg_lo:[1,0,0]
    s_waitcnt lgkmcnt(0)
    v_mfma_f32_16x16x32_bf16 v[224:227], v[188:191], v[156:159], 0
    v_cvt_pk_bf16_f32 v150, v120, v121
    v_cvt_pk_bf16_f32 v151, v122, v123
    v_mfma_f32_16x16x32_bf16 v[224:227], v[192:195], v[160:163], v[224:227]
    v_cvt_pk_bf16_f32 v152, v136, v137
    v_cvt_pk_bf16_f32 v153, v138, v139
    v_mfma_f32_16x16x32_bf16 v[224:227], v[196:199], v[164:167], v[224:227]
    v_cvt_pk_bf16_f32 v154, v116, v117
    v_cvt_pk_bf16_f32 v155, v118, v119
    v_mfma_f32_16x16x32_bf16 v[224:227], v[200:203], v[168:171], v[224:227]
    v_cvt_pk_bf16_f32 v232, v132, v133
    v_cvt_pk_bf16_f32 v233, v134, v135
    v_mfma_f32_16x16x32_bf16 v[224:227], v[204:207], v[172:175], v[224:227]
    ds_write_addtid_b32 v150 offset:0
    ds_write_addtid_b32 v151 offset:256
    v_mfma_f32_16x16x32_bf16 v[224:227], v[208:211], v[176:179], v[224:227]
    ds_write_addtid_b32 v152 offset:544
    ds_write_addtid_b32 v153 offset:800
    v_mfma_f32_16x16x32_bf16 v[224:227], v[212:215], v[180:183], v[224:227]
    ds_write_addtid_b32 v154 offset:1088
    ds_write_addtid_b32 v155 offset:1344
    v_mfma_f32_16x16x32_bf16 v[224:227], v[216:219], v[184:187], v[224:227]
    s_nop 0
    ds_write_addtid_b32 v232 offset:1632
    ds_write_addtid_b32 v233 offset:1888
    v_pk_mul_f32 v[84:85], v[120:121], v[76:77] op_sel:[0,0] op_sel_hi:[0,1]
    v_pk_mul_f32 v[86:87], v[122:123], v[78:79] op_sel:[0,0] op_sel_hi:[0,1]
    v_pk_mul_f32 v[88:89], v[136:137], v[76:77] op_sel:[0,0] op_sel_hi:[0,1]
    v_pk_mul_f32 v[90:91], v[138:139], v[78:79] op_sel:[0,0] op_sel_hi:[0,1]
    v_pk_mul_f32 v[92:93], v[116:117], v[76:77] op_sel:[0,0] op_sel_hi:[0,1]
    v_pk_mul_f32 v[94:95], v[118:119], v[78:79] op_sel:[0,0] op_sel_hi:[0,1]
    v_pk_mul_f32 v[96:97], v[132:133], v[76:77] op_sel:[0,0] op_sel_hi:[0,1]
    v_pk_mul_f32 v[98:99], v[134:135], v[78:79] op_sel:[0,0] op_sel_hi:[0,1]
    v_pk_fma_f32 v[120:121], v[120:121], v[76:77], v[84:85] op_sel:[1,1,0] op_sel_hi:[1,0,1] neg_lo:[1,0,0]
    v_pk_fma_f32 v[122:123], v[122:123], v[78:79], v[86:87] op_sel:[1,1,0] op_sel_hi:[1,0,1] neg_lo:[1,0,0]
    v_pk_fma_f32 v[136:137], v[136:137], v[76:77], v[88:89] op_sel:[1,1,0] op_sel_hi:[1,0,1] neg_lo:[1,0,0]
    v_pk_fma_f32 v[138:139], v[138:139], v[78:79], v[90:91] op_sel:[1,1,0] op_sel_hi:[1,0,1] neg_lo:[1,0,0]
    v_pk_fma_f32 v[116:117], v[116:117], v[76:77], v[92:93] op_sel:[1,1,0] op_sel_hi:[1,0,1] neg_lo:[1,0,0]
    v_pk_fma_f32 v[118:119], v[118:119], v[78:79], v[94:95] op_sel:[1,1,0] op_sel_hi:[1,0,1] neg_lo:[1,0,0]
    v_pk_fma_f32 v[132:133], v[132:133], v[76:77], v[96:97] op_sel:[1,1,0] op_sel_hi:[1,0,1] neg_lo:[1,0,0]
    v_pk_fma_f32 v[134:135], v[134:135], v[78:79], v[98:99] op_sel:[1,1,0] op_sel_hi:[1,0,1] neg_lo:[1,0,0]
    v_cvt_pk_bf16_f32 v234, v120, v121
    v_cvt_pk_bf16_f32 v235, v122, v123
    v_cvt_pk_bf16_f32 v236, v136, v137
    v_cvt_pk_bf16_f32 v237, v138, v139
    v_cvt_pk_bf16_f32 v238, v116, v117
    v_cvt_pk_bf16_f32 v239, v118, v119
    v_cvt_pk_bf16_f32 v148, v132, v133
    v_cvt_pk_bf16_f32 v149, v134, v135
    ds_write_addtid_b32 v234 offset:2176
    ds_write_addtid_b32 v235 offset:2432
    ds_write_addtid_b32 v236 offset:2720
    ds_write_addtid_b32 v237 offset:2976
    ds_write_addtid_b32 v238 offset:3264
    ds_write_addtid_b32 v239 offset:3520
    ds_write_addtid_b32 v148 offset:3808
    ds_write_addtid_b32 v149 offset:4064
    v_pk_mul_f32 v[84:85], v[136:137], v[76:77] op_sel:[0,0] op_sel_hi:[0,1]
    v_pk_mul_f32 v[86:87], v[138:139], v[78:79] op_sel:[0,0] op_sel_hi:[0,1]
    v_pk_mul_f32 v[88:89], v[132:133], v[76:77] op_sel:[0,0] op_sel_hi:[0,1]
    v_pk_mul_f32 v[90:91], v[134:135], v[78:79] op_sel:[0,0] op_sel_hi:[0,1]
    v_pk_fma_f32 v[136:137], v[136:137], v[76:77], v[84:85] op_sel:[1,1,0] op_sel_hi:[1,0,1] neg_lo:[1,0,0]
    v_pk_fma_f32 v[138:139], v[138:139], v[78:79], v[86:87] op_sel:[1,1,0] op_sel_hi:[1,0,1] neg_lo:[1,0,0]
    v_pk_fma_f32 v[132:133], v[132:133], v[76:77], v[88:89] op_sel:[1,1,0] op_sel_hi:[1,0,1] neg_lo:[1,0,0]
    v_pk_fma_f32 v[134:135], v[134:135], v[78:79], v[90:91] op_sel:[1,1,0] op_sel_hi:[1,0,1] neg_lo:[1,0,0]
    v_cvt_pk_bf16_f32 v150, v136, v137
    v_cvt_pk_bf16_f32 v151, v138, v139
    v_cvt_pk_bf16_f32 v152, v132, v133
    v_cvt_pk_bf16_f32 v153, v134, v135
    v_pk_mul_f32 v[84:85], v[136:137], v[76:77] op_sel:[0,0] op_sel_hi:[0,1]
    v_pk_mul_f32 v[86:87], v[138:139], v[78:79] op_sel:[0,0] op_sel_hi:[0,1]
    v_pk_mul_f32 v[88:89], v[132:133], v[76:77] op_sel:[0,0] op_sel_hi:[0,1]
    v_pk_mul_f32 v[90:91], v[134:135], v[78:79] op_sel:[0,0] op_sel_hi:[0,1]
    v_pk_fma_f32 v[136:137], v[136:137], v[76:77], v[84:85] op_sel:[1,1,0] op_sel_hi:[1,0,1] neg_lo:[1,0,0]
    v_pk_fma_f32 v[138:139], v[138:139], v[78:79], v[86:87] op_sel:[1,1,0] op_sel_hi:[1,0,1] neg_lo:[1,0,0]
    v_pk_fma_f32 v[132:133], v[132:133], v[76:77], v[88:89] op_sel:[1,1,0] op_sel_hi:[1,0,1] neg_lo:[1,0,0]
    v_pk_fma_f32 v[134:135], v[134:135], v[78:79], v[90:91] op_sel:[1,1,0] op_sel_hi:[1,0,1] neg_lo:[1,0,0]
    v_cvt_pk_bf16_f32 v154, v136, v137
    v_cvt_pk_bf16_f32 v155, v138, v139
    v_cvt_pk_bf16_f32 v232, v132, v133
    v_cvt_pk_bf16_f32 v233, v134, v135
    ds_write_addtid_b32 v150 offset:4352
    ds_write_addtid_b32 v151 offset:4608
    ds_write_addtid_b32 v152 offset:4896
    ds_write_addtid_b32 v153 offset:5152
    ds_write_addtid_b32 v154 offset:5440
    ds_write_addtid_b32 v155 offset:5696
    ds_write_addtid_b32 v232 offset:5984
    ds_write_addtid_b32 v233 offset:6240
    v_pk_mul_f32 v[84:85], v[136:137], v[76:77] op_sel:[0,0] op_sel_hi:[0,1]
    v_pk_mul_f32 v[86:87], v[138:139], v[78:79] op_sel:[0,0] op_sel_hi:[0,1]
    v_pk_mul_f32 v[88:89], v[132:133], v[76:77] op_sel:[0,0] op_sel_hi:[0,1]
    v_pk_mul_f32 v[90:91], v[134:135], v[78:79] op_sel:[0,0] op_sel_hi:[0,1]
    v_pk_fma_f32 v[136:137], v[136:137], v[76:77], v[84:85] op_sel:[1,1,0] op_sel_hi:[1,0,1] neg_lo:[1,0,0]
    v_pk_fma_f32 v[138:139], v[138:139], v[78:79], v[86:87] op_sel:[1,1,0] op_sel_hi:[1,0,1] neg_lo:[1,0,0]
    v_pk_fma_f32 v[132:133], v[132:133], v[76:77], v[88:89] op_sel:[1,1,0] op_sel_hi:[1,0,1] neg_lo:[1,0,0]
    v_pk_fma_f32 v[134:135], v[134:135], v[78:79], v[90:91] op_sel:[1,1,0] op_sel_hi:[1,0,1] neg_lo:[1,0,0]
    v_cvt_pk_bf16_f32 v234, v136, v137
    v_cvt_pk_bf16_f32 v235, v138, v139
    v_cvt_pk_bf16_f32 v236, v132, v133
    v_cvt_pk_bf16_f32 v237, v134, v135
    v_pk_mul_f32 v[84:85], v[136:137], v[76:77] op_sel:[0,0] op_sel_hi:[0,1]
    v_pk_mul_f32 v[86:87], v[138:139], v[78:79] op_sel:[0,0] op_sel_hi:[0,1]
    v_pk_mul_f32 v[88:89], v[132:133], v[76:77] op_sel:[0,0] op_sel_hi:[0,1]
    v_pk_mul_f32 v[90:91], v[134:135], v[78:79] op_sel:[0,0] op_sel_hi:[0,1]
    v_pk_fma_f32 v[136:137], v[136:137], v[76:77], v[84:85] op_sel:[1,1,0] op_sel_hi:[1,0,1] neg_lo:[1,0,0]
    v_pk_fma_f32 v[138:139], v[138:139], v[78:79], v[86:87] op_sel:[1,1,0] op_sel_hi:[1,0,1] neg_lo:[1,0,0]
    v_pk_fma_f32 v[132:133], v[132:133], v[76:77], v[88:89] op_sel:[1,1,0] op_sel_hi:[1,0,1] neg_lo:[1,0,0]
    v_pk_fma_f32 v[134:135], v[134:135], v[78:79], v[90:91] op_sel:[1,1,0] op_sel_hi:[1,0,1] neg_lo:[1,0,0]
    v_cvt_pk_bf16_f32 v238, v136, v137
    v_cvt_pk_bf16_f32 v239, v138, v139
    v_cvt_pk_bf16_f32 v148, v132, v133
    v_cvt_pk_bf16_f32 v149, v134, v135
    ds_write_addtid_b32 v234 offset:6528
    ds_write_addtid_b32 v235 offset:6784
    ds_write_addtid_b32 v236 offset:7072
    ds_write_addtid_b32 v237 offset:7328
    ds_write_addtid_b32 v238 offset:7616
    ds_write_addtid_b32 v239 offset:7872
    ds_write_addtid_b32 v148 offset:8160
    ds_write_addtid_b32 v149 offset:8416
    ds_read_b128 v[188:191], v59 offset:0
    ds_read_b128 v[192:195], v59 offset:64
    ds_read_b128 v[196:199], v59 offset:128
    ds_read_b128 v[200:203], v59 offset:192
    ds_read_b128 v[204:207], v59 offset:256
    ds_read_b128 v[208:211], v59 offset:320
    ds_read_b128 v[212:215], v59 offset:384
    ds_read_b128 v[216:219], v59 offset:448
    v_cvt_pk_bf16_f32 v240, v223, v222
    v_cvt_pk_bf16_f32 v241, v221, v220
    v_cvt_pk_bf16_f32 v242, v222, v221
    ds_write_b64 v61, v[240:241] offset:512
    ds_write_b16 v61, v240 offset:1726
    ds_write_b32 v61, v242 offset:1728
    ds_write_b16_d16_hi v61, v241 offset:1732
    s_waitcnt lgkmcnt(0)
    v_mfma_f32_16x16x32_bf16 v[228:231], v[188:191], v[156:159], 0
    v_cvt_pk_bf16_f32 v244, v227, v226
    v_mfma_f32_16x16x32_bf16 v[228:231], v[192:195], v[160:163], v[228:231]
    v_cvt_pk_bf16_f32 v245, v225, v224
    v_mfma_f32_16x16x32_bf16 v[228:231], v[196:199], v[164:167], v[228:231]
    v_cvt_pk_bf16_f32 v246, v226, v225
    v_mfma_f32_16x16x32_bf16 v[228:231], v[200:203], v[168:171], v[228:231]
    ds_write_b64 v61, v[244:245] offset:0
    v_mfma_f32_16x16x32_bf16 v[228:231], v[204:207], v[172:175], v[228:231]
    ds_write_b16 v61, v244 offset:1214
    v_mfma_f32_16x16x32_bf16 v[228:231], v[208:211], v[176:179], v[228:231]
    ds_write_b32 v61, v246 offset:1216
    v_mfma_f32_16x16x32_bf16 v[228:231], v[212:215], v[180:183], v[228:231]
    ds_write_b16_d16_hi v61, v245 offset:1220
    v_mfma_f32_16x16x32_bf16 v[228:231], v[216:219], v[184:187], v[228:231]
    v_cvt_pk_bf16_f32 v72, v227, v227
    s_mov_b32 exec_lo, 0
    s_mov_b32 exec_hi, 0x80000000
    ds_write_b32 v62, v72 offset:60
    ds_write_b16 v62, v72 offset:58
    ds_write_b32 v62, v72 offset:1272
    ds_write_b16 v62, v72 offset:1276
    s_mov_b64 exec, -1
    v_cvt_pk_bf16_f32 v74, v228, v229
    v_cvt_pk_bf16_f32 v75, v230, v231
    s_mov_b32 exec_hi, 0
    ds_write_b32 v63, v74 offset:32
    ds_write_b32 v63, v75
    s_mov_b32 exec_hi, -1
    s_mov_b32 exec_lo, 0
    ds_write_b16 v63, v74 offset:96
    ds_write_b16_d16_hi v63, v74 offset:64
    ds_write_b16 v63, v75 offset:32
    ds_write_b16_d16_hi v63, v75
    s_mov_b32 exec_lo, -1
    s_waitcnt vmcnt(0)
    s_cmp_lt_u32 s49, 24
    s_cbranch_scc1 L_tab_done
    s_cmp_ge_u32 s48, 2
    s_cbranch_scc1 L_tab_done
    s_mov_b32 s58, 1000000
L_pollK:
    ds_read_b32 v42, v4 offset:20
    s_sub_u32 s58, s58, 1
    s_waitcnt lgkmcnt(0)
    s_cbranch_scc1 L_pollK_done
    v_cmp_ne_u32 vcc, 1, v42
    s_nop 0
    s_cbranch_vccnz L_pollK
L_pollK_done:
    ds_read_b128 v[220:223], v40 offset:0
    ds_read_b128 v[224:227], v40 offset:1024
    ds_read_b128 v[228:231], v40 offset:2048
    s_add_u32 s4, s66, 4608
    v_add_u32 v61, s4, v5
    v_mov_b32 v62, s4
    v_add_u32 v63, s4, v6
    s_waitcnt lgkmcnt(2)
    v_pk_add_f32 v[220:221], v[220:221], v[28:29]
    v_pk_add_f32 v[222:223], v[222:223], v[30:31]
    s_waitcnt lgkmcnt(1)
    v_pk_add_f32 v[224:225], v[224:225], v[32:33]
    v_pk_add_f32 v[226:227], v[226:227], v[34:35]
    s_waitcnt lgkmcnt(0)
    v_pk_add_f32 v[228:229], v[228:229], v[36:37]
    v_pk_add_f32 v[230:231], v[230:231], v[38:39]
    v_cvt_pk_bf16_f32 v240, v223, v222
    v_cvt_pk_bf16_f32 v241, v221, v220
    v_cvt_pk_bf16_f32 v242, v222, v221
    ds_write_b64 v61, v[240:241] offset:512
    ds_write_b16 v61, v240 offset:1726
    ds_write_b32 v61, v242 offset:1728
    ds_write_b16_d16_hi v61, v241 offset:1732
    v_cvt_pk_bf16_f32 v244, v227, v226
    v_cvt_pk_bf16_f32 v245, v225, v224
    v_cvt_pk_bf16_f32 v246, v226, v225
    ds_write_b64 v61, v[244:245] offset:0
    ds_write_b16 v61, v244 offset:1214
    ds_write_b32 v61, v246 offset:1216
    ds_write_b16_d16_hi v61, v245 offset:1220
    v_cvt_pk_bf16_f32 v72, v227, v227
    s_mov_b32 exec_lo, 0
    s_mov_b32 exec_hi, 0x80000000
    ds_write_b32 v62, v72 offset:60
    ds_write_b16 v62, v72 offset:58
    ds_write_b32 v62, v72 offset:1272
    ds_write_b16 v62, v72 offset:1276
    s_mov_b64 exec, -1
    v_cvt_pk_bf16_f32 v74, v228, v229
    v_cvt_pk_bf16_f32 v75, v230, v231
    s_mov_b32 exec_hi, 0
    ds_write_b32 v63, v74 offset:32
    ds_write_b32 v63, v75
    s_mov_b32 exec_hi, -1
    s_mov_b32 exec_lo, 0
    ds_write_b16 v63, v74 offset:96
    ds_write_b16_d16_hi v63, v74 offset:64
    ds_write_b16 v63, v75 offset:32
    ds_write_b16_d16_hi v63, v75
    s_mov_b32 exec_lo, -1
    ds_write_b32 v4, v41 offset:4
L_tab_done:
    v_readfirstlane_b32 s55, v22
    s_nop 0
    s_mul_i32 s55, s55, 1664525
    s_add_u32 s55, s55, 1013904223
    s_max_u32 s55, s55, 1
    s_cmp_ge_u32 s49, 24
    s_cbranch_scc1 L_xp2
    s_getreg_b32 s4, hwreg(HW_REG_XCC_ID, 0, 4)
    v_mov_b32 v244, s55
    v_mov_b32_e64 v245, s4
    s_cmp_lg_u32 s48, 0
    s_cbranch_scc1 L_xp2
    s_lshl_b32 s4, s56, 3
    s_add_u32 s4, s4, s52
    s_lshl_b32 s4, s4, 7
    s_add_u32 s4, s4, 655360
    v_mov_b32 v246, s4
    s_mov_b64 exec, 1
    global_store_dwordx2 v246, v[244:245], s[46:47] sc1
    s_mov_b64 exec, -1
L_xp2:
    s_cmp_ge_u32 s49, 24
    s_cbranch_scc1 L_nosp
    s_cmp_lt_u32 s48, 2
    s_cselect_b32 s16, s32, s34
    s_cselect_b32 s17, s33, s35
    s_mov_b32 s18, 663552
    s_mov_b32 s19, 0x20000
    s_getreg_b32 s14, hwreg(HW_REG_XCC_ID, 0, 4)
    s_lshl_b32 s12, s56, 10
    s_add_u32 s12, s12, 655360
    s_lshl_b32 s23, s52, 7
    s_add_u32 s23, s23, s12
    s_lshl_b32 s4, s48, 2
    s_add_u32 s23, s23, s4
    s_mov_b32 s33, s57
    s_lshr_b32 s4, s56, 1
    s_mul_i32 s4, s4, 4608
    s_add_u32 s4, s4, 262144
    v_min_u32_e64 v62, 8, v1
    v_lshl_add_u32 v62, v62, 7, s57
    v_subrev_u32 v63, 1152, v62
    v_min_u32 v62, v62, v63
    v_lshrrev_b32 v62, 5, v62
    v_add_u32_e64 v62, s48, v62
    v_lshl_add_u32 v62, v62, 7, s4
    s_mul_i32 s4, s56, 147456
    s_lshl_b32 s15, s48, 12
    s_add_u32 s4, s4, s15
    s_add_u32 s4, s4, 0
    v_lshl_add_u32 v63, v1, 4, s4
    s_add_u32 s34, s33, 128
    s_cmp_eq_u32 s34, 1152
    s_cselect_b32 s34, 0, s34
    s_add_u32 s35, s34, 128
    s_cmp_eq_u32 s35, 1152
    s_cselect_b32 s35, 0, s35
    s_add_u32 s36, s35, 128
    s_cmp_eq_u32 s36, 1152
    s_cselect_b32 s36, 0, s36
    s_add_u32 s37, s36, 128
    s_cmp_eq_u32 s37, 1152
    s_cselect_b32 s37, 0, s37
    s_add_u32 s40, s37, 128
    s_cmp_eq_u32 s40, 1152
    s_cselect_b32 s40, 0, s40
    s_add_u32 s41, s40, 128
    s_cmp_eq_u32 s41, 1152
    s_cselect_b32 s41, 0, s41
    s_add_u32 s44, s41, 128
    s_cmp_eq_u32 s44, 1152
    s_cselect_b32 s44, 0, s44
    s_add_u32 s45, s44, 128
    s_cmp_eq_u32 s45, 1152
    s_cselect_b32 s45, 0, s45
    s_lshl_b32 s4, s56, 6
    v_lshrrev_b32 v96, 3, v0
    v_add_u32 v97, s4, v96
    v_and_b32_e64 v98, 7, v0
    s_mul_i32 s5, s52, 192
    v_lshl_add_u32 v99, v98, 3, s5
    v_mul_u32_u24 v100, 1152, v97
    v_add_u32_e64 v100, v100, v99
    v_add_u32 v101, 36864, v100
    s_lshr_b32 s4, s56, 1
    s_mul_i32 s4, s4, 4608
    s_lshl_b32 s5, s51, 6
    s_add_u32 s4, s4, s5
    s_lshr_b32 s5, s48, 1
    s_lshl_b32 s5, s5, 2
    s_add_u32 s4, s4, s5
    s_and_b32 s5, s48, 1
    s_lshl_b32 s5, s5, 8
    s_add_u32 s4, s4, s5
    s_add_u32 s4, s4, 458752
    v_lshrrev_b32 v102, 3, v1
    v_and_b32_e64 v109, 3, v102
    v_lshl_add_u32 v109, v109, 3, s4
    v_lshrrev_b32_e64 v104, 5, v1
    v_lshl_add_u32 v109, v104, 7, v109
    v_lshl_add_u32 v104, v98, 9, v109
    v_add_u32 v109, 4096, v109
    s_mul_i32 s4, s52, 43
    s_lshr_b32 s4, s4, 5
    s_mul_i32 s4, s4, 1792
    s_add_u32 s4, s4, 393216
    v_min_u32_e64 v105, 27, v1
    v_lshl_add_u32 v105, v105, 7, s4
    s_mul_i32 s4, s52, 96
    s_mul_i32 s5, s48, 24
    s_add_u32 s4, s4, s5
    s_lshl_b32 s4, s4, 12
    s_lshl_b32 s5, s56, 7
    s_add_u32 s4, s4, s5
    s_add_u32 s4, s4, 6291456
    v_lshl_add_u32 v253, v102, 12, s4
    v_lshrrev_b32 v254, 5, v1
    s_mul_i32 s5, s48, 6
    v_add_u32 v254, s5, v254
    v_add_u32 v255, 0, v254
    v_xor_b32 v255, v255, v1
    v_and_b32_e64 v255, 7, v255
    v_lshl_add_u32 v248, v255, 4, v253
    v_add_u32 v255, 2, v254
    v_xor_b32 v255, v255, v1
    v_and_b32_e64 v255, 7, v255
    v_lshl_add_u32 v249, v255, 4, v253
    v_add_u32 v255, 4, v254
    v_xor_b32 v255, v255, v1
    v_and_b32_e64 v255, 7, v255
    v_lshl_add_u32 v250, v255, 4, v253
    s_mul_i32 s4, s52, 96
    s_and_b32 s5, s48, 1
    s_mul_i32 s5, s5, 48
    s_add_u32 s4, s4, s5
    v_add_u32 v253, s4, v102
    v_mul_u32_u24 v253, 1152, v253
    v_xor_b32_e64 v254, v98, v3
    v_lshl_add_u32 v253, v254, 4, v253
    v_xor_b32_e64 v254, 64, v253
    v_add_u32 v254, 8192, v254
    s_mul_i32 s22, s48, 12288
    s_add_u32 s22, s22, 100352
    s_mul_i32 s21, s48, 3072
    s_and_b32 s4, s48, 1
    s_lshl_b32 s4, s4, 2
    s_lshr_b32 s5, s48, 1
    s_add_u32 s4, s4, s5
    v_xor_b32 v251, s4, v98
    v_lshlrev_b32 v251, 4, v251
    v_lshl_add_u32 v251, v98, 9, v251
    v_lshl_add_u32 v251, v102, 1, v251
    v_add_u32 v251, 151552, v251
    v_xor_b32_e64 v252, 32, v251
    v_mul_u32_u24 v96, 400, v96
    v_lshl_add_u32 v96, v98, 4, v96
    v_add_u32 v96, 98304, v96
    v_lshlrev_b32 v100, 1, v100
    v_lshlrev_b32 v101, 1, v101
    v_lshlrev_b32_e64 v64, 16, v44
    v_and_b32 v65, 0xffff0000, v44
    v_lshlrev_b32_e64 v66, 16, v45
    v_and_b32 v67, 0xffff0000, v45
    v_lshlrev_b32_e64 v68, 16, v46
    v_and_b32 v69, 0xffff0000, v46
    v_lshlrev_b32_e64 v70, 16, v47
    v_and_b32 v71, 0xffff0000, v47
    v_lshlrev_b32_e64 v72, 16, v48
    v_and_b32 v73, 0xffff0000, v48
    v_lshlrev_b32_e64 v74, 16, v49
    v_and_b32 v75, 0xffff0000, v49
    v_lshlrev_b32_e64 v76, 16, v28
    v_and_b32 v77, 0xffff0000, v28
    v_lshlrev_b32_e64 v78, 16, v29
    v_and_b32 v79, 0xffff0000, v29
    v_lshlrev_b32_e64 v80, 16, v30
    v_and_b32 v81, 0xffff0000, v30
    v_lshlrev_b32_e64 v82, 16, v31
    v_and_b32 v83, 0xffff0000, v31
    v_lshlrev_b32_e64 v84, 16, v32
    v_and_b32 v85, 0xffff0000, v32
    v_lshlrev_b32_e64 v86, 16, v33
    v_and_b32 v87, 0xffff0000, v33
    v_lshlrev_b32_e64 v88, 16, v34
    v_and_b32 v89, 0xffff0000, v34
    v_lshlrev_b32_e64 v90, 16, v35
    v_and_b32 v91, 0xffff0000, v35
    v_lshlrev_b32_e64 v92, 16, v36
    v_and_b32 v93, 0xffff0000, v36
    v_lshlrev_b32_e64 v94, 16, v37
    v_and_b32 v95, 0xffff0000, v37
    v_lshlrev_b32_e64 v20, 16, v38
    v_and_b32 v21, 0xffff0000, v38
    v_lshlrev_b32_e64 v22, 16, v39
    v_and_b32 v23, 0xffff0000, v39
    v_pk_mul_f32 v[76:77], v[76:77], v[64:65]
    v_pk_mul_f32 v[78:79], v[78:79], v[66:67]
    v_pk_mul_f32 v[80:81], v[80:81], v[68:69]
    v_pk_mul_f32 v[82:83], v[82:83], v[70:71]
    v_pk_mul_f32 v[84:85], v[84:85], v[72:73]
    v_pk_mul_f32 v[86:87], v[86:87], v[74:75]
    v_pk_mul_f32 v[88:89], v[88:89], v[64:65]
    v_pk_mul_f32 v[90:91], v[90:91], v[66:67]
    v_pk_mul_f32 v[92:93], v[92:93], v[68:69]
    v_pk_mul_f32 v[94:95], v[94:95], v[70:71]
    v_pk_mul_f32 v[20:21], v[20:21], v[72:73]
    v_pk_mul_f32 v[22:23], v[22:23], v[74:75]
    v_lshl_add_u32 v8, v1, 4, s68
    s_mul_i32 s4, s48, 5120
    s_add_u32 s4, s4, 69632
    v_lshl_add_u32 v9, v1, 4, s4
    ds_write_b128 v8, v[60:63] offset:0
    ds_write_b128 v8, v[96:99] offset:1024
    ds_write_b128 v8, v[100:103] offset:2048
    ds_write_b128 v8, v[104:107] offset:3072
    ds_write_b128 v8, v[108:111] offset:4096
    ds_write_b128 v8, v[248:251] offset:5120
    ds_write_b128 v8, v[252:255] offset:6144
    ds_write_b128 v8, v[20:23] offset:7168
    ds_write_b128 v9, v[76:79] offset:0
    ds_write_b128 v9, v[80:83] offset:1024
    ds_write_b128 v9, v[84:87] offset:2048
    ds_write_b128 v9, v[88:91] offset:3072
    ds_write_b128 v9, v[92:95] offset:4096
L_nosp:
    v_mov_b32 v10, v56
.p2align 3
L_conv:
    v_add_u32_e64 v5, s70, v10
    v_add_u32 v6, 1024, v5
    v_add_u32 v8, s70, v24
    v_add_u32_e64 v7, s69, v25
    s_lshl_b32 s62, s61, 12
    s_add_u32 s62, s62, 6291456
    v_mov_b32_e64 v9, s70
    ds_read2_b32 v[88:89], v6 offset0:0 offset1:1
    ds_read2_b32 v[90:91], v6 offset0:2 offset1:3
    ds_read2_b32 v[92:93], v5 offset0:240 offset1:241
    ds_read2_b32 v[94:95], v5 offset0:242 offset1:243
    ds_read2_b32 v[96:97], v5 offset0:224 offset1:225
    ds_read2_b32 v[98:99], v5 offset0:226 offset1:227
    ds_read2_b32 v[100:101], v5 offset0:208 offset1:209
    ds_read2_b32 v[102:103], v5 offset0:210 offset1:211
    ds_read2_b32 v[104:105], v5 offset0:192 offset1:193
    ds_read2_b32 v[106:107], v5 offset0:194 offset1:195
    ds_read2_b32 v[108:109], v5 offset0:176 offset1:177
    ds_read2_b32 v[110:111], v5 offset0:178 offset1:179
    ds_read2_b32 v[112:113], v5 offset0:160 offset1:161
    ds_read2_b32 v[114:115], v5 offset0:162 offset1:163
    ds_read2_b32 v[116:117], v5 offset0:144 offset1:145
    ds_read2_b32 v[118:119], v5 offset0:146 offset1:147
    ds_read2_b32 v[120:121], v5 offset0:128 offset1:129
    ds_read2_b32 v[122:123], v5 offset0:130 offset1:131
    ds_read2_b32 v[124:125], v5 offset0:112 offset1:113
    ds_read2_b32 v[126:127], v5 offset0:114 offset1:115
    ds_read2_b32 v[128:129], v5 offset0:96 offset1:97
    ds_read2_b32 v[130:131], v5 offset0:98 offset1:99
    ds_read2_b32 v[132:133], v5 offset0:80 offset1:81
    ds_read2_b32 v[134:135], v5 offset0:82 offset1:83
    ds_read2_b32 v[136:137], v5 offset0:64 offset1:65
    ds_read2_b32 v[138:139], v5 offset0:66 offset1:67
    ds_read2_b32 v[140:141], v5 offset0:48 offset1:49
    ds_read2_b32 v[142:143], v5 offset0:50 offset1:51
    ds_read2_b32 v[144:145], v5 offset0:32 offset1:33
    ds_read2_b32 v[146:147], v5 offset0:34 offset1:35
    ds_read2_b32 v[148:149], v5 offset0:16 offset1:17
    ds_read2_b32 v[150:151], v5 offset0:18 offset1:19
    ds_read2_b32 v[152:153], v5 offset0:0 offset1:1
    ds_read2_b32 v[154:155], v5 offset0:2 offset1:3
    ds_read2_b32 v[156:157], v8 offset0:32 offset1:33
    ds_read2_b32 v[158:159], v8 offset0:34 offset1:35
    ds_read2_b32 v[160:161], v8 offset0:96 offset1:97
    ds_read2_b32 v[162:163], v8 offset0:98 offset1:99
    ds_read2_b32 v[164:165], v8 offset0:16 offset1:17
    ds_read2_b32 v[166:167], v8 offset0:18 offset1:19
    ds_read2_b32 v[168:169], v8 offset0:80 offset1:81
    ds_read2_b32 v[170:171], v8 offset0:82 offset1:83
    ds_read2_b32 v[172:173], v8 offset0:0 offset1:1
    ds_read2_b32 v[174:175], v8 offset0:2 offset1:3
    ds_read2_b32 v[176:177], v8 offset0:64 offset1:65
    ds_read2_b32 v[178:179], v8 offset0:66 offset1:67
    ds_read2_b32 v[180:181], v8 offset0:176 offset1:177
    ds_read2_b32 v[182:183], v8 offset0:178 offset1:179
    ds_read2_b32 v[184:185], v8 offset0:160 offset1:161
    ds_read2_b32 v[186:187], v8 offset0:162 offset1:163
    ds_read2_b32 v[188:189], v8 offset0:144 offset1:145
    ds_read2_b32 v[190:191], v8 offset0:146 offset1:147
    ds_read2_b32 v[192:193], v8 offset0:128 offset1:129
    ds_read2_b32 v[194:195], v8 offset0:130 offset1:131
    ds_read_u16 v11, v9 offset:2690
    s_add_u32 s4, s66, 4608
    v_add_u32_e64 v5, s4, v10
    v_add_u32 v6, 1024, v5
    v_add_u32 v8, s4, v24
    v_mov_b32 v9, s4
    s_mov_b32 s58, 1000000
L_pollU:
    ds_read_b32 v16, v27
    s_sub_u32 s58, s58, 1
    s_waitcnt lgkmcnt(0)
    s_cbranch_scc1 L_pollU_done
    v_cmp_ne_u32 vcc, 1, v16
    s_nop 1
    s_cbranch_vccz L_pollU_done
    s_sleep 2
    s_branch L_pollU
L_pollU_done:
    v_lshlrev_b32_e64 v17, 4, v1
    v_add_u32 v17, 90112, v17
    ds_read_b128 v[28:31], v17 offset:0
    ds_read_b128 v[32:35], v17 offset:1024
    ds_read_b128 v[36:39], v17 offset:2048
    ds_read_b128 v[44:47], v17 offset:4096
    ds_read_b128 v[40:43], v17 offset:3072
    ds_read_b128 v[48:51], v17 offset:5120
    ds_read_b128 v[52:55], v17 offset:6144
    ds_read_b128 v[232:235], v7 offset:448
    ds_read_b128 v[236:239], v7 offset:432
    ds_read_b128 v[240:243], v7 offset:0
    ds_read_b128 v[244:247], v7 offset:64
    ds_read_b128 v[248:251], v7 offset:128
    s_waitcnt lgkmcnt(3)
    v_mfma_f32_16x16x32_bf16 v[196:199], v[232:235], v[28:31], 0
    ds_read_b128 v[252:255], v7 offset:192
    v_lshl_or_b32 v11, v11, 16, v11
    v_mfma_f32_16x16x32_bf16 v[200:203], v[232:235], v[32:35], 0
    v_and_b32 v12, v52, v11
    v_and_b32_e64 v13, v53, v11
    v_mfma_f32_16x16x32_bf16 v[204:207], v[232:235], v[36:39], 0
    v_and_b32 v14, v54, v11
    v_and_b32 v15, v55, v11
    v_mfma_f32_16x16x32_bf16 v[212:215], v[232:235], v[44:47], 0
    v_mfma_f32_16x16x32_bf16 v[208:211], v[236:239], v[40:43], 0
    ds_read_b128 v[16:19], v7 offset:256
    v_mfma_f32_16x16x32_bf16 v[216:219], v[236:239], v[48:51], 0
    s_waitcnt lgkmcnt(3)
    v_mfma_f32_16x16x32_bf16 v[56:59], v[116:119], v[240:243], 0
    ds_read_b128 v[20:23], v7 offset:320
    v_mfma_f32_16x16x32_bf16 v[60:63], v[148:151], v[240:243], 0
    v_mfma_f32_16x16x32_bf16 v[56:59], v[112:115], v[244:247], v[56:59]
    ds_read_b128 v[232:235], v7 offset:384
    v_cvt_pk_bf16_f32 v220, v196, v200
    v_mfma_f32_16x16x32_bf16 v[60:63], v[144:147], v[244:247], v[60:63]
    v_cvt_pk_bf16_f32 v221, v197, v201
    v_cvt_pk_bf16_f32 v222, v198, v202
    s_waitcnt lgkmcnt(3)
    v_mfma_f32_16x16x32_bf16 v[56:59], v[108:111], v[248:251], v[56:59]
    ds_read_b128 v[236:239], v7 offset:448
    v_cvt_pk_bf16_f32 v223, v199, v203
    v_mfma_f32_16x16x32_bf16 v[60:63], v[140:143], v[248:251], v[60:63]
    v_cvt_pk_bf16_f32 v224, v204, v208
    v_cvt_pk_bf16_f32 v225, v205, v209
    v_mfma_f32_16x16x32_bf16 v[56:59], v[104:107], v[252:255], v[56:59]
    ds_read_b128 v[240:243], v7 offset:512
    v_cvt_pk_bf16_f32 v226, v206, v210
    v_mfma_f32_16x16x32_bf16 v[60:63], v[136:139], v[252:255], v[60:63]
    v_cvt_pk_bf16_f32 v227, v207, v211
    v_cvt_pk_bf16_f32 v228, v212, v216
    v_mfma_f32_16x16x32_bf16 v[64:67], v[220:223], v[156:159], 0
    v_cvt_pk_bf16_f32 v229, v213, v217
    v_cvt_pk_bf16_f32 v230, v214, v218
    v_mfma_f32_16x16x32_bf16 v[68:71], v[220:223], v[164:167], 0
    v_cvt_pk_bf16_f32 v231, v215, v219
    v_mfma_f32_16x16x32_bf16 v[72:75], v[220:223], v[172:175], 0
    s_waitcnt lgkmcnt(3)
    v_mfma_f32_16x16x32_bf16 v[56:59], v[100:103], v[16:19], v[56:59]
    ds_read_b128 v[244:247], v7 offset:576
    v_mfma_f32_16x16x32_bf16 v[60:63], v[132:135], v[16:19], v[60:63]
    v_mfma_f32_16x16x32_bf16 v[64:67], v[224:227], v[160:163], v[64:67]
    v_mfma_f32_16x16x32_bf16 v[68:71], v[224:227], v[168:171], v[68:71]
    v_mfma_f32_16x16x32_bf16 v[72:75], v[224:227], v[176:179], v[72:75]
    v_mfma_f32_16x16x32_bf16 v[56:59], v[96:99], v[20:23], v[56:59]
    ds_read_b128 v[248:251], v7 offset:640
    v_mfma_f32_16x16x32_bf16 v[60:63], v[128:131], v[20:23], v[60:63]
    v_mfma_f32_16x16x32_bf16 v[72:75], v[228:231], v[180:183], v[72:75]
    v_mfma_f32_16x16x32_bf16 v[76:79], v[228:231], v[184:187], 0
    v_mfma_f32_16x16x32_bf16 v[80:83], v[228:231], v[188:191], 0
    v_mfma_f32_16x16x32_bf16 v[84:87], v[228:231], v[192:195], 0
    s_waitcnt lgkmcnt(3)
    v_mfma_f32_16x16x32_bf16 v[56:59], v[92:95], v[232:235], v[56:59]
    ds_read_b128 v[252:255], v7 offset:704
    v_mfma_f32_16x16x32_bf16 v[60:63], v[124:127], v[232:235], v[60:63]
    v_mfma_f32_16x16x32_bf16 v[72:75], v[12:15], v[236:239], v[72:75]
    ds_read_b128 v[16:19], v7 offset:768
    v_mfma_f32_16x16x32_bf16 v[56:59], v[88:91], v[236:239], v[56:59]
    v_mfma_f32_16x16x32_bf16 v[60:63], v[120:123], v[236:239], v[60:63]
    v_mfma_f32_16x16x32_bf16 v[64:67], v[152:155], v[236:239], v[64:67]
    s_waitcnt lgkmcnt(3)
    v_mfma_f32_16x16x32_bf16 v[60:63], v[116:119], v[240:243], v[60:63]
    ds_read_b128 v[20:23], v7 offset:832
    v_mfma_f32_16x16x32_bf16 v[64:67], v[148:151], v[240:243], v[64:67]
    v_mfma_f32_16x16x32_bf16 v[60:63], v[112:115], v[244:247], v[60:63]
    ds_read_b128 v[232:235], v7 offset:896
    v_mfma_f32_16x16x32_bf16 v[64:67], v[144:147], v[244:247], v[64:67]
    s_waitcnt lgkmcnt(3)
    v_mfma_f32_16x16x32_bf16 v[60:63], v[108:111], v[248:251], v[60:63]
    ds_read_b128 v[236:239], v7 offset:960
    v_mfma_f32_16x16x32_bf16 v[64:67], v[140:143], v[248:251], v[64:67]
    v_mfma_f32_16x16x32_bf16 v[60:63], v[104:107], v[252:255], v[60:63]
    ds_read_b128 v[240:243], v7 offset:944
    v_mfma_f32_16x16x32_bf16 v[64:67], v[136:139], v[252:255], v[64:67]
    s_waitcnt lgkmcnt(3)
    v_mfma_f32_16x16x32_bf16 v[60:63], v[100:103], v[16:19], v[60:63]
    ds_read_b128 v[244:247], v7 offset:1024
    v_mfma_f32_16x16x32_bf16 v[64:67], v[132:135], v[16:19], v[64:67]
    v_mfma_f32_16x16x32_bf16 v[60:63], v[96:99], v[20:23], v[60:63]
    ds_read_b128 v[248:251], v7 offset:1088
    v_mfma_f32_16x16x32_bf16 v[64:67], v[128:131], v[20:23], v[64:67]
    s_waitcnt lgkmcnt(3)
    v_mfma_f32_16x16x32_bf16 v[60:63], v[92:95], v[232:235], v[60:63]
    ds_read_b128 v[252:255], v7 offset:1152
    v_mfma_f32_16x16x32_bf16 v[64:67], v[124:127], v[232:235], v[64:67]
    v_mfma_f32_16x16x32_bf16 v[196:199], v[236:239], v[28:31], 0
    ds_read_b128 v[16:19], v7 offset:1216
    v_mfma_f32_16x16x32_bf16 v[200:203], v[236:239], v[32:35], 0
    v_mfma_f32_16x16x32_bf16 v[204:207], v[236:239], v[36:39], 0
    v_mfma_f32_16x16x32_bf16 v[212:215], v[236:239], v[44:47], 0
    v_mfma_f32_16x16x32_bf16 v[76:79], v[12:15], v[236:239], v[76:79]
    v_mfma_f32_16x16x32_bf16 v[60:63], v[88:91], v[236:239], v[60:63]
    v_mfma_f32_16x16x32_bf16 v[64:67], v[120:123], v[236:239], v[64:67]
    v_mfma_f32_16x16x32_bf16 v[68:71], v[152:155], v[236:239], v[68:71]
    s_waitcnt lgkmcnt(3)
    v_mfma_f32_16x16x32_bf16 v[208:211], v[240:243], v[40:43], 0
    ds_read_b128 v[20:23], v7 offset:1280
    v_mfma_f32_16x16x32_bf16 v[216:219], v[240:243], v[48:51], 0
    v_mfma_f32_16x16x32_bf16 v[64:67], v[116:119], v[244:247], v[64:67]
    ds_read_b128 v[232:235], v7 offset:1344
    v_mfma_f32_16x16x32_bf16 v[68:71], v[148:151], v[244:247], v[68:71]
    s_waitcnt lgkmcnt(3)
    v_mfma_f32_16x16x32_bf16 v[64:67], v[112:115], v[248:251], v[64:67]
    ds_read_b128 v[236:239], v7 offset:1408
    v_cvt_pk_bf16_f32 v220, v196, v200
    v_mfma_f32_16x16x32_bf16 v[68:71], v[144:147], v[248:251], v[68:71]
    v_cvt_pk_bf16_f32 v221, v197, v201
    v_cvt_pk_bf16_f32 v222, v198, v202
    v_mfma_f32_16x16x32_bf16 v[64:67], v[108:111], v[252:255], v[64:67]
    ds_read_b128 v[240:243], v7 offset:1472
    v_cvt_pk_bf16_f32 v223, v199, v203
    v_mfma_f32_16x16x32_bf16 v[68:71], v[140:143], v[252:255], v[68:71]
    v_cvt_pk_bf16_f32 v56, v56, v57
    v_cvt_pk_bf16_f32 v57, v58, v59
    s_waitcnt lgkmcnt(3)
    v_mfma_f32_16x16x32_bf16 v[64:67], v[104:107], v[16:19], v[64:67]
    ds_read_b128 v[244:247], v7 offset:1456
    v_cvt_pk_bf16_f32 v58, v60, v61
    v_mfma_f32_16x16x32_bf16 v[68:71], v[136:139], v[16:19], v[68:71]
    v_cvt_pk_bf16_f32 v59, v62, v63
    v_cvt_pk_bf16_f32 v224, v204, v208
    v_mfma_f32_16x16x32_bf16 v[68:71], v[220:223], v[156:159], v[68:71]
    v_cvt_pk_bf16_f32 v225, v205, v209
    v_cvt_pk_bf16_f32 v226, v206, v210
    v_mfma_f32_16x16x32_bf16 v[72:75], v[220:223], v[164:167], v[72:75]
    v_cvt_pk_bf16_f32 v227, v207, v211
    v_cvt_pk_bf16_f32 v228, v212, v216
    v_mfma_f32_16x16x32_bf16 v[76:79], v[220:223], v[172:175], v[76:79]
    v_cvt_pk_bf16_f32 v229, v213, v217
    v_cvt_pk_bf16_f32 v230, v214, v218
    v_mfma_f32_16x16x32_bf16 v[64:67], v[100:103], v[20:23], v[64:67]
    ds_read_b128 v[248:251], v7 offset:1536
    v_cvt_pk_bf16_f32 v231, v215, v219
    v_mfma_f32_16x16x32_bf16 v[68:71], v[132:135], v[20:23], v[68:71]
    v_permlane16_swap_b32 v56, v58
    v_permlane16_swap_b32 v57, v59
    v_mfma_f32_16x16x32_bf16 v[68:71], v[224:227], v[160:163], v[68:71]
    buffer_store_dwordx4 v[56:59], v26, s[76:79], s62 offen offset:0 sc1
    v_mfma_f32_16x16x32_bf16 v[72:75], v[224:227], v[168:171], v[72:75]
    v_mfma_f32_16x16x32_bf16 v[76:79], v[224:227], v[176:179], v[76:79]
    s_waitcnt lgkmcnt(3)
    v_mfma_f32_16x16x32_bf16 v[64:67], v[96:99], v[232:235], v[64:67]
    ds_read_b128 v[252:255], v7 offset:1600
    v_mfma_f32_16x16x32_bf16 v[68:71], v[128:131], v[232:235], v[68:71]
    v_mfma_f32_16x16x32_bf16 v[76:79], v[228:231], v[180:183], v[76:79]
    v_mfma_f32_16x16x32_bf16 v[80:83], v[228:231], v[184:187], v[80:83]
    v_mfma_f32_16x16x32_bf16 v[84:87], v[228:231], v[188:191], v[84:87]
    v_mfma_f32_16x16x32_bf16 v[64:67], v[92:95], v[236:239], v[64:67]
    ds_read_b128 v[16:19], v7 offset:1664
    v_mfma_f32_16x16x32_bf16 v[68:71], v[124:127], v[236:239], v[68:71]
    s_waitcnt lgkmcnt(3)
    v_mfma_f32_16x16x32_bf16 v[196:199], v[240:243], v[28:31], 0
    ds_read_b128 v[20:23], v7 offset:1728
    v_mfma_f32_16x16x32_bf16 v[200:203], v[240:243], v[32:35], 0
    v_mfma_f32_16x16x32_bf16 v[204:207], v[240:243], v[36:39], 0
    v_mfma_f32_16x16x32_bf16 v[212:215], v[240:243], v[44:47], 0
    v_mfma_f32_16x16x32_bf16 v[80:83], v[12:15], v[240:243], v[80:83]
    v_mfma_f32_16x16x32_bf16 v[64:67], v[88:91], v[240:243], v[64:67]
    v_mfma_f32_16x16x32_bf16 v[68:71], v[120:123], v[240:243], v[68:71]
    v_mfma_f32_16x16x32_bf16 v[72:75], v[152:155], v[240:243], v[72:75]
    v_mfma_f32_16x16x32_bf16 v[208:211], v[244:247], v[40:43], 0
    ds_read_b128 v[232:235], v7 offset:1792
    v_mfma_f32_16x16x32_bf16 v[216:219], v[244:247], v[48:51], 0
    s_waitcnt lgkmcnt(3)
    v_mfma_f32_16x16x32_bf16 v[68:71], v[116:119], v[248:251], v[68:71]
    ds_read_b128 v[236:239], v7 offset:1856
    v_mfma_f32_16x16x32_bf16 v[72:75], v[148:151], v[248:251], v[72:75]
    v_mfma_f32_16x16x32_bf16 v[68:71], v[112:115], v[252:255], v[68:71]
    ds_read_b128 v[240:243], v7 offset:1920
    v_cvt_pk_bf16_f32 v220, v196, v200
    v_mfma_f32_16x16x32_bf16 v[72:75], v[144:147], v[252:255], v[72:75]
    v_cvt_pk_bf16_f32 v221, v197, v201
    v_cvt_pk_bf16_f32 v222, v198, v202
    s_waitcnt lgkmcnt(3)
    v_mfma_f32_16x16x32_bf16 v[68:71], v[108:111], v[16:19], v[68:71]
    ds_read_b128 v[244:247], v7 offset:1984
    v_cvt_pk_bf16_f32 v223, v199, v203
    v_mfma_f32_16x16x32_bf16 v[72:75], v[140:143], v[16:19], v[72:75]
    v_cvt_pk_bf16_f32 v224, v204, v208
    v_cvt_pk_bf16_f32 v225, v205, v209
    v_mfma_f32_16x16x32_bf16 v[68:71], v[104:107], v[20:23], v[68:71]
    ds_read_b128 v[248:251], v7 offset:1968
    v_cvt_pk_bf16_f32 v226, v206, v210
    v_mfma_f32_16x16x32_bf16 v[72:75], v[136:139], v[20:23], v[72:75]
    v_cvt_pk_bf16_f32 v227, v207, v211
    v_cvt_pk_bf16_f32 v228, v212, v216
    v_mfma_f32_16x16x32_bf16 v[72:75], v[220:223], v[156:159], v[72:75]
    v_cvt_pk_bf16_f32 v229, v213, v217
    v_cvt_pk_bf16_f32 v230, v214, v218
    v_mfma_f32_16x16x32_bf16 v[76:79], v[220:223], v[164:167], v[76:79]
    v_cvt_pk_bf16_f32 v231, v215, v219
    v_mfma_f32_16x16x32_bf16 v[80:83], v[220:223], v[172:175], v[80:83]
    s_waitcnt lgkmcnt(3)
    v_mfma_f32_16x16x32_bf16 v[68:71], v[100:103], v[232:235], v[68:71]
    ds_read_b128 v[252:255], v7 offset:2048
    v_mfma_f32_16x16x32_bf16 v[72:75], v[132:135], v[232:235], v[72:75]
    v_mfma_f32_16x16x32_bf16 v[72:75], v[224:227], v[160:163], v[72:75]
    v_mfma_f32_16x16x32_bf16 v[76:79], v[224:227], v[168:171], v[76:79]
    v_mfma_f32_16x16x32_bf16 v[80:83], v[224:227], v[176:179], v[80:83]
    v_mfma_f32_16x16x32_bf16 v[68:71], v[96:99], v[236:239], v[68:71]
    ds_read_b128 v[16:19], v7 offset:2112
    v_mfma_f32_16x16x32_bf16 v[72:75], v[128:131], v[236:239], v[72:75]
    v_mfma_f32_16x16x32_bf16 v[80:83], v[228:231], v[180:183], v[80:83]
    v_mfma_f32_16x16x32_bf16 v[84:87], v[228:231], v[184:187], v[84:87]
    s_waitcnt lgkmcnt(3)
    v_mfma_f32_16x16x32_bf16 v[68:71], v[92:95], v[240:243], v[68:71]
    ds_read_b128 v[20:23], v7 offset:2176
    v_mfma_f32_16x16x32_bf16 v[72:75], v[124:127], v[240:243], v[72:75]
    v_mfma_f32_16x16x32_bf16 v[196:199], v[244:247], v[28:31], 0
    ds_read_b128 v[232:235], v7 offset:2240
    v_mfma_f32_16x16x32_bf16 v[200:203], v[244:247], v[32:35], 0
    v_mfma_f32_16x16x32_bf16 v[204:207], v[244:247], v[36:39], 0
    v_mfma_f32_16x16x32_bf16 v[212:215], v[244:247], v[44:47], 0
    v_mfma_f32_16x16x32_bf16 v[84:87], v[12:15], v[244:247], v[84:87]
    v_mfma_f32_16x16x32_bf16 v[68:71], v[88:91], v[244:247], v[68:71]
    v_mfma_f32_16x16x32_bf16 v[72:75], v[120:123], v[244:247], v[72:75]
    v_mfma_f32_16x16x32_bf16 v[76:79], v[152:155], v[244:247], v[76:79]
    s_waitcnt lgkmcnt(3)
    v_mfma_f32_16x16x32_bf16 v[208:211], v[248:251], v[40:43], 0
    ds_read_b128 v[236:239], v7 offset:2304
    v_mfma_f32_16x16x32_bf16 v[216:219], v[248:251], v[48:51], 0
    v_mfma_f32_16x16x32_bf16 v[72:75], v[116:119], v[252:255], v[72:75]
    ds_read_b128 v[240:243], v7 offset:2368
    v_mfma_f32_16x16x32_bf16 v[76:79], v[148:151], v[252:255], v[76:79]
    s_waitcnt lgkmcnt(3)
    v_mfma_f32_16x16x32_bf16 v[72:75], v[112:115], v[16:19], v[72:75]
    ds_read_b128 v[244:247], v7 offset:2432
    v_cvt_pk_bf16_f32 v220, v196, v200
    v_mfma_f32_16x16x32_bf16 v[76:79], v[144:147], v[16:19], v[76:79]
    v_cvt_pk_bf16_f32 v221, v197, v201
    v_cvt_pk_bf16_f32 v222, v198, v202
    v_mfma_f32_16x16x32_bf16 v[72:75], v[108:111], v[20:23], v[72:75]
    ds_read_b128 v[248:251], v7 offset:2496
    v_cvt_pk_bf16_f32 v223, v199, v203
    v_mfma_f32_16x16x32_bf16 v[76:79], v[140:143], v[20:23], v[76:79]
    ds_read_u16 v11, v9 offset:2690
    v_cvt_pk_bf16_f32 v64, v64, v65
    s_waitcnt lgkmcnt(4)
    v_mfma_f32_16x16x32_bf16 v[72:75], v[104:107], v[232:235], v[72:75]
    ds_read_b128 v[252:255], v7 offset:2480
    v_cvt_pk_bf16_f32 v65, v66, v67
    v_mfma_f32_16x16x32_bf16 v[76:79], v[136:139], v[232:235], v[76:79]
    v_cvt_pk_bf16_f32 v66, v68, v69
    v_cvt_pk_bf16_f32 v67, v70, v71
    v_mfma_f32_16x16x32_bf16 v[76:79], v[220:223], v[156:159], v[76:79]
    v_cvt_pk_bf16_f32 v224, v204, v208
    v_cvt_pk_bf16_f32 v225, v205, v209
    v_mfma_f32_16x16x32_bf16 v[80:83], v[220:223], v[164:167], v[80:83]
    v_cvt_pk_bf16_f32 v226, v206, v210
    v_cvt_pk_bf16_f32 v227, v207, v211
    v_mfma_f32_16x16x32_bf16 v[84:87], v[220:223], v[172:175], v[84:87]
    v_cvt_pk_bf16_f32 v228, v212, v216
    v_cvt_pk_bf16_f32 v229, v213, v217
    v_mfma_f32_16x16x32_bf16 v[72:75], v[100:103], v[236:239], v[72:75]
    ds_read_b128 v[16:19], v7 offset:2560
    v_cvt_pk_bf16_f32 v230, v214, v218
    v_mfma_f32_16x16x32_bf16 v[76:79], v[132:135], v[236:239], v[76:79]
    v_cvt_pk_bf16_f32 v231, v215, v219
    v_permlane16_swap_b32 v64, v66
    v_mfma_f32_16x16x32_bf16 v[76:79], v[224:227], v[160:163], v[76:79]
    v_permlane16_swap_b32 v65, v67
    s_waitcnt lgkmcnt(2)
    v_lshl_or_b32 v11, v11, 16, v11
    v_mfma_f32_16x16x32_bf16 v[80:83], v[224:227], v[168:171], v[80:83]
    v_and_b32 v12, v52, v11
    v_and_b32_e64 v13, v53, v11
    v_mfma_f32_16x16x32_bf16 v[84:87], v[224:227], v[176:179], v[84:87]
    v_and_b32 v14, v54, v11
    v_and_b32 v15, v55, v11
    v_mfma_f32_16x16x32_bf16 v[72:75], v[96:99], v[240:243], v[72:75]
    ds_read_b128 v[20:23], v7 offset:2624
    buffer_store_dwordx4 v[64:67], v26, s[76:79], s62 offen offset:1024 sc1
    v_mfma_f32_16x16x32_bf16 v[76:79], v[128:131], v[240:243], v[76:79]
    v_mfma_f32_16x16x32_bf16 v[84:87], v[228:231], v[180:183], v[84:87]
    v_mfma_f32_16x16x32_bf16 v[72:75], v[92:95], v[244:247], v[72:75]
    ds_read_b128 v[232:235], v7 offset:2688
    v_mfma_f32_16x16x32_bf16 v[76:79], v[124:127], v[244:247], v[76:79]
    v_mfma_f32_16x16x32_bf16 v[196:199], v[248:251], v[28:31], 0
    ds_read_b128 v[236:239], v7 offset:2752
    v_mfma_f32_16x16x32_bf16 v[200:203], v[248:251], v[32:35], 0
    v_mfma_f32_16x16x32_bf16 v[204:207], v[248:251], v[36:39], 0
    v_mfma_f32_16x16x32_bf16 v[72:75], v[88:91], v[248:251], v[72:75]
    v_mfma_f32_16x16x32_bf16 v[76:79], v[120:123], v[248:251], v[76:79]
    v_mfma_f32_16x16x32_bf16 v[80:83], v[152:155], v[248:251], v[80:83]
    s_waitcnt lgkmcnt(3)
    v_mfma_f32_16x16x32_bf16 v[208:211], v[252:255], v[40:43], 0
    ds_read_b128 v[240:243], v7 offset:2816
    v_mfma_f32_16x16x32_bf16 v[76:79], v[116:119], v[16:19], v[76:79]
    ds_read_b128 v[244:247], v7 offset:2880
    v_mfma_f32_16x16x32_bf16 v[80:83], v[148:151], v[16:19], v[80:83]
    s_waitcnt lgkmcnt(3)
    v_mfma_f32_16x16x32_bf16 v[76:79], v[112:115], v[20:23], v[76:79]
    ds_read_b128 v[248:251], v7 offset:2944
    ds_read2_b32 v[180:181], v8 offset0:176 offset1:177
    v_mfma_f32_16x16x32_bf16 v[80:83], v[144:147], v[20:23], v[80:83]
    ds_read2_b32 v[182:183], v8 offset0:178 offset1:179
    ds_read2_b32 v[184:185], v8 offset0:160 offset1:161
    v_mfma_f32_16x16x32_bf16 v[76:79], v[108:111], v[232:235], v[76:79]
    ds_read_b128 v[252:255], v7 offset:3008
    ds_read2_b32 v[186:187], v8 offset0:162 offset1:163
    v_mfma_f32_16x16x32_bf16 v[80:83], v[140:143], v[232:235], v[80:83]
    v_cvt_pk_bf16_f32 v220, v196, v200
    v_cvt_pk_bf16_f32 v221, v197, v201
    s_waitcnt lgkmcnt(7)
    v_mfma_f32_16x16x32_bf16 v[76:79], v[104:107], v[236:239], v[76:79]
    ds_read_b128 v[16:19], v7 offset:2992
    v_cvt_pk_bf16_f32 v222, v198, v202
    v_mfma_f32_16x16x32_bf16 v[80:83], v[136:139], v[236:239], v[80:83]
    v_cvt_pk_bf16_f32 v223, v199, v203
    v_cvt_pk_bf16_f32 v224, v204, v208
    s_nop 0
    v_mfma_f32_16x16x32_bf16 v[80:83], v[220:223], v[156:159], v[80:83]
    v_cvt_pk_bf16_f32 v225, v205, v209
    v_cvt_pk_bf16_f32 v226, v206, v210
    v_mfma_f32_16x16x32_bf16 v[84:87], v[220:223], v[164:167], v[84:87]
    v_cvt_pk_bf16_f32 v227, v207, v211
    ds_read2_b32 v[188:189], v8 offset0:144 offset1:145
    v_mfma_f32_16x16x32_bf16 v[76:79], v[100:103], v[240:243], v[76:79]
    ds_read_b128 v[20:23], v7 offset:3072
    ds_read2_b32 v[190:191], v8 offset0:146 offset1:147
    v_mfma_f32_16x16x32_bf16 v[80:83], v[132:135], v[240:243], v[80:83]
    ds_read2_b32 v[192:193], v8 offset0:128 offset1:129
    ds_read2_b32 v[194:195], v8 offset0:130 offset1:131
    v_mfma_f32_16x16x32_bf16 v[80:83], v[224:227], v[160:163], v[80:83]
    ds_read2_b32 v[172:173], v8 offset0:0 offset1:1
    ds_read2_b32 v[174:175], v8 offset0:2 offset1:3
    v_mfma_f32_16x16x32_bf16 v[84:87], v[224:227], v[168:171], v[84:87]
    ds_read2_b32 v[176:177], v8 offset0:64 offset1:65
    ds_read2_b32 v[178:179], v8 offset0:66 offset1:67
    s_waitcnt lgkmcnt(15)
    v_mfma_f32_16x16x32_bf16 v[76:79], v[96:99], v[244:247], v[76:79]
    ds_read_b128 v[232:235], v7 offset:3136
    v_mfma_f32_16x16x32_bf16 v[80:83], v[128:131], v[244:247], v[80:83]
    v_mfma_f32_16x16x32_bf16 v[76:79], v[92:95], v[248:251], v[76:79]
    ds_read_b128 v[236:239], v7 offset:3200
    v_mfma_f32_16x16x32_bf16 v[80:83], v[124:127], v[248:251], v[80:83]
    s_waitcnt lgkmcnt(11)
    v_mfma_f32_16x16x32_bf16 v[196:199], v[252:255], v[28:31], 0
    ds_read_b128 v[240:243], v7 offset:3264
    ds_read2_b32 v[164:165], v8 offset0:16 offset1:17
    v_mfma_f32_16x16x32_bf16 v[200:203], v[252:255], v[32:35], 0
    ds_read2_b32 v[166:167], v8 offset0:18 offset1:19
    ds_read2_b32 v[168:169], v8 offset0:80 offset1:81
    v_mfma_f32_16x16x32_bf16 v[204:207], v[252:255], v[36:39], 0
    ds_read2_b32 v[170:171], v8 offset0:82 offset1:83
    v_mfma_f32_16x16x32_bf16 v[76:79], v[88:91], v[252:255], v[76:79]
    v_mfma_f32_16x16x32_bf16 v[80:83], v[120:123], v[252:255], v[80:83]
    v_mfma_f32_16x16x32_bf16 v[84:87], v[152:155], v[252:255], v[84:87]
    v_mfma_f32_16x16x32_bf16 v[208:211], v[16:19], v[40:43], 0
    ds_read_b128 v[244:247], v7 offset:3328
    ds_read2_b32 v[152:153], v5 offset0:0 offset1:1
    s_waitcnt lgkmcnt(8)
    v_mfma_f32_16x16x32_bf16 v[80:83], v[116:119], v[20:23], v[80:83]
    ds_read_b128 v[248:251], v7 offset:3392
    ds_read2_b32 v[154:155], v5 offset0:2 offset1:3
    v_mfma_f32_16x16x32_bf16 v[84:87], v[148:151], v[20:23], v[84:87]
    v_mfma_f32_16x16x32_bf16 v[80:83], v[112:115], v[232:235], v[80:83]
    ds_read_b128 v[252:255], v7 offset:3456
    ds_read2_b32 v[148:149], v5 offset0:16 offset1:17
    v_mfma_f32_16x16x32_bf16 v[84:87], v[144:147], v[232:235], v[84:87]
    ds_read2_b32 v[150:151], v5 offset0:18 offset1:19
    v_cvt_pk_bf16_f32 v220, v196, v200
    s_waitcnt lgkmcnt(11)
    v_mfma_f32_16x16x32_bf16 v[80:83], v[108:111], v[236:239], v[80:83]
    ds_read_b128 v[16:19], v7 offset:3520
    v_cvt_pk_bf16_f32 v221, v197, v201
    v_mfma_f32_16x16x32_bf16 v[84:87], v[140:143], v[236:239], v[84:87]
    v_cvt_pk_bf16_f32 v222, v198, v202
    v_cvt_pk_bf16_f32 v223, v199, v203
    v_mfma_f32_16x16x32_bf16 v[80:83], v[104:107], v[240:243], v[80:83]
    ds_read_b128 v[20:23], v7 offset:3584
    ds_read2_b32 v[144:145], v5 offset0:32 offset1:33
    v_mfma_f32_16x16x32_bf16 v[84:87], v[136:139], v[240:243], v[84:87]
    ds_read2_b32 v[146:147], v5 offset0:34 offset1:35
    v_cvt_pk_bf16_f32 v72, v72, v73
    v_mfma_f32_16x16x32_bf16 v[84:87], v[220:223], v[156:159], v[84:87]
    v_cvt_pk_bf16_f32 v73, v74, v75
    v_cvt_pk_bf16_f32 v74, v76, v77
    s_waitcnt lgkmcnt(8)
    v_mfma_f32_16x16x32_bf16 v[80:83], v[100:103], v[244:247], v[80:83]
    ds_read_b128 v[232:235], v7 offset:3648
    v_cvt_pk_bf16_f32 v75, v78, v79
    v_mfma_f32_16x16x32_bf16 v[84:87], v[132:135], v[244:247], v[84:87]
    v_cvt_pk_bf16_f32 v224, v204, v208
    v_cvt_pk_bf16_f32 v225, v205, v209
    v_cvt_pk_bf16_f32 v226, v206, v210
    v_cvt_pk_bf16_f32 v227, v207, v211
    s_nop 1
    v_mfma_f32_16x16x32_bf16 v[84:87], v[224:227], v[160:163], v[84:87]
    ds_read2_b32 v[140:141], v5 offset0:48 offset1:49
    ds_read2_b32 v[142:143], v5 offset0:50 offset1:51
    v_mfma_f32_16x16x32_bf16 v[80:83], v[96:99], v[248:251], v[80:83]
    ds_read_b128 v[236:239], v7 offset:3712
    ds_read2_b32 v[136:137], v5 offset0:64 offset1:65
    v_mfma_f32_16x16x32_bf16 v[84:87], v[128:131], v[248:251], v[84:87]
    ds_read2_b32 v[138:139], v5 offset0:66 offset1:67
    v_permlane16_swap_b32 v72, v74
    s_waitcnt lgkmcnt(9)
    v_mfma_f32_16x16x32_bf16 v[80:83], v[92:95], v[252:255], v[80:83]
    ds_read_b128 v[240:243], v7 offset:3776
    v_permlane16_swap_b32 v73, v75
    v_mfma_f32_16x16x32_bf16 v[84:87], v[124:127], v[252:255], v[84:87]
    ds_read2_b32 v[132:133], v5 offset0:80 offset1:81
    ds_read2_b32 v[134:135], v5 offset0:82 offset1:83
    v_mfma_f32_16x16x32_bf16 v[80:83], v[88:91], v[16:19], v[80:83]
    ds_read_b128 v[244:247], v7 offset:3840
    buffer_store_dwordx4 v[72:75], v26, s[76:79], s62 offen offset:2048 sc1
    v_mfma_f32_16x16x32_bf16 v[84:87], v[120:123], v[16:19], v[84:87]
    ds_read2_b32 v[128:129], v5 offset0:96 offset1:97
    ds_read2_b32 v[130:131], v5 offset0:98 offset1:99
    s_waitcnt lgkmcnt(11)
    v_mfma_f32_16x16x32_bf16 v[84:87], v[116:119], v[20:23], v[84:87]
    ds_read_b128 v[248:251], v7 offset:3904
    ds_read2_b32 v[124:125], v5 offset0:112 offset1:113
    v_mfma_f32_16x16x32_bf16 v[84:87], v[112:115], v[232:235], v[84:87]
    ds_read_b128 v[252:255], v7 offset:3968
    ds_read2_b32 v[126:127], v5 offset0:114 offset1:115
    s_waitcnt lgkmcnt(9)
    v_mfma_f32_16x16x32_bf16 v[84:87], v[108:111], v[236:239], v[84:87]
    ds_read_b128 v[16:19], v7 offset:4032
    ds_read2_b32 v[156:157], v8 offset0:32 offset1:33
    v_mfma_f32_16x16x32_bf16 v[84:87], v[104:107], v[240:243], v[84:87]
    ds_read2_b32 v[158:159], v8 offset0:34 offset1:35
    ds_read2_b32 v[160:161], v8 offset0:96 offset1:97
    s_waitcnt lgkmcnt(7)
    v_mfma_f32_16x16x32_bf16 v[84:87], v[100:103], v[244:247], v[84:87]
    ds_read2_b32 v[162:163], v8 offset0:98 offset1:99
    ds_read2_b32 v[120:121], v5 offset0:128 offset1:129
    v_mfma_f32_16x16x32_bf16 v[84:87], v[96:99], v[248:251], v[84:87]
    ds_read2_b32 v[122:123], v5 offset0:130 offset1:131
    ds_read2_b32 v[116:117], v5 offset0:144 offset1:145
    s_waitcnt lgkmcnt(9)
    v_mfma_f32_16x16x32_bf16 v[84:87], v[92:95], v[252:255], v[84:87]
    ds_read2_b32 v[118:119], v5 offset0:146 offset1:147
    ds_read2_b32 v[112:113], v5 offset0:160 offset1:161
    s_waitcnt lgkmcnt(9)
    v_mfma_f32_16x16x32_bf16 v[84:87], v[88:91], v[16:19], v[84:87]
    ds_read2_b32 v[114:115], v5 offset0:162 offset1:163
    ds_read2_b32 v[108:109], v5 offset0:176 offset1:177
    ds_read2_b32 v[110:111], v5 offset0:178 offset1:179
    ds_read2_b32 v[104:105], v5 offset0:192 offset1:193
    ds_read2_b32 v[106:107], v5 offset0:194 offset1:195
    ds_read2_b32 v[100:101], v5 offset0:208 offset1:209
    ds_read2_b32 v[102:103], v5 offset0:210 offset1:211
    ds_read2_b32 v[96:97], v5 offset0:224 offset1:225
    ds_read2_b32 v[98:99], v5 offset0:226 offset1:227
    ds_read2_b32 v[92:93], v5 offset0:240 offset1:241
    ds_read2_b32 v[94:95], v5 offset0:242 offset1:243
    ds_read2_b32 v[88:89], v6 offset0:0 offset1:1
    ds_read2_b32 v[90:91], v6 offset0:2 offset1:3
    v_cvt_pk_bf16_f32 v80, v80, v81
    v_cvt_pk_bf16_f32 v81, v82, v83
    v_cvt_pk_bf16_f32 v82, v84, v85
    v_cvt_pk_bf16_f32 v83, v86, v87
    s_nop 0
    v_permlane16_swap_b32 v80, v82
    v_permlane16_swap_b32 v81, v83
    buffer_store_dwordx4 v[80:83], v26, s[76:79], s62 offen offset:3072 sc1
L_A_skip:
    s_cmp_lt_u32 s49, 24
    s_cbranch_scc1 L_A_R2
    s_mov_b32 s61, s65
    s_mov_b32 s69, s66
    s_add_u32 s70, s66, 4608
    s_and_b32 s4, s48, 1
    s_lshl_b32 s4, s4, 3
    s_add_u32 s4, s4, 149508
    v_mov_b32 v27, s4
    v_mov_b32 v11, 149556
    v_cmp_gt_u32 vcc, 32, v1
    s_nop 1
    v_cndmask_b32 v27, v27, v11, vcc
    s_cmp_lt_u32 s48, 2
    s_cbranch_scc0 L_convH
.p2align 3
L_convL:
    s_mov_b32 s58, 1000000
L_pollUL:
    ds_read_b32 v16, v27
    s_sub_u32 s58, s58, 1
    s_waitcnt lgkmcnt(0)
    s_cbranch_scc1 L_pollUL_done
    v_cmp_ne_u32 vcc, 1, v16
    s_nop 1
    s_cbranch_vccz L_pollUL_done
    s_sleep 2
    s_branch L_pollUL
L_pollUL_done:
    v_add_u32 v7, s69, v25
    s_lshl_b32 s62, s61, 12
    s_add_u32 s62, s62, 6291456
    v_mov_b32_e64 v9, s70
    ds_read_b128 v[232:235], v7 offset:448
    ds_read_b128 v[236:239], v7 offset:432
    ds_read_b128 v[240:243], v7 offset:0
    ds_read_b128 v[244:247], v7 offset:64
    ds_read_b128 v[248:251], v7 offset:128
    s_waitcnt lgkmcnt(3)
    v_mfma_f32_16x16x32_bf16 v[196:199], v[232:235], v[28:31], 0
    ds_read_b128 v[252:255], v7 offset:192
    v_mfma_f32_16x16x32_bf16 v[200:203], v[232:235], v[32:35], 0
    v_mfma_f32_16x16x32_bf16 v[204:207], v[232:235], v[36:39], 0
    v_mfma_f32_16x16x32_bf16 v[212:215], v[232:235], v[44:47], 0
    v_mfma_f32_16x16x32_bf16 v[208:211], v[236:239], v[40:43], 0
    ds_read_b128 v[16:19], v7 offset:256
    v_mfma_f32_16x16x32_bf16 v[216:219], v[236:239], v[48:51], 0
    s_waitcnt lgkmcnt(3)
    v_mfma_f32_16x16x32_bf16 v[56:59], v[116:119], v[240:243], 0
    ds_read_b128 v[20:23], v7 offset:320
    v_mfma_f32_16x16x32_bf16 v[60:63], v[148:151], v[240:243], 0
    v_mfma_f32_16x16x32_bf16 v[56:59], v[112:115], v[244:247], v[56:59]
    ds_read_b128 v[232:235], v7 offset:384
    v_cvt_pk_bf16_f32 v220, v196, v200
    v_mfma_f32_16x16x32_bf16 v[60:63], v[144:147], v[244:247], v[60:63]
    v_cvt_pk_bf16_f32 v221, v197, v201
    v_cvt_pk_bf16_f32 v222, v198, v202
    s_waitcnt lgkmcnt(3)
    v_mfma_f32_16x16x32_bf16 v[56:59], v[108:111], v[248:251], v[56:59]
    ds_read_b128 v[236:239], v7 offset:448
    v_cvt_pk_bf16_f32 v223, v199, v203
    v_mfma_f32_16x16x32_bf16 v[60:63], v[140:143], v[248:251], v[60:63]
    v_cvt_pk_bf16_f32 v224, v204, v208
    v_cvt_pk_bf16_f32 v225, v205, v209
    v_mfma_f32_16x16x32_bf16 v[56:59], v[104:107], v[252:255], v[56:59]
    ds_read_b128 v[240:243], v7 offset:512
    v_cvt_pk_bf16_f32 v226, v206, v210
    v_mfma_f32_16x16x32_bf16 v[60:63], v[136:139], v[252:255], v[60:63]
    v_cvt_pk_bf16_f32 v227, v207, v211
    v_cvt_pk_bf16_f32 v228, v212, v216
    v_mfma_f32_16x16x32_bf16 v[64:67], v[220:223], v[156:159], 0
    v_cvt_pk_bf16_f32 v229, v213, v217
    v_cvt_pk_bf16_f32 v230, v214, v218
    v_mfma_f32_16x16x32_bf16 v[68:71], v[220:223], v[164:167], 0
    v_cvt_pk_bf16_f32 v231, v215, v219
    v_mfma_f32_16x16x32_bf16 v[72:75], v[220:223], v[172:175], 0
    s_waitcnt lgkmcnt(3)
    v_mfma_f32_16x16x32_bf16 v[56:59], v[100:103], v[16:19], v[56:59]
    ds_read_b128 v[244:247], v7 offset:576
    v_mfma_f32_16x16x32_bf16 v[60:63], v[132:135], v[16:19], v[60:63]
    v_mfma_f32_16x16x32_bf16 v[64:67], v[224:227], v[160:163], v[64:67]
    v_mfma_f32_16x16x32_bf16 v[68:71], v[224:227], v[168:171], v[68:71]
    v_mfma_f32_16x16x32_bf16 v[72:75], v[224:227], v[176:179], v[72:75]
    v_mfma_f32_16x16x32_bf16 v[56:59], v[96:99], v[20:23], v[56:59]
    ds_read_b128 v[248:251], v7 offset:640
    v_mfma_f32_16x16x32_bf16 v[60:63], v[128:131], v[20:23], v[60:63]
    v_mfma_f32_16x16x32_bf16 v[72:75], v[228:231], v[180:183], v[72:75]
    s_waitcnt lgkmcnt(3)
    v_mfma_f32_16x16x32_bf16 v[56:59], v[92:95], v[232:235], v[56:59]
    ds_read_b128 v[252:255], v7 offset:704
    v_mfma_f32_16x16x32_bf16 v[60:63], v[124:127], v[232:235], v[60:63]
    v_mfma_f32_16x16x32_bf16 v[72:75], v[12:15], v[236:239], v[72:75]
    ds_read_b128 v[16:19], v7 offset:768
    v_mfma_f32_16x16x32_bf16 v[56:59], v[88:91], v[236:239], v[56:59]
    v_mfma_f32_16x16x32_bf16 v[60:63], v[120:123], v[236:239], v[60:63]
    v_mfma_f32_16x16x32_bf16 v[64:67], v[152:155], v[236:239], v[64:67]
    s_waitcnt lgkmcnt(3)
    v_mfma_f32_16x16x32_bf16 v[60:63], v[116:119], v[240:243], v[60:63]
    ds_read_b128 v[20:23], v7 offset:960
    v_mfma_f32_16x16x32_bf16 v[64:67], v[148:151], v[240:243], v[64:67]
    v_mfma_f32_16x16x32_bf16 v[60:63], v[112:115], v[244:247], v[60:63]
    ds_read_b128 v[232:235], v7 offset:944
    v_mfma_f32_16x16x32_bf16 v[64:67], v[144:147], v[244:247], v[64:67]
    s_waitcnt lgkmcnt(3)
    v_mfma_f32_16x16x32_bf16 v[60:63], v[108:111], v[248:251], v[60:63]
    ds_read_b128 v[236:239], v7 offset:832
    v_mfma_f32_16x16x32_bf16 v[64:67], v[140:143], v[248:251], v[64:67]
    v_mfma_f32_16x16x32_bf16 v[60:63], v[104:107], v[252:255], v[60:63]
    ds_read_b128 v[240:243], v7 offset:896
    v_mfma_f32_16x16x32_bf16 v[64:67], v[136:139], v[252:255], v[64:67]
    s_waitcnt lgkmcnt(3)
    v_mfma_f32_16x16x32_bf16 v[60:63], v[100:103], v[16:19], v[60:63]
    ds_read_b128 v[244:247], v7 offset:960
    v_mfma_f32_16x16x32_bf16 v[64:67], v[132:135], v[16:19], v[64:67]
    v_mfma_f32_16x16x32_bf16 v[196:199], v[20:23], v[28:31], 0
    ds_read_b128 v[248:251], v7 offset:1024
    v_mfma_f32_16x16x32_bf16 v[200:203], v[20:23], v[32:35], 0
    v_mfma_f32_16x16x32_bf16 v[204:207], v[20:23], v[36:39], 0
    s_waitcnt lgkmcnt(3)
    v_mfma_f32_16x16x32_bf16 v[208:211], v[232:235], v[40:43], 0
    ds_read_b128 v[252:255], v7 offset:1088
    v_mfma_f32_16x16x32_bf16 v[60:63], v[96:99], v[236:239], v[60:63]
    ds_read_b128 v[16:19], v7 offset:1152
    v_mfma_f32_16x16x32_bf16 v[64:67], v[128:131], v[236:239], v[64:67]
    s_waitcnt lgkmcnt(3)
    v_mfma_f32_16x16x32_bf16 v[60:63], v[92:95], v[240:243], v[60:63]
    ds_read_b128 v[20:23], v7 offset:1216
    v_cvt_pk_bf16_f32 v220, v196, v200
    v_mfma_f32_16x16x32_bf16 v[64:67], v[124:127], v[240:243], v[64:67]
    v_cvt_pk_bf16_f32 v221, v197, v201
    v_cvt_pk_bf16_f32 v222, v198, v202
    v_mfma_f32_16x16x32_bf16 v[60:63], v[88:91], v[244:247], v[60:63]
    ds_read_b128 v[232:235], v7 offset:1280
    v_cvt_pk_bf16_f32 v223, v199, v203
    v_mfma_f32_16x16x32_bf16 v[64:67], v[120:123], v[244:247], v[64:67]
    v_cvt_pk_bf16_f32 v224, v204, v208
    v_cvt_pk_bf16_f32 v225, v205, v209
    v_mfma_f32_16x16x32_bf16 v[68:71], v[152:155], v[244:247], v[68:71]
    v_cvt_pk_bf16_f32 v226, v206, v210
    v_cvt_pk_bf16_f32 v227, v207, v211
    s_waitcnt lgkmcnt(3)
    v_mfma_f32_16x16x32_bf16 v[64:67], v[116:119], v[248:251], v[64:67]
    ds_read_b128 v[236:239], v7 offset:1344
    v_mfma_f32_16x16x32_bf16 v[68:71], v[148:151], v[248:251], v[68:71]
    v_mfma_f32_16x16x32_bf16 v[68:71], v[220:223], v[156:159], v[68:71]
    v_mfma_f32_16x16x32_bf16 v[72:75], v[220:223], v[164:167], v[72:75]
    v_mfma_f32_16x16x32_bf16 v[64:67], v[112:115], v[252:255], v[64:67]
    ds_read_b128 v[240:243], v7 offset:1408
    v_mfma_f32_16x16x32_bf16 v[68:71], v[144:147], v[252:255], v[68:71]
    v_mfma_f32_16x16x32_bf16 v[68:71], v[224:227], v[160:163], v[68:71]
    v_mfma_f32_16x16x32_bf16 v[72:75], v[224:227], v[168:171], v[72:75]
    s_waitcnt lgkmcnt(3)
    v_mfma_f32_16x16x32_bf16 v[64:67], v[108:111], v[16:19], v[64:67]
    ds_read_b128 v[244:247], v7 offset:1472
    v_cvt_pk_bf16_f32 v56, v56, v57
    v_mfma_f32_16x16x32_bf16 v[68:71], v[140:143], v[16:19], v[68:71]
    v_cvt_pk_bf16_f32 v57, v58, v59
    v_cvt_pk_bf16_f32 v58, v60, v61
    v_mfma_f32_16x16x32_bf16 v[64:67], v[104:107], v[20:23], v[64:67]
    ds_read_b128 v[248:251], v7 offset:1456
    v_cvt_pk_bf16_f32 v59, v62, v63
    v_mfma_f32_16x16x32_bf16 v[68:71], v[136:139], v[20:23], v[68:71]
    s_waitcnt lgkmcnt(3)
    v_mfma_f32_16x16x32_bf16 v[64:67], v[100:103], v[232:235], v[64:67]
    ds_read_b128 v[252:255], v7 offset:1536
    v_permlane16_swap_b32 v56, v58
    v_mfma_f32_16x16x32_bf16 v[68:71], v[132:135], v[232:235], v[68:71]
    v_permlane16_swap_b32 v57, v59
    v_mfma_f32_16x16x32_bf16 v[64:67], v[96:99], v[236:239], v[64:67]
    ds_read_b128 v[16:19], v7 offset:1600
    buffer_store_dwordx4 v[56:59], v26, s[76:79], s62 offen offset:0 sc1
    v_mfma_f32_16x16x32_bf16 v[68:71], v[128:131], v[236:239], v[68:71]
    s_waitcnt lgkmcnt(3)
    v_mfma_f32_16x16x32_bf16 v[64:67], v[92:95], v[240:243], v[64:67]
    ds_read_b128 v[20:23], v7 offset:1664
    v_mfma_f32_16x16x32_bf16 v[68:71], v[124:127], v[240:243], v[68:71]
    v_mfma_f32_16x16x32_bf16 v[196:199], v[244:247], v[28:31], 0
    ds_read_b128 v[232:235], v7 offset:1728
    v_mfma_f32_16x16x32_bf16 v[200:203], v[244:247], v[32:35], 0
    v_mfma_f32_16x16x32_bf16 v[204:207], v[244:247], v[36:39], 0
    v_mfma_f32_16x16x32_bf16 v[64:67], v[88:91], v[244:247], v[64:67]
    v_mfma_f32_16x16x32_bf16 v[68:71], v[120:123], v[244:247], v[68:71]
    v_mfma_f32_16x16x32_bf16 v[72:75], v[152:155], v[244:247], v[72:75]
    s_waitcnt lgkmcnt(3)
    v_mfma_f32_16x16x32_bf16 v[208:211], v[248:251], v[40:43], 0
    ds_read_b128 v[236:239], v7 offset:1792
    v_mfma_f32_16x16x32_bf16 v[68:71], v[116:119], v[252:255], v[68:71]
    ds_read_b128 v[240:243], v7 offset:1856
    v_mfma_f32_16x16x32_bf16 v[72:75], v[148:151], v[252:255], v[72:75]
    s_waitcnt lgkmcnt(3)
    v_mfma_f32_16x16x32_bf16 v[68:71], v[112:115], v[16:19], v[68:71]
    ds_read_b128 v[244:247], v7 offset:1920
    v_cvt_pk_bf16_f32 v220, v196, v200
    v_mfma_f32_16x16x32_bf16 v[72:75], v[144:147], v[16:19], v[72:75]
    v_cvt_pk_bf16_f32 v221, v197, v201
    v_cvt_pk_bf16_f32 v222, v198, v202
    v_mfma_f32_16x16x32_bf16 v[68:71], v[108:111], v[20:23], v[68:71]
    ds_read_b128 v[248:251], v7 offset:1984
    v_cvt_pk_bf16_f32 v223, v199, v203
    v_mfma_f32_16x16x32_bf16 v[72:75], v[140:143], v[20:23], v[72:75]
    v_cvt_pk_bf16_f32 v224, v204, v208
    v_cvt_pk_bf16_f32 v225, v205, v209
    s_waitcnt lgkmcnt(3)
    v_mfma_f32_16x16x32_bf16 v[68:71], v[104:107], v[232:235], v[68:71]
    ds_read_b128 v[252:255], v7 offset:2048
    v_cvt_pk_bf16_f32 v226, v206, v210
    v_mfma_f32_16x16x32_bf16 v[72:75], v[136:139], v[232:235], v[72:75]
    v_cvt_pk_bf16_f32 v227, v207, v211
    v_mfma_f32_16x16x32_bf16 v[72:75], v[220:223], v[156:159], v[72:75]
    v_mfma_f32_16x16x32_bf16 v[68:71], v[100:103], v[236:239], v[68:71]
    ds_read_b128 v[16:19], v7 offset:2112
    v_mfma_f32_16x16x32_bf16 v[72:75], v[132:135], v[236:239], v[72:75]
    v_mfma_f32_16x16x32_bf16 v[72:75], v[224:227], v[160:163], v[72:75]
    s_waitcnt lgkmcnt(3)
    v_mfma_f32_16x16x32_bf16 v[68:71], v[96:99], v[240:243], v[68:71]
    ds_read_b128 v[20:23], v7 offset:2176
    v_mfma_f32_16x16x32_bf16 v[72:75], v[128:131], v[240:243], v[72:75]
    v_mfma_f32_16x16x32_bf16 v[68:71], v[92:95], v[244:247], v[68:71]
    ds_read_b128 v[232:235], v7 offset:2240
    v_mfma_f32_16x16x32_bf16 v[72:75], v[124:127], v[244:247], v[72:75]
    s_waitcnt lgkmcnt(3)
    v_mfma_f32_16x16x32_bf16 v[68:71], v[88:91], v[248:251], v[68:71]
    ds_read_b128 v[236:239], v7 offset:2304
    v_mfma_f32_16x16x32_bf16 v[72:75], v[120:123], v[248:251], v[72:75]
    v_mfma_f32_16x16x32_bf16 v[72:75], v[116:119], v[252:255], v[72:75]
    ds_read_b128 v[240:243], v7 offset:2368
    s_waitcnt lgkmcnt(3)
    v_mfma_f32_16x16x32_bf16 v[72:75], v[112:115], v[16:19], v[72:75]
    ds_read_b128 v[244:247], v7 offset:2432
    v_mfma_f32_16x16x32_bf16 v[72:75], v[108:111], v[20:23], v[72:75]
    ds_read_b128 v[248:251], v7 offset:2496
    v_cvt_pk_bf16_f32 v64, v64, v65
    s_waitcnt lgkmcnt(3)
    v_mfma_f32_16x16x32_bf16 v[72:75], v[104:107], v[232:235], v[72:75]
    v_cvt_pk_bf16_f32 v65, v66, v67
    v_cvt_pk_bf16_f32 v66, v68, v69
    v_mfma_f32_16x16x32_bf16 v[72:75], v[100:103], v[236:239], v[72:75]
    v_cvt_pk_bf16_f32 v67, v70, v71
    v_permlane16_swap_b32 v64, v66
    s_waitcnt lgkmcnt(2)
    v_mfma_f32_16x16x32_bf16 v[72:75], v[96:99], v[240:243], v[72:75]
    v_permlane16_swap_b32 v65, v67
    buffer_store_dwordx4 v[64:67], v26, s[76:79], s62 offen offset:1024 sc1
    s_waitcnt lgkmcnt(1)
    v_mfma_f32_16x16x32_bf16 v[72:75], v[92:95], v[244:247], v[72:75]
    s_waitcnt lgkmcnt(0)
    v_mfma_f32_16x16x32_bf16 v[72:75], v[88:91], v[248:251], v[72:75]
    s_nop 7
    v_cvt_pk_bf16_f32 v72, v72, v73
    v_cvt_pk_bf16_f32 v73, v74, v75
    v_mov_b32 v74, v72
    v_mov_b32_e64 v75, v73
    s_nop 0
    v_permlane16_swap_b32 v72, v74
    v_permlane16_swap_b32 v73, v75
    s_mov_b64 exec, s[74:75]
    buffer_store_dwordx4 v[72:75], v26, s[76:79], s62 offen offset:2048 sc1
    s_mov_b64 exec, -1
    s_branch L_A_last
.p2align 3
L_convH:
    s_mov_b32 s58, 1000000
L_pollUH:
    ds_read_b32 v16, v27
    s_sub_u32 s58, s58, 1
    s_waitcnt lgkmcnt(0)
    s_cbranch_scc1 L_pollUH_done
    v_cmp_ne_u32 vcc, 1, v16
    s_nop 1
    s_cbranch_vccz L_pollUH_done
    s_sleep 2
    s_branch L_pollUH
L_pollUH_done:
    v_add_u32 v7, s69, v25
    s_lshl_b32 s62, s61, 12
    s_add_u32 s62, s62, 6291456
    v_mov_b32_e64 v9, s70
    ds_read_b128 v[232:235], v7 offset:448
    ds_read_b128 v[236:239], v7 offset:432
    ds_read_b128 v[240:243], v7 offset:1984
    ds_read_b128 v[244:247], v7 offset:2048
    ds_read_b128 v[248:251], v7 offset:2112
    s_waitcnt lgkmcnt(3)
    v_mfma_f32_16x16x32_bf16 v[212:215], v[232:235], v[44:47], 0
    ds_read_b128 v[252:255], v7 offset:2176
    v_mfma_f32_16x16x32_bf16 v[216:219], v[236:239], v[48:51], 0
    ds_read_b128 v[16:19], v7 offset:2240
    s_waitcnt lgkmcnt(3)
    v_mfma_f32_16x16x32_bf16 v[76:79], v[152:155], v[240:243], 0
    ds_read_b128 v[20:23], v7 offset:2304
    v_mfma_f32_16x16x32_bf16 v[76:79], v[148:151], v[244:247], v[76:79]
    ds_read_b128 v[232:235], v7 offset:2368
    s_waitcnt lgkmcnt(3)
    v_mfma_f32_16x16x32_bf16 v[76:79], v[144:147], v[248:251], v[76:79]
    ds_read_b128 v[236:239], v7 offset:2432
    v_mfma_f32_16x16x32_bf16 v[76:79], v[140:143], v[252:255], v[76:79]
    ds_read_b128 v[240:243], v7 offset:960
    v_cvt_pk_bf16_f32 v228, v212, v216
    s_waitcnt lgkmcnt(3)
    v_mfma_f32_16x16x32_bf16 v[76:79], v[136:139], v[16:19], v[76:79]
    ds_read_b128 v[244:247], v7 offset:944
    v_cvt_pk_bf16_f32 v229, v213, v217
    v_cvt_pk_bf16_f32 v230, v214, v218
    v_cvt_pk_bf16_f32 v231, v215, v219
    s_nop 1
    v_mfma_f32_16x16x32_bf16 v[76:79], v[228:231], v[184:187], v[76:79]
    v_mfma_f32_16x16x32_bf16 v[80:83], v[228:231], v[188:191], 0
    v_mfma_f32_16x16x32_bf16 v[84:87], v[228:231], v[192:195], 0
    v_mfma_f32_16x16x32_bf16 v[76:79], v[132:135], v[20:23], v[76:79]
    ds_read_b128 v[248:251], v7 offset:2496
    s_waitcnt lgkmcnt(3)
    v_mfma_f32_16x16x32_bf16 v[76:79], v[128:131], v[232:235], v[76:79]
    ds_read_b128 v[252:255], v7 offset:2560
    v_mfma_f32_16x16x32_bf16 v[76:79], v[124:127], v[236:239], v[76:79]
    ds_read_b128 v[16:19], v7 offset:2624
    s_waitcnt lgkmcnt(3)
    v_mfma_f32_16x16x32_bf16 v[196:199], v[240:243], v[28:31], 0
    ds_read_b128 v[20:23], v7 offset:2688
    v_mfma_f32_16x16x32_bf16 v[200:203], v[240:243], v[32:35], 0
    v_mfma_f32_16x16x32_bf16 v[204:207], v[240:243], v[36:39], 0
    v_mfma_f32_16x16x32_bf16 v[212:215], v[240:243], v[44:47], 0
    v_mfma_f32_16x16x32_bf16 v[76:79], v[12:15], v[240:243], v[76:79]
    v_mfma_f32_16x16x32_bf16 v[208:211], v[244:247], v[40:43], 0
    ds_read_b128 v[232:235], v7 offset:2752
    v_mfma_f32_16x16x32_bf16 v[216:219], v[244:247], v[48:51], 0
    s_waitcnt lgkmcnt(3)
    v_mfma_f32_16x16x32_bf16 v[76:79], v[120:123], v[248:251], v[76:79]
    ds_read_b128 v[236:239], v7 offset:1472
    v_mfma_f32_16x16x32_bf16 v[80:83], v[152:155], v[248:251], v[80:83]
    v_mfma_f32_16x16x32_bf16 v[76:79], v[116:119], v[252:255], v[76:79]
    ds_read_b128 v[240:243], v7 offset:1456
    v_cvt_pk_bf16_f32 v220, v196, v200
    v_mfma_f32_16x16x32_bf16 v[80:83], v[148:151], v[252:255], v[80:83]
    v_cvt_pk_bf16_f32 v221, v197, v201
    v_cvt_pk_bf16_f32 v222, v198, v202
    s_waitcnt lgkmcnt(3)
    v_mfma_f32_16x16x32_bf16 v[76:79], v[112:115], v[16:19], v[76:79]
    ds_read_b128 v[244:247], v7 offset:2816
    v_cvt_pk_bf16_f32 v223, v199, v203
    v_mfma_f32_16x16x32_bf16 v[80:83], v[144:147], v[16:19], v[80:83]
    v_cvt_pk_bf16_f32 v224, v204, v208
    v_cvt_pk_bf16_f32 v225, v205, v209
    v_mfma_f32_16x16x32_bf16 v[76:79], v[220:223], v[172:175], v[76:79]
    v_cvt_pk_bf16_f32 v226, v206, v210
    v_cvt_pk_bf16_f32 v227, v207, v211
    v_mfma_f32_16x16x32_bf16 v[76:79], v[108:111], v[20:23], v[76:79]
    ds_read_b128 v[248:251], v7 offset:2880
    v_cvt_pk_bf16_f32 v228, v212, v216
    v_mfma_f32_16x16x32_bf16 v[80:83], v[140:143], v[20:23], v[80:83]
    v_cvt_pk_bf16_f32 v229, v213, v217
    v_cvt_pk_bf16_f32 v230, v214, v218
    v_mfma_f32_16x16x32_bf16 v[76:79], v[224:227], v[176:179], v[76:79]
    v_cvt_pk_bf16_f32 v231, v215, v219
    s_waitcnt lgkmcnt(3)
    v_mfma_f32_16x16x32_bf16 v[76:79], v[104:107], v[232:235], v[76:79]
    ds_read_b128 v[252:255], v7 offset:2944
    v_mfma_f32_16x16x32_bf16 v[80:83], v[136:139], v[232:235], v[80:83]
    v_mfma_f32_16x16x32_bf16 v[76:79], v[228:231], v[180:183], v[76:79]
    v_mfma_f32_16x16x32_bf16 v[80:83], v[228:231], v[184:187], v[80:83]
    v_mfma_f32_16x16x32_bf16 v[84:87], v[228:231], v[188:191], v[84:87]
    v_mfma_f32_16x16x32_bf16 v[196:199], v[236:239], v[28:31], 0
    ds_read_b128 v[16:19], v7 offset:3008
    v_mfma_f32_16x16x32_bf16 v[200:203], v[236:239], v[32:35], 0
    v_mfma_f32_16x16x32_bf16 v[204:207], v[236:239], v[36:39], 0
    v_mfma_f32_16x16x32_bf16 v[212:215], v[236:239], v[44:47], 0
    v_mfma_f32_16x16x32_bf16 v[80:83], v[12:15], v[236:239], v[80:83]
    s_waitcnt lgkmcnt(3)
    v_mfma_f32_16x16x32_bf16 v[208:211], v[240:243], v[40:43], 0
    ds_read_b128 v[20:23], v7 offset:3072
    v_mfma_f32_16x16x32_bf16 v[216:219], v[240:243], v[48:51], 0
    v_mfma_f32_16x16x32_bf16 v[76:79], v[100:103], v[244:247], v[76:79]
    ds_read_b128 v[232:235], v7 offset:1984
    v_mfma_f32_16x16x32_bf16 v[80:83], v[132:135], v[244:247], v[80:83]
    s_waitcnt lgkmcnt(3)
    v_mfma_f32_16x16x32_bf16 v[76:79], v[96:99], v[248:251], v[76:79]
    ds_read_b128 v[236:239], v7 offset:1968
    v_cvt_pk_bf16_f32 v220, v196, v200
    v_mfma_f32_16x16x32_bf16 v[80:83], v[128:131], v[248:251], v[80:83]
    v_cvt_pk_bf16_f32 v221, v197, v201
    v_cvt_pk_bf16_f32 v222, v198, v202
    v_mfma_f32_16x16x32_bf16 v[76:79], v[92:95], v[252:255], v[76:79]
    ds_read_b128 v[240:243], v7 offset:3136
    v_cvt_pk_bf16_f32 v223, v199, v203
    v_mfma_f32_16x16x32_bf16 v[80:83], v[124:127], v[252:255], v[80:83]
    v_cvt_pk_bf16_f32 v224, v204, v208
    v_cvt_pk_bf16_f32 v225, v205, v209
    v_mfma_f32_16x16x32_bf16 v[76:79], v[220:223], v[164:167], v[76:79]
    v_cvt_pk_bf16_f32 v226, v206, v210
    v_cvt_pk_bf16_f32 v227, v207, v211
    v_mfma_f32_16x16x32_bf16 v[80:83], v[220:223], v[172:175], v[80:83]
    s_waitcnt lgkmcnt(3)
    v_mfma_f32_16x16x32_bf16 v[76:79], v[88:91], v[16:19], v[76:79]
    ds_read_b128 v[244:247], v7 offset:3200
    v_cvt_pk_bf16_f32 v228, v212, v216
    v_mfma_f32_16x16x32_bf16 v[80:83], v[120:123], v[16:19], v[80:83]
    v_cvt_pk_bf16_f32 v229, v213, v217
    v_cvt_pk_bf16_f32 v230, v214, v218
    v_mfma_f32_16x16x32_bf16 v[84:87], v[152:155], v[16:19], v[84:87]
    v_cvt_pk_bf16_f32 v231, v215, v219
    v_mfma_f32_16x16x32_bf16 v[76:79], v[224:227], v[168:171], v[76:79]
    v_mfma_f32_16x16x32_bf16 v[80:83], v[224:227], v[176:179], v[80:83]
    v_mfma_f32_16x16x32_bf16 v[80:83], v[116:119], v[20:23], v[80:83]
    ds_read_b128 v[248:251], v7 offset:3264
    v_mfma_f32_16x16x32_bf16 v[84:87], v[148:151], v[20:23], v[84:87]
    v_mfma_f32_16x16x32_bf16 v[80:83], v[228:231], v[180:183], v[80:83]
    v_mfma_f32_16x16x32_bf16 v[84:87], v[228:231], v[184:187], v[84:87]
    s_waitcnt lgkmcnt(3)
    v_mfma_f32_16x16x32_bf16 v[196:199], v[232:235], v[28:31], 0
    ds_read_b128 v[252:255], v7 offset:3328
    v_mfma_f32_16x16x32_bf16 v[200:203], v[232:235], v[32:35], 0
    v_mfma_f32_16x16x32_bf16 v[204:207], v[232:235], v[36:39], 0
    v_mfma_f32_16x16x32_bf16 v[212:215], v[232:235], v[44:47], 0
    v_mfma_f32_16x16x32_bf16 v[84:87], v[12:15], v[232:235], v[84:87]
    v_mfma_f32_16x16x32_bf16 v[208:211], v[236:239], v[40:43], 0
    ds_read_b128 v[16:19], v7 offset:3392
    v_mfma_f32_16x16x32_bf16 v[216:219], v[236:239], v[48:51], 0
    s_waitcnt lgkmcnt(3)
    v_mfma_f32_16x16x32_bf16 v[80:83], v[112:115], v[240:243], v[80:83]
    ds_read_b128 v[20:23], v7 offset:2496
    v_mfma_f32_16x16x32_bf16 v[84:87], v[144:147], v[240:243], v[84:87]
    v_mfma_f32_16x16x32_bf16 v[80:83], v[108:111], v[244:247], v[80:83]
    ds_read_b128 v[232:235], v7 offset:2480
    v_cvt_pk_bf16_f32 v220, v196, v200
    v_mfma_f32_16x16x32_bf16 v[84:87], v[140:143], v[244:247], v[84:87]
    v_cvt_pk_bf16_f32 v221, v197, v201
    v_cvt_pk_bf16_f32 v222, v198, v202
    s_waitcnt lgkmcnt(3)
    v_mfma_f32_16x16x32_bf16 v[80:83], v[104:107], v[248:251], v[80:83]
    ds_read_b128 v[236:239], v7 offset:3456
    v_cvt_pk_bf16_f32 v223, v199, v203
    v_mfma_f32_16x16x32_bf16 v[84:87], v[136:139], v[248:251], v[84:87]
    v_cvt_pk_bf16_f32 v224, v204, v208
    v_cvt_pk_bf16_f32 v225, v205, v209
    v_mfma_f32_16x16x32_bf16 v[76:79], v[220:223], v[156:159], v[76:79]
    v_cvt_pk_bf16_f32 v226, v206, v210
    v_cvt_pk_bf16_f32 v227, v207, v211
    v_mfma_f32_16x16x32_bf16 v[80:83], v[220:223], v[164:167], v[80:83]
    v_mfma_f32_16x16x32_bf16 v[84:87], v[220:223], v[172:175], v[84:87]
    v_mfma_f32_16x16x32_bf16 v[80:83], v[100:103], v[252:255], v[80:83]
    ds_read_b128 v[240:243], v7 offset:3520
    v_cvt_pk_bf16_f32 v228, v212, v216
    v_mfma_f32_16x16x32_bf16 v[84:87], v[132:135], v[252:255], v[84:87]
    v_cvt_pk_bf16_f32 v229, v213, v217
    v_cvt_pk_bf16_f32 v230, v214, v218
    v_mfma_f32_16x16x32_bf16 v[76:79], v[224:227], v[160:163], v[76:79]
    v_cvt_pk_bf16_f32 v231, v215, v219
    v_mfma_f32_16x16x32_bf16 v[80:83], v[224:227], v[168:171], v[80:83]
    v_mfma_f32_16x16x32_bf16 v[84:87], v[224:227], v[176:179], v[84:87]
    s_waitcnt lgkmcnt(3)
    v_mfma_f32_16x16x32_bf16 v[80:83], v[96:99], v[16:19], v[80:83]
    ds_read_b128 v[244:247], v7 offset:3584
    v_mfma_f32_16x16x32_bf16 v[84:87], v[128:131], v[16:19], v[84:87]
    v_mfma_f32_16x16x32_bf16 v[84:87], v[228:231], v[180:183], v[84:87]
    v_mfma_f32_16x16x32_bf16 v[196:199], v[20:23], v[28:31], 0
    ds_read_b128 v[248:251], v7 offset:3648
    v_mfma_f32_16x16x32_bf16 v[200:203], v[20:23], v[32:35], 0
    v_mfma_f32_16x16x32_bf16 v[204:207], v[20:23], v[36:39], 0
    s_waitcnt lgkmcnt(3)
    v_mfma_f32_16x16x32_bf16 v[208:211], v[232:235], v[40:43], 0
    ds_read_b128 v[252:255], v7 offset:3712
    v_mfma_f32_16x16x32_bf16 v[80:83], v[92:95], v[236:239], v[80:83]
    ds_read_b128 v[16:19], v7 offset:3008
    v_mfma_f32_16x16x32_bf16 v[84:87], v[124:127], v[236:239], v[84:87]
    s_waitcnt lgkmcnt(3)
    v_mfma_f32_16x16x32_bf16 v[80:83], v[88:91], v[240:243], v[80:83]
    ds_read_b128 v[20:23], v7 offset:2992
    v_cvt_pk_bf16_f32 v220, v196, v200
    v_mfma_f32_16x16x32_bf16 v[84:87], v[120:123], v[240:243], v[84:87]
    v_cvt_pk_bf16_f32 v221, v197, v201
    v_cvt_pk_bf16_f32 v222, v198, v202
    v_mfma_f32_16x16x32_bf16 v[84:87], v[116:119], v[244:247], v[84:87]
    ds_read_b128 v[232:235], v7 offset:3776
    v_cvt_pk_bf16_f32 v223, v199, v203
    s_nop 1
    v_mfma_f32_16x16x32_bf16 v[80:83], v[220:223], v[156:159], v[80:83]
    v_cvt_pk_bf16_f32 v224, v204, v208
    v_cvt_pk_bf16_f32 v225, v205, v209
    v_mfma_f32_16x16x32_bf16 v[84:87], v[220:223], v[164:167], v[84:87]
    v_cvt_pk_bf16_f32 v226, v206, v210
    v_cvt_pk_bf16_f32 v227, v207, v211
    s_waitcnt lgkmcnt(3)
    v_mfma_f32_16x16x32_bf16 v[84:87], v[112:115], v[248:251], v[84:87]
    ds_read_b128 v[236:239], v7 offset:3840
    v_cvt_pk_bf16_f32 v76, v76, v77
    v_mfma_f32_16x16x32_bf16 v[80:83], v[224:227], v[160:163], v[80:83]
    v_cvt_pk_bf16_f32 v77, v78, v79
    v_mov_b32 v78, v76
    v_mfma_f32_16x16x32_bf16 v[84:87], v[224:227], v[168:171], v[84:87]
    v_mov_b32_e64 v79, v77
    v_mfma_f32_16x16x32_bf16 v[84:87], v[108:111], v[252:255], v[84:87]
    ds_read_b128 v[240:243], v7 offset:3904
    s_waitcnt lgkmcnt(3)
    v_mfma_f32_16x16x32_bf16 v[196:199], v[16:19], v[28:31], 0
    ds_read_b128 v[244:247], v7 offset:3968
    v_permlane16_swap_b32 v76, v78
    v_mfma_f32_16x16x32_bf16 v[200:203], v[16:19], v[32:35], 0
    v_permlane16_swap_b32 v77, v79
    v_mfma_f32_16x16x32_bf16 v[204:207], v[16:19], v[36:39], 0
    v_mfma_f32_16x16x32_bf16 v[208:211], v[20:23], v[40:43], 0
    ds_read_b128 v[248:251], v7 offset:4032
    s_waitcnt lgkmcnt(3)
    v_mfma_f32_16x16x32_bf16 v[84:87], v[104:107], v[232:235], v[84:87]
    v_mfma_f32_16x16x32_bf16 v[84:87], v[100:103], v[236:239], v[84:87]
    s_mov_b64 exec, s[74:75]
    buffer_store_dwordx4 v[76:79], v26, s[76:79], s62 offen offset:2560 sc1
    s_mov_b64 exec, -1
    v_cvt_pk_bf16_f32 v220, v196, v200
    s_waitcnt lgkmcnt(2)
    v_mfma_f32_16x16x32_bf16 v[84:87], v[96:99], v[240:243], v[84:87]
    v_cvt_pk_bf16_f32 v221, v197, v201
    v_cvt_pk_bf16_f32 v222, v198, v202
    v_cvt_pk_bf16_f32 v223, v199, v203
    s_nop 1
    v_mfma_f32_16x16x32_bf16 v[84:87], v[220:223], v[156:159], v[84:87]
    v_cvt_pk_bf16_f32 v224, v204, v208
    v_cvt_pk_bf16_f32 v225, v205, v209
    s_waitcnt lgkmcnt(1)
    v_mfma_f32_16x16x32_bf16 v[84:87], v[92:95], v[244:247], v[84:87]
    v_cvt_pk_bf16_f32 v226, v206, v210
    v_cvt_pk_bf16_f32 v227, v207, v211
    s_nop 1
    v_mfma_f32_16x16x32_bf16 v[84:87], v[224:227], v[160:163], v[84:87]
    s_waitcnt lgkmcnt(0)
    v_mfma_f32_16x16x32_bf16 v[84:87], v[88:91], v[248:251], v[84:87]
    v_cvt_pk_bf16_f32 v80, v80, v81
    v_cvt_pk_bf16_f32 v81, v82, v83
    s_nop 5
    v_cvt_pk_bf16_f32 v82, v84, v85
    v_cvt_pk_bf16_f32 v83, v86, v87
    s_nop 0
    v_permlane16_swap_b32 v80, v82
    v_permlane16_swap_b32 v81, v83
    buffer_store_dwordx4 v[80:83], v26, s[76:79], s62 offen offset:3072 sc1
L_A_last:
    v_mov_b32 v6, s71
    v_mov_b32_e64 v22, s55
    s_mov_b64 exec, 1
    s_waitcnt vmcnt(0)
    global_store_dword v6, v22, s[46:47] sc1
    s_mov_b64 exec, -1
    s_lshl_b32 s4, s49, 3
    s_add_u32 s4, s4, s50
    s_lshl_b32 s4, s4, 3
    s_add_u32 s4, s4, s48
    s_cmp_lg_u32 s4, 1986
    s_cbranch_scc1 L_fin3
    v_min_u32 v8, 55, v1
    v_lshlrev_b32 v8, 8, v8
    v_add_u32 v8, 393216, v8
    s_mov_b32 s58, 1000000
L_pollW:
    s_sleep 24
    global_load_dwordx4 v[64:67], v8, s[46:47] offset:0 sc1
    global_load_dwordx4 v[68:71], v8, s[46:47] offset:128 sc1
    s_sub_u32 s58, s58, 1
    s_waitcnt vmcnt(0)
    s_cbranch_scc1 L_pollW_done
    v_xor_b32 v64, s55, v64
    v_xor_b32 v65, s55, v65
    v_xor_b32 v66, s55, v66
    v_xor_b32 v67, s55, v67
    v_xor_b32 v68, s55, v68
    v_xor_b32 v69, s55, v69
    v_xor_b32 v70, s55, v70
    v_xor_b32 v71, s55, v71
    v_or_b32 v64, v64, v65
    v_or_b32 v64, v64, v66
    v_or_b32 v64, v64, v67
    v_or_b32 v64, v64, v68
    v_or_b32 v64, v64, v69
    v_or_b32 v64, v64, v70
    v_or_b32 v64, v64, v71
    v_cmp_ne_u32 vcc, 0, v64
    s_nop 1
    s_cbranch_vccnz L_pollW
L_pollW_done:
    v_mov_b32 v6, 0
    v_mov_b32_e64 v7, s55
    s_mov_b64 exec, 1
    global_store_dword v6, v7, s[46:47] sc1
    s_mov_b64 exec, -1
L_fin3:
    s_endpgm
L_A_R2:
    v_min_u32_e64 v30, 5, v1
    v_lshl_add_u32 v30, v30, 7, s12
    global_load_dwordx2 v[28:29], v30, s[46:47] sc1
    v_lshl_add_u32 v8, v1, 4, s68
    s_mul_i32 s4, s48, 5120
    s_add_u32 s4, s4, 69632
    v_lshl_add_u32 v9, v1, 4, s4
    ds_read_b128 v[60:63], v8 offset:0
    ds_read_b128 v[96:99], v8 offset:1024
    ds_read_b128 v[100:103], v8 offset:2048
    ds_read_b128 v[104:107], v8 offset:3072
    ds_read_b128 v[108:111], v8 offset:4096
    ds_read_b128 v[248:251], v8 offset:5120
    ds_read_b128 v[252:255], v8 offset:6144
    ds_read_b128 v[20:23], v8 offset:7168
    ds_read_b128 v[76:79], v9 offset:0
    ds_read_b128 v[80:83], v9 offset:1024
    ds_read_b128 v[84:87], v9 offset:2048
    ds_read_b128 v[88:91], v9 offset:3072
    ds_read_b128 v[92:95], v9 offset:4096
    v_mov_b32 v6, s71
    v_mov_b32 v16, s55
    v_mov_b32 v17, s14
    v_mov_b32 v7, 1
    v_and_b32 v5, 3, v1
    v_lshlrev_b32 v5, 3, v5
    v_add_u32 v5, 149504, v5
    ds_write_b32 v4, v7
    s_mov_b32 s68, s42
    s_mov_b32 s69, s43
    s_mov_b32 s70, 4718592
    s_mov_b32 s71, 0x20000
    v_mov_b64 v[32:33], 0
    v_mov_b64 v[34:35], 0
    v_mov_b64 v[36:37], 0
    v_mov_b64 v[38:39], 0
    v_mov_b64 v[40:41], 0
    v_mov_b64 v[42:43], 0
    v_mov_b64 v[44:45], 0
    v_mov_b64 v[46:47], 0
    v_mov_b64 v[48:49], 0
    v_mov_b64 v[50:51], 0
    v_mov_b64 v[52:53], 0
    v_mov_b64 v[54:55], 0
    s_mov_b32 s58, 1000000
L_pollD:
    ds_read_b32 v26, v5
    s_sub_u32 s58, s58, 1
    s_waitcnt lgkmcnt(0)
    s_cbranch_scc1 L_pollD_done
    v_cmp_ne_u32 vcc, 1, v26
    s_nop 1
    s_cbranch_vccnz L_pollD
L_pollD_done:
    s_waitcnt vmcnt(0)
    v_cmp_ne_u64 s[72:73], v[28:29], v[16:17]
    s_mov_b64 exec, 1
    global_store_dword v6, v16, s[46:47] sc1
    s_mov_b64 exec, -1
    s_branch L_P2
L_end:
    s_endpgm
.fill 64, 4, 0xbf800000
.section .rodata,"a"
.p2align 8
band_tab:
.long 0x00000000, 0x00000000, 0x00000000, 0x00000000
.long 0x00000000, 0x00000000, 0x00000000, 0x00000000
.long 0x00000000, 0x00000000, 0x00000000, 0x00000000
.long 0x00000000, 0x00000000, 0x00000000, 0x00000000
.long 0x00000000, 0x00000000, 0x00000000, 0x00000000
.long 0x00000000, 0x00000000, 0x00000000, 0x00000000
.long 0x00000000, 0x00000000, 0x00000000, 0x00000000
.long 0x00000000, 0x00000000, 0x00000000, 0x00000000
.long 0x00000000, 0x00000000, 0x00000000, 0x00000000
.long 0x00000000, 0x00000000, 0x00000000, 0x00000000
.long 0x00000000, 0x00000000, 0x00000000, 0x00000000
.long 0x00000000, 0x00000000, 0x00000000, 0x00000000
.long 0x00000000, 0x00000000, 0x00000000, 0x00000000
.long 0x00000000, 0x00000000, 0x00000000, 0x00000000
.long 0x00000000, 0x00000000, 0x00000000, 0x00000000
.long 0x00000000, 0x00000000, 0x00000000, 0x00000000
.long 0x00000000, 0x3f800000, 0x3f803f80, 0x00000000
.long 0x00000000, 0x00000000, 0x3f803f80, 0x00003f80
.long 0x00000000, 0x00000000, 0x3f800000, 0x3f803f80
.long 0x00000000, 0x00000000, 0x00000000, 0x3f803f80
.long 0x00000000, 0x00000000, 0x00000000, 0x3f800000
.long 0x00000000, 0x00000000, 0x00000000, 0x00000000
.long 0x00000000, 0x00000000, 0x00000000, 0x00000000
.long 0x00000000, 0x00000000, 0x00000000, 0x00000000
.long 0x00000000, 0x00000000, 0x00000000, 0x00000000
.long 0x00000000, 0x00000000, 0x00000000, 0x00000000
.long 0x00000000, 0x00000000, 0x00000000, 0x00000000
.long 0x00000000, 0x00000000, 0x00000000, 0x00000000
.long 0x00000000, 0x00000000, 0x00000000, 0x00000000
.long 0x00000000, 0x00000000, 0x00000000, 0x00000000
.long 0x00000000, 0x00000000, 0x00000000, 0x00000000
.long 0x00000000, 0x00000000, 0x00000000, 0x00000000
.long 0x00000000, 0x00000000, 0x00000000, 0x00000000
.long 0x00000000, 0x00000000, 0x00000000, 0x00000000
.long 0x00000000, 0x00000000, 0x00000000, 0x00000000
.long 0x00003f80, 0x00000000, 0x00000000, 0x00000000
.long 0x3f803f80, 0x00000000, 0x00000000, 0x00000000
.long 0x3f803f80, 0x00003f80, 0x00000000, 0x00000000
.long 0x3f800000, 0x3f803f80, 0x00000000, 0x00000000
.long 0x00000000, 0x3f803f80, 0x00003f80, 0x00000000
.long 0x00000000, 0x3f800000, 0x3f803f80, 0x00000000
.long 0x00000000, 0x00000000, 0x3f803f80, 0x00003f80
.long 0x00000000, 0x00000000, 0x3f800000, 0x3f803f80
.long 0x00000000, 0x00000000, 0x00000000, 0x3f803f80
.long 0x00000000, 0x00000000, 0x00000000, 0x3f800000
.long 0x00000000, 0x00000000, 0x00000000, 0x00000000
.long 0x00000000, 0x00000000, 0x00000000, 0x00000000
.long 0x00000000, 0x00000000, 0x00000000, 0x00000000
.long 0x00000000, 0x00000000, 0x00000000, 0x00000000
.long 0x00000000, 0x00000000, 0x00000000, 0x00000000
.long 0x00000000, 0x00000000, 0x00000000, 0x00000000
.long 0x00000000, 0x00000000, 0x00000000, 0x00000000
.long 0x00000000, 0x00000000, 0x00000000, 0x00000000
.long 0x00000000, 0x00000000, 0x00000000, 0x00000000
.long 0x00000000, 0x00000000, 0x00000000, 0x00000000
.long 0x00000000, 0x00000000, 0x00000000, 0x00000000
.long 0x00000000, 0x00000000, 0x00000000, 0x00000000
.long 0x00000000, 0x00000000, 0x00000000, 0x00000000
.long 0x00000000, 0x00000000, 0x00000000, 0x00000000
.long 0x00003f80, 0x00000000, 0x00000000, 0x00000000
.long 0x3f803f80, 0x00000000, 0x00000000, 0x00000000
.long 0x3f803f80, 0x00003f80, 0x00000000, 0x00000000
.long 0x3f800000, 0x3f803f80, 0x00000000, 0x00000000
.long 0x00000000, 0x3f803f80, 0x00003f80, 0x00000000
.long 0x00000000, 0x00000000, 0x00000000, 0x3f803f80
.long 0x00000000, 0x00000000, 0x00000000, 0x3f800000
.long 0x00000000, 0x00000000, 0x00000000, 0x00000000
.long 0x00000000, 0x00000000, 0x00000000, 0x00000000
.long 0x00000000, 0x00000000, 0x00000000, 0x00000000
.long 0x00000000, 0x00000000, 0x00000000, 0x00000000
.long 0x00000000, 0x00000000, 0x00000000, 0x00000000
.long 0x00000000, 0x00000000, 0x00000000, 0x00000000
.long 0x00000000, 0x00000000, 0x00000000, 0x00000000
.long 0x00000000, 0x00000000, 0x00000000, 0x00000000
.long 0x00000000, 0x00000000, 0x00000000, 0x00000000
.long 0x00000000, 0x00000000, 0x00000000, 0x00000000
.long 0x00000000, 0x00000000, 0x00000000, 0x00000000
.long 0x00000000, 0x00000000, 0x00000000, 0x00000000
.long 0x00000000, 0x00000000, 0x00000000, 0x00000000
.long 0x00000000, 0x00000000, 0x00000000, 0x00000000
.long 0x3f803f80, 0x00003f80, 0x00000000, 0x00000000
.long 0x3f803f80, 0x3f803f80, 0x00000000, 0x00000000
.long 0x3f803f80, 0x3f803f80, 0x00003f80, 0x00000000
.long 0x3f800000, 0x3f803f80, 0x3f803f80, 0x00000000
.long 0x00000000, 0x3f803f80, 0x3f803f80, 0x00003f80
.long 0x00000000, 0x3f800000, 0x3f803f80, 0x3f803f80
.long 0x00000000, 0x00000000, 0x3f803f80, 0x3f803f80
.long 0x00000000, 0x00000000, 0x3f800000, 0x3f803f80
.long 0x00000000, 0x00000000, 0x00000000, 0x3f803f80
.long 0x00000000, 0x00000000, 0x00000000, 0x3f800000
.long 0x00000000, 0x00000000, 0x00000000, 0x00000000
.long 0x00000000, 0x00000000, 0x00000000, 0x00000000
.long 0x00000000, 0x00000000, 0x00000000, 0x00000000
.long 0x00000000, 0x00000000, 0x00000000, 0x00000000
.long 0x00000000, 0x00000000, 0x00000000, 0x00000000
.long 0x00000000, 0x00000000, 0x00000000, 0x00000000
.long 0x00000000, 0x00000000, 0x00000000, 0x00000000
.long 0x00000000, 0x00000000, 0x00000000, 0x00000000
.long 0x00000000, 0x00000000, 0x00000000, 0x00000000
.long 0x00000000, 0x00000000, 0x00000000, 0x00000000
.long 0x00000000, 0x00000000, 0x00000000, 0x00000000
.long 0x00000000, 0x00000000, 0x00000000, 0x00000000
.long 0x00003f80, 0x00000000, 0x00000000, 0x00000000
.long 0x3f803f80, 0x00000000, 0x00000000, 0x00000000
.long 0x3f803f80, 0x00003f80, 0x00000000, 0x00000000
.long 0x3f803f80, 0x3f803f80, 0x00000000, 0x00000000
.long 0x3f803f80, 0x3f803f80, 0x00003f80, 0x00000000
.long 0x3f800000, 0x3f803f80, 0x3f803f80, 0x00000000
.long 0x00000000, 0x3f803f80, 0x3f803f80, 0x00003f80
.long 0x00000000, 0x3f800000, 0x3f803f80, 0x3f803f80
.long 0x00000000, 0x00000000, 0x3f803f80, 0x3f803f80
.long 0x00000000, 0x00000000, 0x3f800000, 0x3f803f80
.long 0x00000000, 0x00000000, 0x00000000, 0x00000000
.long 0x00000000, 0x00000000, 0x00000000, 0x00000000
.long 0x00000000, 0x00000000, 0x00000000, 0x00000000
.long 0x00000000, 0x00000000, 0x00000000, 0x00000000
.long 0x00000000, 0x00000000, 0x00000000, 0x00000000
.long 0x00000000, 0x00000000, 0x00000000, 0x00000000
.long 0x00000000, 0x00000000, 0x00000000, 0x00000000
.long 0x00000000, 0x00000000, 0x00000000, 0x00000000
.long 0x00000000, 0x00000000, 0x00000000, 0x00000000
.long 0x00000000, 0x00000000, 0x00000000, 0x00000000
.long 0x00000000, 0x00000000, 0x00000000, 0x00000000
.long 0x00000000, 0x00000000, 0x00000000, 0x00000000
.long 0x00000000, 0x00000000, 0x00000000, 0x00000000
.long 0x00000000, 0x00000000, 0x00000000, 0x00000000
.long 0x00003f80, 0x00000000, 0x00000000, 0x00000000
.long 0x3f803f80, 0x00000000, 0x00000000, 0x00000000
.long 0x00000000, 0x3f800000, 0x3f803f80, 0x00000000
.long 0x00000000, 0x00000000, 0x3f803f80, 0x00003f80
.long 0x00000000, 0x00000000, 0x3f800000, 0x3f803f80
.long 0x00000000, 0x00000000, 0x00000000, 0x3f803f80
.long 0x00000000, 0x00000000, 0x00000000, 0x3f800000
.long 0x00000000, 0x00000000, 0x00000000, 0x00000000
.long 0x00000000, 0x00000000, 0x00000000, 0x00000000
.long 0x00000000, 0x00000000, 0x00000000, 0x00000000
.long 0x00000000, 0x00000000, 0x00000000, 0x00000000
.long 0x00000000, 0x00000000, 0x00000000, 0x00000000
.long 0x00000000, 0x00000000, 0x00000000, 0x00000000
.long 0x00000000, 0x00000000, 0x00000000, 0x00000000
.long 0x00000000, 0x00000000, 0x00000000, 0x00000000
.long 0x00000000, 0x00000000, 0x00000000, 0x00000000
.long 0x00000000, 0x00000000, 0x00000000, 0x00000000
.long 0x00000000, 0x00000000, 0x00000000, 0x00000000
.long 0x00000000, 0x00000000, 0x00000000, 0x00000000
.long 0x00000000, 0x00000000, 0x00000000, 0x00000000
.long 0x00000000, 0x00000000, 0x00000000, 0x00000000
.long 0x00003f80, 0x00000000, 0x00000000, 0x00000000
.long 0x3f803f80, 0x00000000, 0x00000000, 0x00000000
.long 0x3f803f80, 0x00003f80, 0x00000000, 0x00000000
.long 0x3f800000, 0x3f803f80, 0x00000000, 0x00000000
.long 0x00000000, 0x3f803f80, 0x00003f80, 0x00000000
.long 0x00000000, 0x3f800000, 0x3f803f80, 0x00000000
.long 0x00000000, 0x00000000, 0x3f803f80, 0x00003f80
.long 0x00000000, 0x00000000, 0x3f800000, 0x3f803f80
.long 0x00000000, 0x00000000, 0x00000000, 0x3f803f80
.long 0x00000000, 0x00000000, 0x00000000, 0x3f800000
.long 0x00000000, 0x00000000, 0x00000000, 0x00000000
.long 0x00000000, 0x00000000, 0x00000000, 0x00000000
.long 0x00000000, 0x00000000, 0x00000000, 0x00000000
.long 0x00000000, 0x00000000, 0x00000000, 0x00000000
.long 0x00000000, 0x00000000, 0x00000000, 0x00000000
.long 0x00000000, 0x00000000, 0x00000000, 0x00000000
.long 0x00000000, 0x00000000, 0x00000000, 0x00000000
.long 0x00000000, 0x00000000, 0x00000000, 0x00000000
.long 0x00000000, 0x00000000, 0x00000000, 0x00000000
.long 0x00000000, 0x00000000, 0x00000000, 0x00000000
.long 0x00000000, 0x00000000, 0x00000000, 0x00000000
.long 0x00000000, 0x00000000, 0x00000000, 0x00000000
.long 0x00000000, 0x00000000, 0x00000000, 0x00000000
.long 0x00000000, 0x00000000, 0x00000000, 0x00000000
.long 0x00003f80, 0x00000000, 0x00000000, 0x00000000
.long 0x3f803f80, 0x00000000, 0x00000000, 0x00000000
.long 0x3f803f80, 0x00003f80, 0x00000000, 0x00000000
.long 0x3f800000, 0x3f803f80, 0x00000000, 0x00000000
.long 0x00000000, 0x3f803f80, 0x00003f80, 0x00000000
.long 0x00000000, 0x00000000, 0x00000000, 0x00000000
.long 0x00000000, 0x00000000, 0x00000000, 0x00000000
.long 0x00000000, 0x00000000, 0x00000000, 0x00000000
.long 0x00000000, 0x00000000, 0x00000000, 0x00000000
.long 0x00000000, 0x00000000, 0x00000000, 0x00000000
.long 0x00000000, 0x00000000, 0x00000000, 0x00000000
.long 0x00000000, 0x00000000, 0x00000000, 0x00000000
.long 0x00000000, 0x00000000, 0x00000000, 0x00000000
.long 0x00000000, 0x00000000, 0x00000000, 0x00000000
.long 0x00000000, 0x00000000, 0x00000000, 0x00000000
.long 0x00000000, 0x00000000, 0x00000000, 0x00000000
.long 0x00000000, 0x00000000, 0x00000000, 0x00000000
.long 0x00000000, 0x00000000, 0x00000000, 0x00000000
.long 0x00000000, 0x00000000, 0x00000000, 0x00000000
.long 0x00000000, 0x00000000, 0x00000000, 0x00000000
.long 0x00000000, 0x00000000, 0x00000000, 0x00000000
.long 0x00000000, 0x00000000, 0x00000000, 0x3f803f80
.long 0x00000000, 0x00000000, 0x00000000, 0x3f800000
.long 0x00000000, 0x00000000, 0x00000000, 0x00000000
.long 0x00000000, 0x00000000, 0x00000000, 0x00000000
.long 0x00000000, 0x00000000, 0x00000000, 0x00000000
.long 0x00000000, 0x00000000, 0x00000000, 0x00000000
.long 0x00000000, 0x00000000, 0x00000000, 0x00000000
.long 0x00000000, 0x00000000, 0x00000000, 0x00000000
.long 0x00000000, 0x00000000, 0x00000000, 0x00000000
.long 0x00000000, 0x00000000, 0x00000000, 0x00000000
.long 0x00000000, 0x00000000, 0x00000000, 0x00000000
.long 0x00000000, 0x00000000, 0x00000000, 0x00000000
.long 0x00000000, 0x00000000, 0x00000000, 0x00000000
.long 0x00000000, 0x00000000, 0x00000000, 0x00000000
.long 0x00000000, 0x00000000, 0x00000000, 0x00000000
.long 0x00000000, 0x00000000, 0x00000000, 0x00000000
.long 0x3f803f80, 0x00003f80, 0x00000000, 0x00000000
.long 0x3f803f80, 0x3f803f80, 0x00000000, 0x00000000
.long 0x3f803f80, 0x3f803f80, 0x00003f80, 0x00000000
.long 0x3f800000, 0x3f803f80, 0x3f803f80, 0x00000000
.long 0x00000000, 0x3f803f80, 0x3f803f80, 0x00003f80
.long 0x00000000, 0x3f800000, 0x3f803f80, 0x3f803f80
.long 0x00000000, 0x00000000, 0x3f803f80, 0x3f803f80
.long 0x00000000, 0x00000000, 0x3f800000, 0x3f803f80
.long 0x00000000, 0x00000000, 0x00000000, 0x3f803f80
.long 0x00000000, 0x00000000, 0x00000000, 0x3f800000
.long 0x00000000, 0x00000000, 0x00000000, 0x00000000
.long 0x00000000, 0x00000000, 0x00000000, 0x00000000
.long 0x00000000, 0x00000000, 0x00000000, 0x00000000
.long 0x00000000, 0x00000000, 0x00000000, 0x00000000
.long 0x00000000, 0x00000000, 0x00000000, 0x00000000
.long 0x00000000, 0x00000000, 0x00000000, 0x00000000
.long 0x00000000, 0x00000000, 0x00000000, 0x00000000
.long 0x00000000, 0x00000000, 0x00000000, 0x00000000
.long 0x00000000, 0x00000000, 0x00000000, 0x00000000
.long 0x00000000, 0x00000000, 0x00000000, 0x00000000
.long 0x00000000, 0x00000000, 0x00000000, 0x00000000
.long 0x00000000, 0x00000000, 0x00000000, 0x00000000
.long 0x00003f80, 0x00000000, 0x00000000, 0x00000000
.long 0x3f803f80, 0x00000000, 0x00000000, 0x00000000
.long 0x3f803f80, 0x00003f80, 0x00000000, 0x00000000
.long 0x3f803f80, 0x3f803f80, 0x00000000, 0x00000000
.long 0x3f803f80, 0x3f803f80, 0x00003f80, 0x00000000
.long 0x3f800000, 0x3f803f80, 0x3f803f80, 0x00000000
.long 0x00000000, 0x3f803f80, 0x3f803f80, 0x00003f80
.long 0x00000000, 0x3f800000, 0x3f803f80, 0x3f803f80
.long 0x00000000, 0x00000000, 0x3f803f80, 0x3f803f80
.long 0x00000000, 0x00000000, 0x3f800000, 0x3f803f80
.long 0x00000000, 0x00000000, 0x00000000, 0x00000000
.long 0x00000000, 0x00000000, 0x00000000, 0x00000000
.long 0x00000000, 0x00000000, 0x00000000, 0x00000000
.long 0x00000000, 0x00000000, 0x00000000, 0x00000000
.long 0x00000000, 0x00000000, 0x00000000, 0x00000000
.long 0x00000000, 0x00000000, 0x00000000, 0x00000000
.long 0x00000000, 0x00000000, 0x00000000, 0x00000000
.long 0x00000000, 0x00000000, 0x00000000, 0x00000000
.long 0x00000000, 0x00000000, 0x00000000, 0x00000000
.long 0x00000000, 0x00000000, 0x00000000, 0x00000000
.long 0x00000000, 0x00000000, 0x00000000, 0x00000000
.long 0x00000000, 0x00000000, 0x00000000, 0x00000000
.long 0x00000000, 0x00000000, 0x00000000, 0x00000000
.long 0x00000000, 0x00000000, 0x00000000, 0x00000000
.long 0x00003f80, 0x00000000, 0x00000000, 0x00000000
.long 0x3f803f80, 0x00000000, 0x00000000, 0x00000000
.long 0x00000000, 0x00000000, 0x3f800000, 0x3f803f80
.long 0x00000000, 0x00000000, 0x00000000, 0x3f803f80
.long 0x00000000, 0x00000000, 0x00000000, 0x3f800000
.long 0x00000000, 0x00000000, 0x00000000, 0x00000000
.long 0x00000000, 0x00000000, 0x00000000, 0x00000000
.long 0x00000000, 0x00000000, 0x00000000, 0x00000000
.long 0x00000000, 0x00000000, 0x00000000, 0x00000000
.long 0x00000000, 0x00000000, 0x00000000, 0x00000000
.long 0x00000000, 0x00000000, 0x00000000, 0x00000000
.long 0x00000000, 0x00000000, 0x00000000, 0x00000000
.long 0x00000000, 0x00000000, 0x00000000, 0x00000000
.long 0x00000000, 0x00000000, 0x00000000, 0x00000000
.long 0x00000000, 0x00000000, 0x00000000, 0x00000000
.long 0x00000000, 0x00000000, 0x00000000, 0x00000000
.long 0x00000000, 0x00000000, 0x00000000, 0x00000000
.long 0x00000000, 0x00000000, 0x00000000, 0x00000000
.long 0x3f803f80, 0x3f803f80, 0x00000000, 0x00000000
.long 0x3f803f80, 0x3f803f80, 0x00003f80, 0x00000000
.long 0x3f803f80, 0x3f803f80, 0x3f803f80, 0x00000000
.long 0x3f803f80, 0x3f803f80, 0x3f803f80, 0x00003f80
.long 0x3f800000, 0x3f803f80, 0x3f803f80, 0x3f803f80
.long 0x00000000, 0x3f803f80, 0x3f803f80, 0x3f803f80
.long 0x00000000, 0x3f800000, 0x3f803f80, 0x3f803f80
.long 0x00000000, 0x00000000, 0x3f803f80, 0x3f803f80
.long 0x00000000, 0x00000000, 0x3f800000, 0x3f803f80
.long 0x00000000, 0x00000000, 0x00000000, 0x3f803f80
.long 0x00000000, 0x00000000, 0x00000000, 0x3f800000
.long 0x00000000, 0x00000000, 0x00000000, 0x00000000
.long 0x00000000, 0x00000000, 0x00000000, 0x00000000
.long 0x00000000, 0x00000000, 0x00000000, 0x00000000
.long 0x00000000, 0x00000000, 0x00000000, 0x00000000
.long 0x00000000, 0x00000000, 0x00000000, 0x00000000
.long 0x00000000, 0x00000000, 0x00000000, 0x00000000
.long 0x00000000, 0x00000000, 0x00000000, 0x00000000
.long 0x00000000, 0x00000000, 0x00000000, 0x00000000
.long 0x00000000, 0x00000000, 0x00000000, 0x00000000
.long 0x00000000, 0x00000000, 0x00000000, 0x00000000
.long 0x00003f80, 0x00000000, 0x00000000, 0x00000000
.long 0x3f803f80, 0x00000000, 0x00000000, 0x00000000
.long 0x3f803f80, 0x00003f80, 0x00000000, 0x00000000
.long 0x3f803f80, 0x3f803f80, 0x00000000, 0x00000000
.long 0x3f803f80, 0x3f803f80, 0x00003f80, 0x00000000
.long 0x3f803f80, 0x3f803f80, 0x3f803f80, 0x00000000
.long 0x3f803f80, 0x3f803f80, 0x3f803f80, 0x00003f80
.long 0x3f800000, 0x3f803f80, 0x3f803f80, 0x3f803f80
.long 0x00000000, 0x3f803f80, 0x3f803f80, 0x3f803f80
.long 0x00000000, 0x3f800000, 0x3f803f80, 0x3f803f80
.long 0x00000000, 0x00000000, 0x3f803f80, 0x3f803f80
.long 0x00000000, 0x00000000, 0x00000000, 0x00000000
.long 0x00000000, 0x00000000, 0x00000000, 0x00000000
.long 0x00000000, 0x00000000, 0x00000000, 0x00000000
.long 0x00000000, 0x00000000, 0x00000000, 0x00000000
.long 0x00000000, 0x00000000, 0x00000000, 0x00000000
.long 0x00000000, 0x00000000, 0x00000000, 0x00000000
.long 0x00000000, 0x00000000, 0x00000000, 0x00000000
.long 0x00000000, 0x00000000, 0x00000000, 0x00000000
.long 0x00000000, 0x00000000, 0x00000000, 0x00000000
.long 0x00000000, 0x00000000, 0x00000000, 0x00000000
.long 0x00000000, 0x00000000, 0x00000000, 0x00000000
.long 0x00000000, 0x00000000, 0x00000000, 0x00000000
.long 0x00000000, 0x00000000, 0x00000000, 0x00000000
.long 0x00003f80, 0x00000000, 0x00000000, 0x00000000
.long 0x3f803f80, 0x00000000, 0x00000000, 0x00000000
.long 0x3f803f80, 0x00003f80, 0x00000000, 0x00000000
.long 0x00000000, 0x00000000, 0x3f803f80, 0x3f803f80
.long 0x00000000, 0x00000000, 0x3f800000, 0x3f803f80
.long 0x00000000, 0x00000000, 0x00000000, 0x3f803f80
.long 0x00000000, 0x00000000, 0x00000000, 0x3f800000
.long 0x00000000, 0x00000000, 0x00000000, 0x00000000
.long 0x00000000, 0x00000000, 0x00000000, 0x00000000
.long 0x00000000, 0x00000000, 0x00000000, 0x00000000
.long 0x00000000, 0x00000000, 0x00000000, 0x00000000
.long 0x00000000, 0x00000000, 0x00000000, 0x00000000
.long 0x00000000, 0x00000000, 0x00000000, 0x00000000
.long 0x00000000, 0x00000000, 0x00000000, 0x00000000
.long 0x00000000, 0x00000000, 0x00000000, 0x00000000
.long 0x00000000, 0x00000000, 0x00000000, 0x00000000
.long 0x00000000, 0x00000000, 0x00000000, 0x00000000
.long 0x00000000, 0x00000000, 0x00000000, 0x00000000
.long 0x00000000, 0x00000000, 0x00000000, 0x00000000
.long 0x3f803f80, 0x3f803f80, 0x00003f80, 0x00000000
.long 0x3f803f80, 0x3f803f80, 0x3f803f80, 0x00000000
.long 0x3f803f80, 0x3f803f80, 0x3f803f80, 0x00003f80
.long 0x3f803f80, 0x3f803f80, 0x3f803f80, 0x3f803f80
.long 0x3f803f80, 0x3f803f80, 0x3f803f80, 0x3f803f80
.long 0x3f800000, 0x3f803f80, 0x3f803f80, 0x3f803f80
.long 0x00000000, 0x3f803f80, 0x3f803f80, 0x3f803f80
.long 0x00000000, 0x3f800000, 0x3f803f80, 0x3f803f80
.long 0x00000000, 0x00000000, 0x3f803f80, 0x3f803f80
.long 0x00000000, 0x00000000, 0x3f800000, 0x3f803f80
.long 0x00000000, 0x00000000, 0x00000000, 0x3f803f80
.long 0x00000000, 0x00000000, 0x00000000, 0x3f800000
.long 0x00000000, 0x00000000, 0x00000000, 0x00000000
.long 0x00000000, 0x00000000, 0x00000000, 0x00000000
.long 0x00000000, 0x00000000, 0x00000000, 0x00000000
.long 0x00000000, 0x00000000, 0x00000000, 0x00000000
.long 0x00000000, 0x00000000, 0x00000000, 0x00000000
.long 0x00000000, 0x00000000, 0x00000000, 0x00000000
.long 0x00000000, 0x00000000, 0x00000000, 0x00000000
.long 0x00000000, 0x00000000, 0x00000000, 0x00000000
.long 0x00003f80, 0x00000000, 0x00000000, 0x00000000
.long 0x3f803f80, 0x00000000, 0x00000000, 0x00000000
.long 0x3f803f80, 0x00003f80, 0x00000000, 0x00000000
.long 0x3f803f80, 0x3f803f80, 0x00000000, 0x00000000
.long 0x3f803f80, 0x3f803f80, 0x00003f80, 0x00000000
.long 0x3f803f80, 0x3f803f80, 0x3f803f80, 0x00000000
.long 0x3f803f80, 0x3f803f80, 0x3f803f80, 0x00003f80
.long 0x3f803f80, 0x3f803f80, 0x3f803f80, 0x3f803f80
.long 0x3f803f80, 0x3f803f80, 0x3f803f80, 0x3f803f80
.long 0x3f800000, 0x3f803f80, 0x3f803f80, 0x3f803f80
.long 0x00000000, 0x3f803f80, 0x3f803f80, 0x3f803f80
.long 0x00000000, 0x3f800000, 0x3f803f80, 0x3f803f80
.long 0x00000000, 0x00000000, 0x00000000, 0x00000000
.long 0x00000000, 0x00000000, 0x00000000, 0x00000000
.long 0x00000000, 0x00000000, 0x00000000, 0x00000000
.long 0x00000000, 0x00000000, 0x00000000, 0x00000000
.long 0x00000000, 0x00000000, 0x00000000, 0x00000000
.long 0x00000000, 0x00000000, 0x00000000, 0x00000000
.long 0x00000000, 0x00000000, 0x00000000, 0x00000000
.long 0x00000000, 0x00000000, 0x00000000, 0x00000000
.long 0x00000000, 0x00000000, 0x00000000, 0x00000000
.long 0x00000000, 0x00000000, 0x00000000, 0x00000000
.long 0x00000000, 0x00000000, 0x00000000, 0x00000000
.long 0x00000000, 0x00000000, 0x00000000, 0x00000000
.long 0x00003f80, 0x00000000, 0x00000000, 0x00000000
.long 0x3f803f80, 0x00000000, 0x00000000, 0x00000000
.long 0x3f803f80, 0x00003f80, 0x00000000, 0x00000000
.long 0x3f803f80, 0x3f803f80, 0x00000000, 0x00000000
.long 0x00000000, 0x00000000, 0x00000000, 0x00000000
.long 0x00000000, 0x00000000, 0x00000000, 0x00000000
.long 0x00000000, 0x00000000, 0x00000000, 0x00000000
.long 0x00000000, 0x00000000, 0x00000000, 0x00000000
.long 0x00000000, 0x00000000, 0x00000000, 0x00000000
.long 0x00000000, 0x00000000, 0x00000000, 0x00000000
.long 0x00000000, 0x00000000, 0x00000000, 0x00000000
.long 0x00000000, 0x00000000, 0x00000000, 0x00000000
.long 0x00000000, 0x00000000, 0x00000000, 0x00000000
.long 0x00000000, 0x00000000, 0x00000000, 0x00000000
.long 0x00000000, 0x00000000, 0x00000000, 0x00000000
.long 0x00000000, 0x00000000, 0x00000000, 0x00000000
.long 0x00000000, 0x00000000, 0x00000000, 0x00000000
.long 0x00000000, 0x00000000, 0x00000000, 0x00000000
.long 0x00000000, 0x00000000, 0x00000000, 0x00000000
.long 0x00000000, 0x00000000, 0x00000000, 0x00000000
.long 0x00000000, 0x00000000, 0xffffffff, 0x00000000
.long 0x00000000, 0x00000000, 0xffff0000, 0x0000ffff
.long 0x00000000, 0x00000000, 0x00000000, 0xffffffff
.long 0x00000000, 0x00000000, 0x00000000, 0xffff0000
.long 0x00000000, 0x00000000, 0x00000000, 0x00000000
.long 0x00000000, 0x00000000, 0x00000000, 0x00000000
.long 0x00000000, 0x00000000, 0x00000000, 0x00000000
.long 0x00000000, 0x00000000, 0x00000000, 0x00000000
.long 0x00000000, 0x00000000, 0x00000000, 0x00000000
.long 0x00000000, 0x00000000, 0x00000000, 0x00000000
.long 0x00000000, 0x00000000, 0x00000000, 0x00000000
.long 0x00000000, 0x00000000, 0x00000000, 0x00000000
.long 0x00000000, 0x00000000, 0x00000000, 0x00000000
.long 0x00000000, 0x00000000, 0x00000000, 0x00000000
.long 0x00000000, 0x00000000, 0x00000000, 0x00000000
.long 0x00000000, 0x00000000, 0x00000000, 0x00000000
.long 0x00000000, 0x00000000, 0x00000000, 0x00000000
.long 0x00000000, 0x00000000, 0x00000000, 0x00000000
.long 0x00000000, 0x00000000, 0x00000000, 0x00000000
.long 0x0000ffff, 0x00000000, 0x00000000, 0x00000000
.long 0xffffffff, 0x00000000, 0x00000000, 0x00000000
.long 0xffff0000, 0x0000ffff, 0x00000000, 0x00000000
.long 0x00000000, 0xffffffff, 0x00000000, 0x00000000
.long 0x00000000, 0xffff0000, 0x0000ffff, 0x00000000
.long 0x00000000, 0x00000000, 0xffffffff, 0x00000000
.long 0x00000000, 0x00000000, 0xffff0000, 0x0000ffff
.long 0x00000000, 0x00000000, 0x00000000, 0xffffffff
.long 0x00000000, 0x00000000, 0x00000000, 0xffff0000
.long 0x00000000, 0x00000000, 0x00000000, 0x00000000
.long 0x00000000, 0x00000000, 0x00000000, 0x00000000
.long 0x00000000, 0x00000000, 0x00000000, 0x00000000
.long 0x00000000, 0x00000000, 0x00000000, 0x00000000
.long 0x00000000, 0x00000000, 0x00000000, 0x00000000
.long 0x00000000, 0x00000000, 0x00000000, 0x00000000
.long 0x00000000, 0x00000000, 0x00000000, 0x00000000
.long 0x00000000, 0x00000000, 0x00000000, 0x00000000
.long 0x00000000, 0x00000000, 0x00000000, 0x00000000
.long 0x00000000, 0x00000000, 0x00000000, 0x00000000
.long 0x00000000, 0x00000000, 0x00000000, 0x00000000
.long 0x00000000, 0x00000000, 0x00000000, 0x00000000
.long 0x00000000, 0x00000000, 0x00000000, 0x00000000
.long 0x00000000, 0x00000000, 0x00000000, 0x00000000
.long 0x00000000, 0x00000000, 0x00000000, 0x00000000
.long 0x0000ffff, 0x00000000, 0x00000000, 0x00000000
.long 0xffffffff, 0x00000000, 0x00000000, 0x00000000
.long 0xffff0000, 0x0000ffff, 0x00000000, 0x00000000
.long 0x00000000, 0xffffffff, 0x00000000, 0x00000000
.long 0x00000000, 0xffff0000, 0x0000ffff, 0x00000000
.fill 256, 4, 0
.p2align 6
.amdhsa_kernel gated_mix__ssm_conv_s4d__ssm_conv_s5__prompt_kernel
  .amdhsa_next_free_vgpr 256
  .amdhsa_next_free_sgpr 102
  .amdhsa_accum_offset 256
  .amdhsa_group_segment_fixed_size 0
  .amdhsa_kernarg_size 160
  .amdhsa_user_sgpr_count 2
  .amdhsa_user_sgpr_kernarg_segment_ptr 1
  .amdhsa_system_sgpr_workgroup_id_x 1
.end_amdhsa_kernel
```
